```python
import torch

def _softmax(x, axis=-1):
    return torch.softmax(x, dim=axis)
def _gelu(x):
    return torch.nn.functional.gelu(x, approximate="tanh")
def _silu(x):
    return torch.nn.functional.silu(x)
def _sigmoid(x):
    return torch.sigmoid(x)
def _layernorm(x, axis=-1, eps=1e-5):
    m = x.mean(dim=axis, keepdim=True)
    v = x.var(dim=axis, keepdim=True, unbiased=False)
    return (x - m) / torch.sqrt(v + eps)
def _scatter_add(tgt, idx, src, axis=0):
    return tgt.clone().index_add_(axis, idx, src)
def _segment_sum(src, seg, n):
    out = torch.zeros((n,) + src.shape[1:], dtype=src.dtype)
    return out.index_add_(0, seg, src)
def _pad(x, pw):
    flat = tuple(v for pair in reversed(pw) for v in pair)
    return torch.nn.functional.pad(x, flat)

kernel_name = 'sequential_preLN__linear_kernel_hedgehog__dense_activation_relu__prompt'

def setup_inputs():

    _w = (lambda a: (lambda t: t.to(torch.bfloat16) if t.is_floating_point() else t)(torch.as_tensor(a)))
    def _A_setup():
        B, S, D, H = 1, 2048, 640, 32
        Dh = D // H
        return {
            "x": _w((lambda *s: torch.randn(*s, dtype=torch.bfloat16) * 0.05)(B, S, D)),
            "wqkv": _w((lambda *s: torch.randn(*s, dtype=torch.bfloat16) * 0.2)(D, 3 * D)),
            "w_phi": _w((lambda *s: torch.randn(*s, dtype=torch.bfloat16) * 0.2)(H, Dh, Dh) * (Dh ** -0.5)),
            "wo": _w((lambda *s: torch.randn(*s, dtype=torch.bfloat16) * 0.05)(D, D)),
        }
    _A_in = _A_setup()

    def _B_setup():
        B, S, D, Dff = 1, 2048, 640, 1728
        return {
            "x": _w((lambda *s: torch.randn(*s, dtype=torch.bfloat16) * 0.05)(B, S, D)),
            "w1": _w((lambda *s: torch.randn(*s, dtype=torch.bfloat16) * 0.05)(D, Dff)),
            "w2": _w((lambda *s: torch.randn(*s, dtype=torch.bfloat16) * 0.05)(Dff, D)),
        }
    _B_in = _B_setup()

    return {
        "A_x": _A_in["x"],
        "A_wqkv": _A_in["wqkv"],
        "A_w_phi": _A_in["w_phi"],
        "A_wo": _A_in["wo"],
        "B_x": _B_in["x"],
        "B_w1": _B_in["w1"],
        "B_w2": _B_in["w2"],
    }

def reference(A_x, A_wqkv, A_w_phi, A_wo, B_x, B_w1, B_w2):
    def _A_ref(x, wqkv, w_phi, wo):
        B, S, D = x.shape
        H = 32; Dh = D // H
        qkv = (lambda x, *d: x.permute(*d))((x @ wqkv).reshape(B, S, 3, H, Dh), 2, 0, 3, 1, 4)
        q, k, v = qkv[0], qkv[1], qkv[2]
        pq = torch.einsum("bhsd,hdf->bhsf", q, w_phi)
        pk = torch.einsum("bhsd,hdf->bhsf", k, w_phi)
        phi_q = torch.concatenate([_softmax(pq, axis=-1), _softmax(-pq, axis=-1)], axis=-1)
        phi_k = torch.concatenate([_softmax(pk, axis=-1), _softmax(-pk, axis=-1)], axis=-1)
        kv = torch.einsum("bhsf,bhsd->bhfd", phi_k, v)
        z  = torch.einsum("bhsf->bhf", phi_k)
        num = torch.einsum("bhqf,bhfd->bhqd", phi_q, kv)
        den = torch.einsum("bhqf,bhf->bhq", phi_q, z)[..., None] + 1e-6
        o = num / den
        return (lambda x, *d: x.permute(*d))(o, 0, 2, 1, 3).reshape(B, S, D) @ wo

    def _B_ref(x, w1, w2):
        h = torch.einsum("bsd,df->bsf", x, w1)
        zero = torch.zeros_like(h)
        h = torch.maximum(h, zero)
        return torch.einsum("bsf,fd->bsd", h, w2)

    x = A_x
    h = x + _A_ref(_layernorm(x, axis=-1), A_wqkv, A_w_phi, A_wo)
    h2 = h + _B_ref(_layernorm(h, axis=-1), B_w1, B_w2)
    return h2
```

```asm
; @launch grid=(256,1,1) block=(512,1,1) lds=163840
.amdgcn_target "amdgcn-amd-amdhsa--gfx950"
.text
.globl sequential_preLN__linear_kernel_hedgehog__dense_activation_relu__prompt_kernel
.p2align 8
.type sequential_preLN__linear_kernel_hedgehog__dense_activation_relu__prompt_kernel,@function
sequential_preLN__linear_kernel_hedgehog__dense_activation_relu__prompt_kernel:
    s_load_dwordx16 s[4:19], s[0:1], 0
    s_load_dwordx4 s[20:23], s[0:1], 64
    s_cmp_ge_u32 s2, 256
    s_cbranch_scc1 L_end
    v_lshrrev_b32 v8, 6, v0
    v_and_b32 v2, 63, v0
    v_readfirstlane_b32 s37, v8
    s_and_b32 s38, s2, 7
    s_lshl_b32 s39, s38, 1
    s_bfe_u32 s40, s2, 0x10003
    s_add_u32 s34, s39, s40
    s_lshr_b32 s35, s2, 4
    s_mul_i32 s38, s34, 1
    s_mul_i32 s39, s35, 1
    s_add_u32 s38, s38, s39
    s_mul_i32 s39, s38, 13108
    s_lshr_b32 s39, s39, 16
    s_mul_i32 s39, s39, 5
    s_sub_u32 s62, s38, s39
    s_and_b32 s36, s37, 3
    s_mul_i32 s63, s36, 4096
    s_add_u32 s63, s63, 61440
    s_cmp_lt_u32 s37, 4
    s_cbranch_scc1 L_compute
    v_lshrrev_b32 v8, 3, v2
    v_lshrrev_b32 v9, 4, v2
    v_and_b32 v10, 7, v2
    v_xor_b32 v9, v9, v10
    v_mul_u32_u24 v8, 1280, v8
    v_lshl_add_u32 v28, v9, 4, v8
    v_xor_b32 v29, 64, v28
    v_add_u32 v30, 18432, v28
    v_add_u32 v31, 27648, v29
    v_add_u32 v29, 9216, v29
    s_lshl_b32 s38, s34, 2
    s_add_u32 s38, s38, s36
    s_mul_i32 s70, s38, 40960
    s_mul_i32 s38, s36, 122880
    s_mul_i32 s71, s35, 80
    s_add_u32 s71, s71, s38
    s_mul_i32 s76, s36, 5120
    v_add_u32 v8, 0, v2
    v_mul_u32_u24 v9, 6554, v8
    v_lshrrev_b32 v9, 16, v9
    v_mul_u32_u24 v10, 10, v9
    v_sub_u32 v8, v8, v10
    v_and_b32 v32, 0x13, v9
    v_bfe_u32 v10, v9, 2, 1
    v_lshl_add_u32 v32, v10, 3, v32
    v_bfe_u32 v10, v9, 3, 1
    v_lshl_add_u32 v32, v10, 2, v32
    v_mul_u32_u24 v32, 3840, v32
    v_lshl_add_u32 v32, v8, 4, v32
    v_cmp_lt_u32 vcc, 4, v8
    v_mov_b32 v9, 1280
    v_mov_b32 v10, 2480
    v_cndmask_b32 v9, v9, v10, vcc
    v_add_u32 v32, v32, v9
    v_add_u32 v8, 64, v2
    v_mul_u32_u24 v9, 6554, v8
    v_lshrrev_b32 v9, 16, v9
    v_mul_u32_u24 v10, 10, v9
    v_sub_u32 v8, v8, v10
    v_and_b32 v33, 0x13, v9
    v_bfe_u32 v10, v9, 2, 1
    v_lshl_add_u32 v33, v10, 3, v33
    v_bfe_u32 v10, v9, 3, 1
    v_lshl_add_u32 v33, v10, 2, v33
    v_mul_u32_u24 v33, 3840, v33
    v_lshl_add_u32 v33, v8, 4, v33
    v_cmp_lt_u32 vcc, 4, v8
    v_mov_b32 v9, 256
    v_mov_b32 v10, 1456
    v_cndmask_b32 v9, v9, v10, vcc
    v_add_u32 v33, v33, v9
    v_add_u32 v8, 128, v2
    v_mul_u32_u24 v9, 6554, v8
    v_lshrrev_b32 v9, 16, v9
    v_mul_u32_u24 v10, 10, v9
    v_sub_u32 v8, v8, v10
    v_and_b32 v34, 0x13, v9
    v_bfe_u32 v10, v9, 2, 1
    v_lshl_add_u32 v34, v10, 3, v34
    v_bfe_u32 v10, v9, 3, 1
    v_lshl_add_u32 v34, v10, 2, v34
    v_mul_u32_u24 v34, 3840, v34
    v_lshl_add_u32 v34, v8, 4, v34
    v_cmp_lt_u32 vcc, 4, v8
    v_mov_b32 v9, -768
    v_mov_b32 v10, 432
    v_cndmask_b32 v9, v9, v10, vcc
    v_add_u32 v34, v34, v9
    v_add_u32 v8, 192, v2
    v_mul_u32_u24 v9, 6554, v8
    v_lshrrev_b32 v9, 16, v9
    v_mul_u32_u24 v10, 10, v9
    v_sub_u32 v8, v8, v10
    v_and_b32 v35, 0x13, v9
    v_bfe_u32 v10, v9, 2, 1
    v_lshl_add_u32 v35, v10, 3, v35
    v_bfe_u32 v10, v9, 3, 1
    v_lshl_add_u32 v35, v10, 2, v35
    v_mul_u32_u24 v35, 3840, v35
    v_lshl_add_u32 v35, v8, 4, v35
    v_cmp_lt_u32 vcc, 4, v8
    v_mov_b32 v9, -1792
    v_mov_b32 v10, -592
    v_cndmask_b32 v9, v9, v10, vcc
    v_add_u32 v35, v35, v9
    v_add_u32 v8, 256, v2
    v_mul_u32_u24 v9, 6554, v8
    v_lshrrev_b32 v9, 16, v9
    v_mul_u32_u24 v10, 10, v9
    v_sub_u32 v8, v8, v10
    v_and_b32 v36, 0x13, v9
    v_bfe_u32 v10, v9, 2, 1
    v_lshl_add_u32 v36, v10, 3, v36
    v_bfe_u32 v10, v9, 3, 1
    v_lshl_add_u32 v36, v10, 2, v36
    v_mul_u32_u24 v36, 3840, v36
    v_lshl_add_u32 v36, v8, 4, v36
    v_cmp_lt_u32 vcc, 4, v8
    v_mov_b32 v9, 1280
    v_mov_b32 v10, 2480
    v_cndmask_b32 v9, v9, v10, vcc
    v_add_u32 v36, v36, v9
    s_waitcnt lgkmcnt(0)
    s_mov_b32 s28, s4
    s_and_b32 s29, s5, 0xffff
    s_mov_b32 s30, 2621440
    s_mov_b32 s31, 0x20000
    s_mov_b32 s72, s6
    s_and_b32 s73, s7, 0xffff
    s_mov_b32 s74, 2457600
    s_mov_b32 s75, 0x20000
    s_mul_i32 s51, s62, 256
    s_add_u32 s51, s51, s70
    s_add_u32 m0, s63, 0
    s_nop 0
    buffer_load_dwordx4 v28, s[28:31], s51 offen lds
    buffer_load_dwordx4 v29, s[28:31], s51 offen offset:1024 lds
    buffer_load_dwordx4 v30, s[28:31], s51 offen offset:2048 lds
    buffer_load_dwordx4 v31, s[28:31], s51 offen offset:3072 lds
    s_mul_i32 s51, s62, 491520
    s_add_u32 s51, s51, s71
    s_add_u32 m0, s76, 0
    s_nop 0
    buffer_load_dwordx4 v32, s[72:75], s51 offen lds
    buffer_load_dwordx4 v33, s[72:75], s51 offen offset:1024 lds
    buffer_load_dwordx4 v34, s[72:75], s51 offen offset:2048 lds
    buffer_load_dwordx4 v35, s[72:75], s51 offen offset:3072 lds
    s_add_u32 m0, s76, 4096
    s_nop 0
    buffer_load_dwordx4 v36, s[72:75], s51 offen lds
    s_mul_i32 s51, s62, 256
    s_add_u32 s51, s51, s70
    s_add_u32 s51, s51, 128
    s_add_u32 m0, s63, 16384
    s_nop 0
    buffer_load_dwordx4 v28, s[28:31], s51 offen lds
    buffer_load_dwordx4 v29, s[28:31], s51 offen offset:1024 lds
    buffer_load_dwordx4 v30, s[28:31], s51 offen offset:2048 lds
    buffer_load_dwordx4 v31, s[28:31], s51 offen offset:3072 lds
    s_load_dwordx2 s[32:33], s[22:23], 0
    s_mov_b32 s24, s22
    s_and_b32 s25, s23, 0xffff
    s_mov_b32 s26, 268435456
    s_mov_b32 s27, 0x20000
    v_lshlrev_b32 v3, 4, v2
    v_lshlrev_b32 v4, 2, v2
    v_lshlrev_b32 v5, 3, v2
    v_lshrrev_b32 v6, 4, v2
    v_and_b32 v7, 15, v2
    v_mov_b32 v11, 0
    s_getreg_b32 s50, hwreg(HW_REG_XCC_ID)
    s_lshl_b32 s53, s36, 10
    s_lshl_b32 s56, s34, 4
    s_add_u32 s56, s56, s35
    s_mul_i32 s56, s56, 128
    s_add_u32 s56, s56, 65536
    s_lshl_b32 s38, s34, 3
    s_lshl_b32 s39, s36, 1
    s_add_u32 s57, s38, s39
    s_and_b32 s58, s35, 7
    s_lshr_b32 s59, s35, 3
    s_lshl_b32 s40, s59, 2
    s_add_u32 s60, s38, s40
    s_add_u32 s60, s60, s36
    s_mul_i32 s64, s58, 102400
    s_add_u32 s64, s64, 1048576
    s_add_u32 s64, s64, s53
    s_mul_i32 s65, s35, 143360
    s_add_u32 s65, s65, 1900544
    s_add_u32 s65, s65, s53
    s_mul_i32 s66, s58, 276480
    s_add_u32 s66, s66, 4194304
    s_add_u32 s66, s66, s53
    s_xor_b32 s69, s35, 1
    s_mul_i32 s38, s57, 20480
    s_add_u32 s38, s38, 6422528
    s_lshl_b32 s39, s69, 10
    s_add_u32 s67, s38, s39
    s_lshl_b32 s39, s69, 8
    s_add_u32 s68, s38, s39
    s_add_u32 s68, s68, 16384
    s_mul_i32 s61, s69, 32768
    s_add_u32 s61, s61, 18874368
    v_mov_b32 v8, 0x3f803f80
    v_accvgpr_write_b32 a0, v8
    v_accvgpr_write_b32 a1, v8
    v_accvgpr_write_b32 a2, v8
    v_accvgpr_write_b32 a3, v8
    v_lshrrev_b32 v8, 1, v7
    v_xor_b32 v8, v8, v6
    v_lshlrev_b32 v8, 4, v8
    v_lshl_add_u32 v8, v7, 7, v8
    v_add_u32 v21, s63, v8
    v_xor_b32 v22, 64, v21
    v_bfe_u32 v25, v2, 2, 3
    v_and_b32 v8, 32, v2
    v_lshrrev_b32 v8, 1, v8
    v_add_u32 v25, v25, v8
    v_and_b32 v9, 3, v2
    v_mul_u32_u24 v8, 160, v25
    v_lshl_add_u32 v23, v9, 3, v8
    v_mul_u32_u24 v9, 40, v9
    v_add3_u32 v24, v8, v9, 32
    s_lshl_b32 s38, s36, 2
    s_add_u32 s38, s38, 159744
    v_mov_b32 v26, s38
    v_and_b32 v8, 3, v2
    v_lshlrev_b32 v8, 2, v8
    v_add_u32 v27, 159744, v8
    v_add_u32 v8, 0, v2
    v_mul_u32_u24 v9, 10923, v8
    v_lshrrev_b32 v9, 16, v9
    v_mul_u32_u24 v10, 6, v9
    v_sub_u32 v8, v8, v10
    v_and_b32 v37, 0x13, v9
    v_bfe_u32 v10, v9, 2, 1
    v_lshl_add_u32 v37, v10, 3, v37
    v_bfe_u32 v10, v9, 3, 1
    v_lshl_add_u32 v37, v10, 2, v37
    v_mul_u32_u24 v37, 3840, v37
    v_lshl_add_u32 v37, v8, 4, v37
    v_cmp_gt_u32 vcc, 5, v8
    v_mov_b32 v9, 0x40000000
    s_nop 0
    v_cndmask_b32 v37, v9, v37, vcc
    v_add_u32 v8, 64, v2
    v_mul_u32_u24 v9, 10923, v8
    v_lshrrev_b32 v9, 16, v9
    v_mul_u32_u24 v10, 6, v9
    v_sub_u32 v8, v8, v10
    v_and_b32 v38, 0x13, v9
    v_bfe_u32 v10, v9, 2, 1
    v_lshl_add_u32 v38, v10, 3, v38
    v_bfe_u32 v10, v9, 3, 1
    v_lshl_add_u32 v38, v10, 2, v38
    v_mul_u32_u24 v38, 3840, v38
    v_lshl_add_u32 v38, v8, 4, v38
    v_add_u32 v38, 0xfffffc00, v38
    v_cmp_gt_u32 vcc, 5, v8
    v_mov_b32 v9, 0x40000000
    s_nop 0
    v_cndmask_b32 v38, v9, v38, vcc
    v_add_u32 v8, 128, v2
    v_mul_u32_u24 v9, 10923, v8
    v_lshrrev_b32 v9, 16, v9
    v_mul_u32_u24 v10, 6, v9
    v_sub_u32 v8, v8, v10
    v_and_b32 v39, 0x13, v9
    v_bfe_u32 v10, v9, 2, 1
    v_lshl_add_u32 v39, v10, 3, v39
    v_bfe_u32 v10, v9, 3, 1
    v_lshl_add_u32 v39, v10, 2, v39
    v_mul_u32_u24 v39, 3840, v39
    v_lshl_add_u32 v39, v8, 4, v39
    v_add_u32 v39, 0xfffff800, v39
    v_cmp_gt_u32 vcc, 5, v8
    v_mov_b32 v9, 0x40000000
    s_nop 0
    v_cndmask_b32 v39, v9, v39, vcc
    s_mul_i32 s38, s36, 122880
    s_mul_i32 s77, s69, 80
    s_add_u32 s77, s77, s38
    v_add_u32 v76, s76, v23
    v_add_u32 v77, s76, v24
    v_and_b32 v9, 3, v2
    v_mul_u32_u24 v8, 96, v25
    v_lshl_add_u32 v23, v9, 3, v8
    v_and_b32 v9, 1, v2
    v_mul_u32_u24 v9, 40, v9
    v_add3_u32 v24, v8, v9, 32
    v_add_u32 v78, 94208, v23
    v_add_u32 v79, 94208, v24
    s_waitcnt lgkmcnt(0)
    s_add_u32 s32, s32, 1
    s_addc_u32 s33, s33, 0
    v_mov_b32 v16, s32
    v_mov_b32 v17, s33
    v_mov_b32 v18, s50
    v_mov_b32 v19, 0
    s_barrier
    s_waitcnt vmcnt(9)
    v_mov_b32 v10, 1
    ds_write_b32 v26, v10 offset:80
    s_waitcnt vmcnt(4)
    v_mov_b32 v10, 2
    ds_write_b32 v26, v10 offset:80
    s_add_u32 s51, s62, 1
    s_cmp_ge_u32 s51, 5
    s_cselect_b32 s52, 5, 0
    s_sub_u32 s51, s51, s52
    s_mul_i32 s51, s51, 491520
    s_add_u32 s51, s51, s71
    s_add_u32 m0, s76, 20480
    s_nop 0
    buffer_load_dwordx4 v32, s[72:75], s51 offen lds
    buffer_load_dwordx4 v33, s[72:75], s51 offen offset:1024 lds
    buffer_load_dwordx4 v34, s[72:75], s51 offen offset:2048 lds
    buffer_load_dwordx4 v35, s[72:75], s51 offen offset:3072 lds
    s_add_u32 m0, s76, 24576
    s_nop 0
    buffer_load_dwordx4 v36, s[72:75], s51 offen lds
    ds_read_b128 a[4:7], v21
    ds_read_b128 a[8:11], v21 offset:2048
    ds_read_b128 a[12:15], v22
    ds_read_b128 a[16:19], v22 offset:2048
    s_waitcnt lgkmcnt(0)
    v_mfma_f32_16x16x32_bf16 v[60:63], a[0:3], a[4:7], 0
    v_mfma_f32_16x16x32_bf16 v[68:71], a[4:7], a[4:7], 0
    v_mfma_f32_16x16x32_bf16 v[64:67], a[0:3], a[8:11], 0
    v_mfma_f32_16x16x32_bf16 v[72:75], a[8:11], a[8:11], 0
    v_mfma_f32_16x16x32_bf16 v[60:63], a[0:3], a[12:15], v[60:63]
    v_mfma_f32_16x16x32_bf16 v[68:71], a[12:15], a[12:15], v[68:71]
    v_mfma_f32_16x16x32_bf16 v[64:67], a[0:3], a[16:19], v[64:67]
    v_mfma_f32_16x16x32_bf16 v[72:75], a[16:19], a[16:19], v[72:75]
    ds_read_b64_tr_b16 v[80:81], v76
    ds_read_b64_tr_b16 v[82:83], v76 offset:1280
    ds_read_b64_tr_b16 v[84:85], v76 offset:40
    ds_read_b64_tr_b16 v[86:87], v76 offset:1320
    ds_read_b64_tr_b16 v[88:89], v77
    ds_read_b64_tr_b16 v[90:91], v77 offset:1280
    ds_read_b64_tr_b16 v[92:93], v76 offset:80
    ds_read_b64_tr_b16 v[94:95], v76 offset:1360
    ds_read_b64_tr_b16 v[96:97], v76 offset:120
    ds_read_b64_tr_b16 v[98:99], v76 offset:1400
    s_add_u32 s51, s62, 1
    s_cmp_ge_u32 s51, 5
    s_cselect_b32 s52, 5, 0
    s_sub_u32 s51, s51, s52
    s_mul_i32 s51, s51, 256
    s_add_u32 s51, s51, s70
    s_add_u32 m0, s63, 32768
    s_nop 0
    buffer_load_dwordx4 v28, s[28:31], s51 offen lds
    buffer_load_dwordx4 v29, s[28:31], s51 offen offset:1024 lds
    buffer_load_dwordx4 v30, s[28:31], s51 offen offset:2048 lds
    buffer_load_dwordx4 v31, s[28:31], s51 offen offset:3072 lds
    s_waitcnt vmcnt(9)
    v_mov_b32 v10, 3
    ds_write_b32 v26, v10 offset:80
    s_add_u32 s51, s62, 1
    s_cmp_ge_u32 s51, 5
    s_cselect_b32 s52, 5, 0
    s_sub_u32 s51, s51, s52
    s_mul_i32 s51, s51, 256
    s_add_u32 s51, s51, s70
    s_add_u32 s51, s51, 128
    s_add_u32 m0, s63, 49152
    s_nop 0
    buffer_load_dwordx4 v28, s[28:31], s51 offen lds
    buffer_load_dwordx4 v29, s[28:31], s51 offen offset:1024 lds
    buffer_load_dwordx4 v30, s[28:31], s51 offen offset:2048 lds
    buffer_load_dwordx4 v31, s[28:31], s51 offen offset:3072 lds
    s_waitcnt lgkmcnt(1)
    v_mfma_f32_16x16x32_bf16 v[40:43], v[80:83], a[0:3], 0
    v_mfma_f32_16x16x32_bf16 v[44:47], v[84:87], a[0:3], 0
    v_mfma_f32_16x16x32_bf16 v[48:51], v[88:91], a[0:3], 0
    v_mfma_f32_16x16x32_bf16 v[52:55], v[92:95], a[0:3], 0
    v_mfma_f32_16x16x32_bf16 v[56:59], v[96:99], a[0:3], 0
    ds_read_b128 a[20:23], v21 offset:16384
    ds_read_b128 a[24:27], v21 offset:18432
    ds_read_b128 a[28:31], v22 offset:16384
    ds_read_b128 a[32:35], v22 offset:18432
    ds_read_b32 v12, v27 offset:176
    s_waitcnt lgkmcnt(0)
    v_cmp_gt_u32 vcc, 2, v12
    s_cbranch_vccnz L_cw_100001
L_cn_100002:
    s_waitcnt vmcnt(8)
    v_mov_b32 v10, 4
    ds_write_b32 v26, v10 offset:80
    s_add_u32 s51, s62, 2
    s_cmp_ge_u32 s51, 5
    s_cselect_b32 s52, 5, 0
    s_sub_u32 s51, s51, s52
    s_mul_i32 s51, s51, 491520
    s_add_u32 s51, s51, s71
    s_add_u32 m0, s76, 40960
    s_nop 0
    buffer_load_dwordx4 v32, s[72:75], s51 offen lds
    buffer_load_dwordx4 v33, s[72:75], s51 offen offset:1024 lds
    buffer_load_dwordx4 v34, s[72:75], s51 offen offset:2048 lds
    buffer_load_dwordx4 v35, s[72:75], s51 offen offset:3072 lds
    s_add_u32 m0, s76, 45056
    s_nop 0
    buffer_load_dwordx4 v36, s[72:75], s51 offen lds
    v_mfma_f32_16x16x32_bf16 v[60:63], a[0:3], a[20:23], v[60:63]
    v_mfma_f32_16x16x32_bf16 v[68:71], a[20:23], a[20:23], v[68:71]
    v_mfma_f32_16x16x32_bf16 v[64:67], a[0:3], a[24:27], v[64:67]
    v_mfma_f32_16x16x32_bf16 v[72:75], a[24:27], a[24:27], v[72:75]
    v_mfma_f32_16x16x32_bf16 v[60:63], a[0:3], a[28:31], v[60:63]
    v_mfma_f32_16x16x32_bf16 v[68:71], a[28:31], a[28:31], v[68:71]
    v_mfma_f32_16x16x32_bf16 v[64:67], a[0:3], a[32:35], v[64:67]
    v_mfma_f32_16x16x32_bf16 v[72:75], a[32:35], a[32:35], v[72:75]
    ds_read_b64_tr_b16 v[80:81], v76 offset:20480
    ds_read_b64_tr_b16 v[82:83], v76 offset:21760
    ds_read_b64_tr_b16 v[84:85], v76 offset:20520
    ds_read_b64_tr_b16 v[86:87], v76 offset:21800
    ds_read_b64_tr_b16 v[88:89], v77 offset:20480
    ds_read_b64_tr_b16 v[90:91], v77 offset:21760
    ds_read_b64_tr_b16 v[92:93], v76 offset:20560
    ds_read_b64_tr_b16 v[94:95], v76 offset:21840
    ds_read_b64_tr_b16 v[96:97], v76 offset:20600
    ds_read_b64_tr_b16 v[98:99], v76 offset:21880
    s_waitcnt vmcnt(9)
    v_mov_b32 v10, 5
    ds_write_b32 v26, v10 offset:80
    ds_read_b32 v12, v26 offset:96
    s_waitcnt lgkmcnt(0)
    v_cmp_gt_u32 vcc, 1, v12
    s_cbranch_vccnz L_cw_100004
L_cn_100005:
    s_add_u32 s51, s62, 2
    s_cmp_ge_u32 s51, 5
    s_cselect_b32 s52, 5, 0
    s_sub_u32 s51, s51, s52
    s_mul_i32 s51, s51, 256
    s_add_u32 s51, s51, s70
    s_add_u32 m0, s63, 0
    s_nop 0
    buffer_load_dwordx4 v28, s[28:31], s51 offen lds
    buffer_load_dwordx4 v29, s[28:31], s51 offen offset:1024 lds
    buffer_load_dwordx4 v30, s[28:31], s51 offen offset:2048 lds
    buffer_load_dwordx4 v31, s[28:31], s51 offen offset:3072 lds
    v_mfma_f32_16x16x32_bf16 v[40:43], v[80:83], a[0:3], v[40:43]
    v_mfma_f32_16x16x32_bf16 v[44:47], v[84:87], a[0:3], v[44:47]
    v_mfma_f32_16x16x32_bf16 v[48:51], v[88:91], a[0:3], v[48:51]
    v_mfma_f32_16x16x32_bf16 v[52:55], v[92:95], a[0:3], v[52:55]
    v_mfma_f32_16x16x32_bf16 v[56:59], v[96:99], a[0:3], v[56:59]
    ds_read_b128 a[36:39], v21 offset:32768
    ds_read_b128 a[40:43], v21 offset:34816
    ds_read_b128 a[44:47], v22 offset:32768
    ds_read_b128 a[48:51], v22 offset:34816
    s_waitcnt vmcnt(9)
    v_mov_b32 v10, 6
    ds_write_b32 v26, v10 offset:80
    ds_read_b32 v12, v26 offset:96
    s_waitcnt lgkmcnt(0)
    v_cmp_gt_u32 vcc, 2, v12
    s_cbranch_vccnz L_cw_100007
L_cn_100008:
    s_add_u32 s51, s62, 2
    s_cmp_ge_u32 s51, 5
    s_cselect_b32 s52, 5, 0
    s_sub_u32 s51, s51, s52
    s_mul_i32 s51, s51, 256
    s_add_u32 s51, s51, s70
    s_add_u32 s51, s51, 128
    s_add_u32 m0, s63, 16384
    s_nop 0
    buffer_load_dwordx4 v28, s[28:31], s51 offen lds
    buffer_load_dwordx4 v29, s[28:31], s51 offen offset:1024 lds
    buffer_load_dwordx4 v30, s[28:31], s51 offen offset:2048 lds
    buffer_load_dwordx4 v31, s[28:31], s51 offen offset:3072 lds
    v_mfma_f32_16x16x32_bf16 v[60:63], a[0:3], a[36:39], v[60:63]
    v_mfma_f32_16x16x32_bf16 v[68:71], a[36:39], a[36:39], v[68:71]
    v_mfma_f32_16x16x32_bf16 v[64:67], a[0:3], a[40:43], v[64:67]
    v_mfma_f32_16x16x32_bf16 v[72:75], a[40:43], a[40:43], v[72:75]
    v_mfma_f32_16x16x32_bf16 v[60:63], a[0:3], a[44:47], v[60:63]
    v_mfma_f32_16x16x32_bf16 v[68:71], a[44:47], a[44:47], v[68:71]
    v_mfma_f32_16x16x32_bf16 v[64:67], a[0:3], a[48:51], v[64:67]
    v_mfma_f32_16x16x32_bf16 v[72:75], a[48:51], a[48:51], v[72:75]
    ds_read_b128 a[52:55], v21 offset:49152
    ds_read_b128 a[56:59], v21 offset:51200
    ds_read_b128 a[60:63], v22 offset:49152
    ds_read_b128 a[64:67], v22 offset:51200
    s_waitcnt vmcnt(8)
    v_mov_b32 v10, 7
    ds_write_b32 v26, v10 offset:80
    ds_read_b32 v12, v27 offset:96
    s_waitcnt lgkmcnt(0)
    v_cmp_gt_u32 vcc, 3, v12
    s_cbranch_vccnz L_cw_100010
L_cn_100011:
    s_add_u32 s51, s62, 3
    s_cmp_ge_u32 s51, 5
    s_cselect_b32 s52, 5, 0
    s_sub_u32 s51, s51, s52
    s_mul_i32 s51, s51, 491520
    s_add_u32 s51, s51, s71
    s_add_u32 m0, s76, 0
    s_nop 0
    buffer_load_dwordx4 v32, s[72:75], s51 offen lds
    buffer_load_dwordx4 v33, s[72:75], s51 offen offset:1024 lds
    buffer_load_dwordx4 v34, s[72:75], s51 offen offset:2048 lds
    buffer_load_dwordx4 v35, s[72:75], s51 offen offset:3072 lds
    s_add_u32 m0, s76, 4096
    s_nop 0
    buffer_load_dwordx4 v36, s[72:75], s51 offen lds
    v_mfma_f32_16x16x32_bf16 v[60:63], a[0:3], a[52:55], v[60:63]
    v_mfma_f32_16x16x32_bf16 v[68:71], a[52:55], a[52:55], v[68:71]
    v_mfma_f32_16x16x32_bf16 v[64:67], a[0:3], a[56:59], v[64:67]
    v_mfma_f32_16x16x32_bf16 v[72:75], a[56:59], a[56:59], v[72:75]
    v_mfma_f32_16x16x32_bf16 v[60:63], a[0:3], a[60:63], v[60:63]
    v_mfma_f32_16x16x32_bf16 v[68:71], a[60:63], a[60:63], v[68:71]
    v_mfma_f32_16x16x32_bf16 v[64:67], a[0:3], a[64:67], v[64:67]
    v_mfma_f32_16x16x32_bf16 v[72:75], a[64:67], a[64:67], v[72:75]
    ds_read_b64_tr_b16 v[80:81], v76 offset:40960
    ds_read_b64_tr_b16 v[82:83], v76 offset:42240
    ds_read_b64_tr_b16 v[84:85], v76 offset:41000
    ds_read_b64_tr_b16 v[86:87], v76 offset:42280
    ds_read_b64_tr_b16 v[88:89], v77 offset:40960
    ds_read_b64_tr_b16 v[90:91], v77 offset:42240
    ds_read_b64_tr_b16 v[92:93], v76 offset:41040
    ds_read_b64_tr_b16 v[94:95], v76 offset:42320
    ds_read_b64_tr_b16 v[96:97], v76 offset:41080
    ds_read_b64_tr_b16 v[98:99], v76 offset:42360
    s_waitcnt vmcnt(9)
    v_mov_b32 v10, 8
    ds_write_b32 v26, v10 offset:80
    s_add_u32 s51, s62, 3
    s_cmp_ge_u32 s51, 5
    s_cselect_b32 s52, 5, 0
    s_sub_u32 s51, s51, s52
    s_mul_i32 s51, s51, 256
    s_add_u32 s51, s51, s70
    s_add_u32 m0, s63, 32768
    s_nop 0
    buffer_load_dwordx4 v28, s[28:31], s51 offen lds
    buffer_load_dwordx4 v29, s[28:31], s51 offen offset:1024 lds
    buffer_load_dwordx4 v30, s[28:31], s51 offen offset:2048 lds
    buffer_load_dwordx4 v31, s[28:31], s51 offen offset:3072 lds
    s_waitcnt lgkmcnt(1)
    v_mfma_f32_16x16x32_bf16 v[40:43], v[80:83], a[0:3], v[40:43]
    v_mfma_f32_16x16x32_bf16 v[44:47], v[84:87], a[0:3], v[44:47]
    v_mfma_f32_16x16x32_bf16 v[48:51], v[88:91], a[0:3], v[48:51]
    v_mfma_f32_16x16x32_bf16 v[52:55], v[92:95], a[0:3], v[52:55]
    v_mfma_f32_16x16x32_bf16 v[56:59], v[96:99], a[0:3], v[56:59]
    ds_read_b128 a[68:71], v21
    ds_read_b128 a[72:75], v21 offset:2048
    ds_read_b128 a[76:79], v22
    ds_read_b128 a[80:83], v22 offset:2048
    s_waitcnt vmcnt(9)
    v_mov_b32 v10, 9
    ds_write_b32 v26, v10 offset:80
    ds_read_b32 v12, v26 offset:96
    s_waitcnt lgkmcnt(0)
    v_cmp_gt_u32 vcc, 4, v12
    s_cbranch_vccnz L_cw_100013
L_cn_100014:
    s_add_u32 s51, s62, 3
    s_cmp_ge_u32 s51, 5
    s_cselect_b32 s52, 5, 0
    s_sub_u32 s51, s51, s52
    s_mul_i32 s51, s51, 256
    s_add_u32 s51, s51, s70
    s_add_u32 s51, s51, 128
    s_add_u32 m0, s63, 49152
    s_nop 0
    buffer_load_dwordx4 v28, s[28:31], s51 offen lds
    buffer_load_dwordx4 v29, s[28:31], s51 offen offset:1024 lds
    buffer_load_dwordx4 v30, s[28:31], s51 offen offset:2048 lds
    buffer_load_dwordx4 v31, s[28:31], s51 offen offset:3072 lds
    v_mfma_f32_16x16x32_bf16 v[60:63], a[0:3], a[68:71], v[60:63]
    v_mfma_f32_16x16x32_bf16 v[68:71], a[68:71], a[68:71], v[68:71]
    v_mfma_f32_16x16x32_bf16 v[64:67], a[0:3], a[72:75], v[64:67]
    v_mfma_f32_16x16x32_bf16 v[72:75], a[72:75], a[72:75], v[72:75]
    v_mfma_f32_16x16x32_bf16 v[60:63], a[0:3], a[76:79], v[60:63]
    v_mfma_f32_16x16x32_bf16 v[68:71], a[76:79], a[76:79], v[68:71]
    v_mfma_f32_16x16x32_bf16 v[64:67], a[0:3], a[80:83], v[64:67]
    v_mfma_f32_16x16x32_bf16 v[72:75], a[80:83], a[80:83], v[72:75]
    ds_read_b128 a[84:87], v21 offset:16384
    ds_read_b128 a[88:91], v21 offset:18432
    ds_read_b128 a[92:95], v22 offset:16384
    ds_read_b128 a[96:99], v22 offset:18432
    s_waitcnt vmcnt(8)
    v_mov_b32 v10, 10
    ds_write_b32 v26, v10 offset:80
    ds_read_b32 v12, v27 offset:96
    s_waitcnt lgkmcnt(0)
    v_cmp_gt_u32 vcc, 5, v12
    s_cbranch_vccnz L_cw_100016
L_cn_100017:
    s_add_u32 s51, s62, 4
    s_cmp_ge_u32 s51, 5
    s_cselect_b32 s52, 5, 0
    s_sub_u32 s51, s51, s52
    s_mul_i32 s51, s51, 491520
    s_add_u32 s51, s51, s71
    s_add_u32 m0, s76, 20480
    s_nop 0
    buffer_load_dwordx4 v32, s[72:75], s51 offen lds
    buffer_load_dwordx4 v33, s[72:75], s51 offen offset:1024 lds
    buffer_load_dwordx4 v34, s[72:75], s51 offen offset:2048 lds
    buffer_load_dwordx4 v35, s[72:75], s51 offen offset:3072 lds
    s_add_u32 m0, s76, 24576
    s_nop 0
    buffer_load_dwordx4 v36, s[72:75], s51 offen lds
    v_mfma_f32_16x16x32_bf16 v[60:63], a[0:3], a[84:87], v[60:63]
    v_mfma_f32_16x16x32_bf16 v[68:71], a[84:87], a[84:87], v[68:71]
    v_mfma_f32_16x16x32_bf16 v[64:67], a[0:3], a[88:91], v[64:67]
    v_mfma_f32_16x16x32_bf16 v[72:75], a[88:91], a[88:91], v[72:75]
    v_mfma_f32_16x16x32_bf16 v[60:63], a[0:3], a[92:95], v[60:63]
    v_mfma_f32_16x16x32_bf16 v[68:71], a[92:95], a[92:95], v[68:71]
    v_mfma_f32_16x16x32_bf16 v[64:67], a[0:3], a[96:99], v[64:67]
    v_mfma_f32_16x16x32_bf16 v[72:75], a[96:99], a[96:99], v[72:75]
    ds_read_b64_tr_b16 v[80:81], v76
    ds_read_b64_tr_b16 v[82:83], v76 offset:1280
    ds_read_b64_tr_b16 v[84:85], v76 offset:40
    ds_read_b64_tr_b16 v[86:87], v76 offset:1320
    ds_read_b64_tr_b16 v[88:89], v77
    ds_read_b64_tr_b16 v[90:91], v77 offset:1280
    ds_read_b64_tr_b16 v[92:93], v76 offset:80
    ds_read_b64_tr_b16 v[94:95], v76 offset:1360
    ds_read_b64_tr_b16 v[96:97], v76 offset:120
    ds_read_b64_tr_b16 v[98:99], v76 offset:1400
    s_waitcnt vmcnt(9)
    v_mov_b32 v10, 11
    ds_write_b32 v26, v10 offset:80
    s_add_u32 s51, s62, 4
    s_cmp_ge_u32 s51, 5
    s_cselect_b32 s52, 5, 0
    s_sub_u32 s51, s51, s52
    s_mul_i32 s51, s51, 256
    s_add_u32 s51, s51, s70
    s_add_u32 m0, s63, 0
    s_nop 0
    buffer_load_dwordx4 v28, s[28:31], s51 offen lds
    buffer_load_dwordx4 v29, s[28:31], s51 offen offset:1024 lds
    buffer_load_dwordx4 v30, s[28:31], s51 offen offset:2048 lds
    buffer_load_dwordx4 v31, s[28:31], s51 offen offset:3072 lds
    s_waitcnt lgkmcnt(1)
    v_mfma_f32_16x16x32_bf16 v[40:43], v[80:83], a[0:3], v[40:43]
    v_mfma_f32_16x16x32_bf16 v[44:47], v[84:87], a[0:3], v[44:47]
    v_mfma_f32_16x16x32_bf16 v[48:51], v[88:91], a[0:3], v[48:51]
    v_mfma_f32_16x16x32_bf16 v[52:55], v[92:95], a[0:3], v[52:55]
    v_mfma_f32_16x16x32_bf16 v[56:59], v[96:99], a[0:3], v[56:59]
    ds_read_b128 a[100:103], v21 offset:32768
    ds_read_b128 a[104:107], v21 offset:34816
    ds_read_b128 v[80:83], v22 offset:32768
    ds_read_b128 v[84:87], v22 offset:34816
    v_mov_b32 v10, 7
    ds_write_b32 v26, v10 offset:112
    s_waitcnt vmcnt(9)
    v_mov_b32 v10, 12
    ds_write_b32 v26, v10 offset:80
    ds_read_b32 v12, v26 offset:96
    s_waitcnt lgkmcnt(0)
    v_cmp_gt_u32 vcc, 6, v12
    s_cbranch_vccnz L_cw_100019
L_cn_100020:
    s_add_u32 s51, s62, 4
    s_cmp_ge_u32 s51, 5
    s_cselect_b32 s52, 5, 0
    s_sub_u32 s51, s51, s52
    s_mul_i32 s51, s51, 256
    s_add_u32 s51, s51, s70
    s_add_u32 s51, s51, 128
    s_add_u32 m0, s63, 16384
    s_nop 0
    buffer_load_dwordx4 v28, s[28:31], s51 offen lds
    buffer_load_dwordx4 v29, s[28:31], s51 offen offset:1024 lds
    buffer_load_dwordx4 v30, s[28:31], s51 offen offset:2048 lds
    buffer_load_dwordx4 v31, s[28:31], s51 offen offset:3072 lds
    v_mfma_f32_16x16x32_bf16 v[60:63], a[0:3], a[100:103], v[60:63]
    v_mfma_f32_16x16x32_bf16 v[68:71], a[100:103], a[100:103], v[68:71]
    v_mfma_f32_16x16x32_bf16 v[64:67], a[0:3], a[104:107], v[64:67]
    v_mfma_f32_16x16x32_bf16 v[72:75], a[104:107], a[104:107], v[72:75]
    v_mfma_f32_16x16x32_bf16 v[60:63], a[0:3], v[80:83], v[60:63]
    v_mfma_f32_16x16x32_bf16 v[68:71], v[80:83], v[80:83], v[68:71]
    v_mfma_f32_16x16x32_bf16 v[64:67], a[0:3], v[84:87], v[64:67]
    v_mfma_f32_16x16x32_bf16 v[72:75], v[84:87], v[84:87], v[72:75]
    ds_read_b128 v[88:91], v21 offset:49152
    ds_read_b128 v[92:95], v21 offset:51200
    ds_read_b128 v[96:99], v22 offset:49152
    ds_read_b128 v[100:103], v22 offset:51200
    v_mov_b32 v10, 8
    ds_write_b32 v26, v10 offset:112
    s_waitcnt vmcnt(8)
    v_mov_b32 v10, 13
    ds_write_b32 v26, v10 offset:80
    s_waitcnt lgkmcnt(2)
    v_mfma_f32_16x16x32_bf16 v[60:63], a[0:3], v[88:91], v[60:63]
    v_mfma_f32_16x16x32_bf16 v[68:71], v[88:91], v[88:91], v[68:71]
    v_mfma_f32_16x16x32_bf16 v[64:67], a[0:3], v[92:95], v[64:67]
    v_mfma_f32_16x16x32_bf16 v[72:75], v[92:95], v[92:95], v[72:75]
    v_mfma_f32_16x16x32_bf16 v[60:63], a[0:3], v[96:99], v[60:63]
    v_mfma_f32_16x16x32_bf16 v[68:71], v[96:99], v[96:99], v[68:71]
    v_mfma_f32_16x16x32_bf16 v[64:67], a[0:3], v[100:103], v[64:67]
    v_mfma_f32_16x16x32_bf16 v[72:75], v[100:103], v[100:103], v[72:75]
    ds_read_b64_tr_b16 v[104:105], v76 offset:20480
    ds_read_b64_tr_b16 v[106:107], v76 offset:21760
    ds_read_b64_tr_b16 v[108:109], v76 offset:20520
    ds_read_b64_tr_b16 v[110:111], v76 offset:21800
    ds_read_b64_tr_b16 v[112:113], v77 offset:20480
    ds_read_b64_tr_b16 v[114:115], v77 offset:21760
    ds_read_b64_tr_b16 v[116:117], v76 offset:20560
    ds_read_b64_tr_b16 v[118:119], v76 offset:21840
    ds_read_b64_tr_b16 v[120:121], v76 offset:20600
    ds_read_b64_tr_b16 v[122:123], v76 offset:21880
    s_waitcnt vmcnt(4)
    v_mov_b32 v10, 14
    ds_write_b32 v26, v10 offset:80
    s_waitcnt lgkmcnt(1)
    v_mfma_f32_16x16x32_bf16 v[40:43], v[104:107], a[0:3], v[40:43]
    v_mfma_f32_16x16x32_bf16 v[44:47], v[108:111], a[0:3], v[44:47]
    v_mfma_f32_16x16x32_bf16 v[48:51], v[112:115], a[0:3], v[48:51]
    v_mfma_f32_16x16x32_bf16 v[52:55], v[116:119], a[0:3], v[52:55]
    v_mfma_f32_16x16x32_bf16 v[56:59], v[120:123], a[0:3], v[56:59]
    s_mul_i32 s38, s36, 512
    s_add_u32 s38, s38, 161792
    v_lshl_add_u32 v8, v6, 4, s38
    s_nop 0
    ds_write_b128 v8, v[40:43]
    ds_write_b128 v8, v[44:47] offset:64
    ds_write_b128 v8, v[48:51] offset:128
    ds_write_b128 v8, v[52:55] offset:192
    ds_write_b128 v8, v[56:59] offset:256
    v_mov_b32 v10, 1
    ds_write_b32 v26, v10 offset:160
    ds_read_b128 v[40:43], v21
    ds_read_b128 v[44:47], v21 offset:2048
    ds_read_b128 v[48:51], v22
    ds_read_b128 v[52:55], v22 offset:2048
    v_mov_b32 v10, 9
    ds_write_b32 v26, v10 offset:112
    ds_read_b32 v12, v27 offset:144
    s_waitcnt lgkmcnt(0)
    v_cmp_gt_u32 vcc, 1, v12
    s_cbranch_vccnz L_cw_100022
L_cn_100023:
    s_mul_i32 s51, s62, 491520
    s_add_u32 s51, s51, s77
    s_mul_i32 s52, s36, 3072
    s_add_u32 m0, s52, 126976
    s_nop 0
    buffer_load_dwordx4 v37, s[72:75], s51 offen lds
    buffer_load_dwordx4 v38, s[72:75], s51 offen offset:1024 lds
    buffer_load_dwordx4 v39, s[72:75], s51 offen offset:2048 lds
    v_mfma_f32_16x16x32_bf16 v[60:63], a[0:3], v[40:43], v[60:63]
    v_mfma_f32_16x16x32_bf16 v[68:71], v[40:43], v[40:43], v[68:71]
    v_mfma_f32_16x16x32_bf16 v[64:67], a[0:3], v[44:47], v[64:67]
    v_mfma_f32_16x16x32_bf16 v[72:75], v[44:47], v[44:47], v[72:75]
    v_mfma_f32_16x16x32_bf16 v[60:63], a[0:3], v[48:51], v[60:63]
    v_mfma_f32_16x16x32_bf16 v[68:71], v[48:51], v[48:51], v[68:71]
    v_mfma_f32_16x16x32_bf16 v[64:67], a[0:3], v[52:55], v[64:67]
    v_mfma_f32_16x16x32_bf16 v[72:75], v[52:55], v[52:55], v[72:75]
    ds_read_b32 v12, v27 offset:160
    s_waitcnt lgkmcnt(0)
    v_cmp_gt_u32 vcc, 1, v12
    s_cbranch_vccnz L_cw_100025
L_cn_100026:
    s_lshl_b32 s38, s36, 6
    s_add_u32 s38, s38, 161792
    v_lshl_add_u32 v8, v6, 4, s38
    ds_read_b128 v[56:59], v8
    ds_read_b128 v[104:107], v8 offset:512
    ds_read_b128 v[108:111], v8 offset:1024
    ds_read_b128 v[112:115], v8 offset:1536
    s_waitcnt lgkmcnt(0)
    v_add_f32 v56, v56, v104
    v_add_f32 v108, v108, v112
    v_add_f32 v57, v57, v105
    v_add_f32 v109, v109, v113
    v_add_f32 v58, v58, v106
    v_add_f32 v110, v110, v114
    v_add_f32 v59, v59, v107
    v_add_f32 v111, v111, v115
    v_add_f32 v56, v56, v108
    v_add_f32 v57, v57, v109
    v_add_f32 v58, v58, v110
    v_add_f32 v59, v59, v111
    v_subrev_u32 v8, 1792, v8
    ds_write_b128 v8, v[56:59]
    v_lshlrev_b32 v8, 4, v6
    v_add_u32 v8, 162048, v8
    ds_read_b128 v[56:59], v8
    ds_read_b128 v[104:107], v8 offset:512
    ds_read_b128 v[108:111], v8 offset:1024
    ds_read_b128 v[112:115], v8 offset:1536
    s_waitcnt lgkmcnt(0)
    v_add_f32 v56, v56, v104
    v_add_f32 v108, v108, v112
    v_add_f32 v57, v57, v105
    v_add_f32 v109, v109, v113
    v_add_f32 v58, v58, v106
    v_add_f32 v110, v110, v114
    v_add_f32 v59, v59, v107
    v_add_f32 v111, v111, v115
    v_add_f32 v56, v56, v108
    v_add_f32 v57, v57, v109
    v_add_f32 v58, v58, v110
    v_add_f32 v59, v59, v111
    v_subrev_u32 v8, 1792, v8
    ds_write_b128 v8, v[56:59]
    s_waitcnt vmcnt(3)
    v_mov_b32 v10, 15
    ds_write_b32 v26, v10 offset:80
    ds_read_b128 v[56:59], v21 offset:16384
    ds_read_b128 v[104:107], v21 offset:18432
    ds_read_b128 v[108:111], v22 offset:16384
    ds_read_b128 v[112:115], v22 offset:18432
    v_mov_b32 v10, 10
    ds_write_b32 v26, v10 offset:112
    s_waitcnt lgkmcnt(1)
    v_mfma_f32_16x16x32_bf16 v[60:63], a[0:3], v[56:59], v[60:63]
    v_mfma_f32_16x16x32_bf16 v[68:71], v[56:59], v[56:59], v[68:71]
    v_mfma_f32_16x16x32_bf16 v[64:67], a[0:3], v[104:107], v[64:67]
    v_mfma_f32_16x16x32_bf16 v[72:75], v[104:107], v[104:107], v[72:75]
    v_mfma_f32_16x16x32_bf16 v[60:63], a[0:3], v[108:111], v[60:63]
    v_mfma_f32_16x16x32_bf16 v[68:71], v[108:111], v[108:111], v[68:71]
    v_mfma_f32_16x16x32_bf16 v[64:67], a[0:3], v[112:115], v[64:67]
    v_mfma_f32_16x16x32_bf16 v[72:75], v[112:115], v[112:115], v[72:75]
    v_and_b32 v9, 3, v7
    v_lshrrev_b32 v10, 2, v7
    s_lshl_b32 s38, s36, 8
    s_add_u32 s38, s38, 160768
    v_lshl_add_u32 v8, v7, 3, s38
    v_cmp_eq_u32 vcc, 1, v9
    s_nop 1
    v_cndmask_b32 v68, v68, v69, vcc
    v_cndmask_b32 v72, v72, v73, vcc
    v_cmp_eq_u32 vcc, 2, v9
    s_nop 1
    v_cndmask_b32 v68, v68, v70, vcc
    v_cndmask_b32 v72, v72, v74, vcc
    v_cmp_eq_u32 vcc, 3, v9
    s_nop 1
    v_cndmask_b32 v68, v68, v71, vcc
    v_cndmask_b32 v72, v72, v75, vcc
    v_cmp_eq_u32 vcc, v10, v6
    s_nop 1
    v_cndmask_b32 v68, 0, v68, vcc
    v_mul_f32 v60, 0x3acccccd, v60
    v_cndmask_b32 v72, 0, v72, vcc
    v_mul_f32 v64, 0x3acccccd, v64
    s_nop 0
    v_permlane16_swap_b32 v68, v72
    v_add_f32 v68, v68, v72
    v_mov_b32 v72, v68
    s_nop 1
    v_permlane32_swap_b32 v68, v72
    v_add_f32 v68, v68, v72
    v_mov_b32 v72, v68
    s_nop 1
    v_permlane16_swap_b32 v68, v72
    v_mov_b32 v9, 0x3acccccd
    v_mul_f32 v62, v60, v60
    v_fma_f32 v62, v68, v9, -v62
    v_max_f32 v62, 0, v62
    v_add_f32 v62, 0x3727c5ac, v62
    v_rsq_f32 v62, v62
    s_nop 0
    v_mul_f32 v61, 0x3fb8aa3b, v62
    v_mul_f32 v66, v64, v64
    v_fma_f32 v66, v72, v9, -v66
    v_max_f32 v66, 0, v66
    v_add_f32 v66, 0x3727c5ac, v66
    v_rsq_f32 v66, v66
    s_nop 0
    v_mul_f32 v65, 0x3fb8aa3b, v66
    ds_write_b64 v8, v[60:61]
    ds_write_b64 v8, v[64:65] offset:128
    v_mov_b32 v10, 1
    ds_write_b32 v26, v10
    s_add_u32 s51, s62, 1
    s_cmp_ge_u32 s51, 5
    s_cselect_b32 s52, 5, 0
    s_sub_u32 s51, s51, s52
    s_mul_i32 s51, s51, 491520
    s_add_u32 s51, s51, s77
    s_mul_i32 s52, s36, 3072
    s_add_u32 m0, s52, 139264
    s_nop 0
    buffer_load_dwordx4 v37, s[72:75], s51 offen lds
    buffer_load_dwordx4 v38, s[72:75], s51 offen offset:1024 lds
    buffer_load_dwordx4 v39, s[72:75], s51 offen offset:2048 lds
    ds_read_b32 v12, v27 offset:96
    s_waitcnt lgkmcnt(0)
    v_cmp_gt_u32 vcc, 7, v12
    s_cbranch_vccnz L_cw_100028
L_cn_100029:
    s_add_u32 s51, s62, 2
    s_cmp_ge_u32 s51, 5
    s_cselect_b32 s52, 5, 0
    s_sub_u32 s51, s51, s52
    s_mul_i32 s51, s51, 491520
    s_add_u32 s51, s51, s77
    s_mul_i32 s52, s36, 3072
    s_add_u32 m0, s52, 40960
    s_nop 0
    buffer_load_dwordx4 v37, s[72:75], s51 offen lds
    buffer_load_dwordx4 v38, s[72:75], s51 offen offset:1024 lds
    buffer_load_dwordx4 v39, s[72:75], s51 offen offset:2048 lds
    ds_read_b32 v12, v27 offset:112
    s_waitcnt lgkmcnt(0)
    v_cmp_gt_u32 vcc, 7, v12
    s_cbranch_vccnz L_cw_100031
L_cn_100032:
    s_add_u32 s51, s62, 3
    s_cmp_ge_u32 s51, 5
    s_cselect_b32 s52, 5, 0
    s_sub_u32 s51, s51, s52
    s_mul_i32 s51, s51, 491520
    s_add_u32 s51, s51, s77
    s_mul_i32 s52, s36, 3072
    s_add_u32 m0, s52, 94208
    s_nop 0
    buffer_load_dwordx4 v37, s[72:75], s51 offen lds
    buffer_load_dwordx4 v38, s[72:75], s51 offen offset:1024 lds
    buffer_load_dwordx4 v39, s[72:75], s51 offen offset:2048 lds
    ds_read_b32 v12, v27 offset:112
    s_waitcnt lgkmcnt(0)
    v_cmp_gt_u32 vcc, 8, v12
    s_cbranch_vccnz L_cw_100034
L_cn_100035:
    s_waitcnt vmcnt(9)
    v_mov_b32 v10, 16
    ds_write_b32 v26, v10 offset:80
    ds_read_b32 v12, v27 offset:96
    s_waitcnt lgkmcnt(0)
    v_cmp_gt_u32 vcc, 8, v12
    s_cbranch_vccnz L_cw_100037
L_cn_100038:
    s_add_u32 s51, s62, 4
    s_cmp_ge_u32 s51, 5
    s_cselect_b32 s52, 5, 0
    s_sub_u32 s51, s51, s52
    s_mul_i32 s51, s51, 491520
    s_add_u32 s51, s51, s77
    s_mul_i32 s52, s36, 3072
    s_add_u32 m0, s52, 110592
    s_nop 0
    buffer_load_dwordx4 v37, s[72:75], s51 offen lds
    buffer_load_dwordx4 v38, s[72:75], s51 offen offset:1024 lds
    buffer_load_dwordx4 v39, s[72:75], s51 offen offset:2048 lds
    s_mul_i32 s38, s36, 3072
    s_add_u32 s38, s38, 126976
    v_add_u32 v25, s38, v23
    v_add_u32 v72, s38, v24
    ds_read_b64_tr_b16 v[74:75], v25
    ds_read_b64_tr_b16 v[76:77], v25 offset:768
    ds_read_b64_tr_b16 v[116:117], v25 offset:40
    ds_read_b64_tr_b16 v[118:119], v25 offset:808
    ds_read_b64_tr_b16 v[120:121], v72
    ds_read_b64_tr_b16 v[122:123], v72 offset:768
    s_mov_b32 s45, 65536
    buffer_load_dwordx4 v[28:31], v3, s[24:27], s45 offen sc1
    buffer_load_dwordx4 v[32:35], v3, s[24:27], s45 offen offset:1024 sc1
    s_waitcnt vmcnt(11)
    v_mov_b32 v10, 17
    ds_write_b32 v26, v10 offset:80
    s_waitcnt lgkmcnt(1)
    v_mfma_f32_16x16x32_bf16 v[60:63], v[74:77], a[0:3], 0
    v_mfma_f32_16x16x32_bf16 v[64:67], v[116:119], a[0:3], 0
    v_mfma_f32_16x16x32_bf16 v[68:71], v[120:123], a[0:3], 0
    s_mul_i32 s38, s36, 3072
    s_add_u32 s38, s38, 139264
    v_add_u32 v25, s38, v23
    v_add_u32 v72, s38, v24
    ds_read_b64_tr_b16 v[36:37], v25
    ds_read_b64_tr_b16 v[38:39], v25 offset:768
    ds_read_b64_tr_b16 v[74:75], v25 offset:40
    ds_read_b64_tr_b16 v[76:77], v25 offset:808
    ds_read_b64_tr_b16 v[116:117], v72
    ds_read_b64_tr_b16 v[118:119], v72 offset:768
    s_waitcnt vmcnt(8)
    v_mov_b32 v10, 18
    ds_write_b32 v26, v10 offset:80
    s_waitcnt lgkmcnt(1)
    v_mfma_f32_16x16x32_bf16 v[60:63], v[36:39], a[0:3], v[60:63]
    v_mfma_f32_16x16x32_bf16 v[64:67], v[74:77], a[0:3], v[64:67]
    v_mfma_f32_16x16x32_bf16 v[68:71], v[116:119], a[0:3], v[68:71]
    s_mul_i32 s38, s36, 3072
    s_add_u32 s38, s38, 40960
    v_add_u32 v25, s38, v23
    v_add_u32 v72, s38, v24
    ds_read_b64_tr_b16 v[36:37], v25
    ds_read_b64_tr_b16 v[38:39], v25 offset:768
    ds_read_b64_tr_b16 v[74:75], v25 offset:40
    ds_read_b64_tr_b16 v[76:77], v25 offset:808
    ds_read_b64_tr_b16 v[116:117], v72
    ds_read_b64_tr_b16 v[118:119], v72 offset:768
    s_waitcnt vmcnt(5)
    v_mov_b32 v10, 19
    ds_write_b32 v26, v10 offset:80
    s_waitcnt lgkmcnt(1)
    v_mfma_f32_16x16x32_bf16 v[60:63], v[36:39], a[0:3], v[60:63]
    v_mfma_f32_16x16x32_bf16 v[64:67], v[74:77], a[0:3], v[64:67]
    v_mfma_f32_16x16x32_bf16 v[68:71], v[116:119], a[0:3], v[68:71]
    s_mul_i32 s38, s36, 3072
    s_add_u32 s38, s38, 94208
    v_add_u32 v25, s38, v23
    v_add_u32 v72, s38, v24
    ds_read_b64_tr_b16 v[36:37], v25
    ds_read_b64_tr_b16 v[38:39], v25 offset:768
    ds_read_b64_tr_b16 v[74:75], v25 offset:40
    ds_read_b64_tr_b16 v[76:77], v25 offset:808
    ds_read_b64_tr_b16 v[116:117], v72
    ds_read_b64_tr_b16 v[118:119], v72 offset:768
    s_waitcnt vmcnt(2)
    v_mov_b32 v10, 20
    ds_write_b32 v26, v10 offset:80
    s_waitcnt lgkmcnt(1)
    v_mfma_f32_16x16x32_bf16 v[60:63], v[36:39], a[0:3], v[60:63]
    v_mfma_f32_16x16x32_bf16 v[64:67], v[74:77], a[0:3], v[64:67]
    v_mfma_f32_16x16x32_bf16 v[68:71], v[116:119], a[0:3], v[68:71]
    s_mul_i32 s38, s36, 3072
    s_add_u32 s38, s38, 110592
    v_add_u32 v25, s38, v23
    v_add_u32 v72, s38, v24
    ds_read_b64_tr_b16 v[36:37], v25
    ds_read_b64_tr_b16 v[38:39], v25 offset:768
    ds_read_b64_tr_b16 v[74:75], v25 offset:40
    ds_read_b64_tr_b16 v[76:77], v25 offset:808
    ds_read_b64_tr_b16 v[116:117], v72
    ds_read_b64_tr_b16 v[118:119], v72 offset:768
    s_waitcnt lgkmcnt(0)
    v_mfma_f32_16x16x32_bf16 v[60:63], v[36:39], a[0:3], v[60:63]
    v_mfma_f32_16x16x32_bf16 v[64:67], v[74:77], a[0:3], v[64:67]
    v_mfma_f32_16x16x32_bf16 v[68:71], v[116:119], a[0:3], v[68:71]
    s_mul_i32 s38, s36, 512
    s_add_u32 s38, s38, 162112
    v_lshl_add_u32 v8, v6, 4, s38
    s_nop 2
    ds_write_b128 v8, v[60:63]
    ds_write_b128 v8, v[64:67] offset:64
    ds_write_b128 v8, v[68:71] offset:128
    v_mov_b32 v10, 2
    ds_write_b32 v26, v10 offset:160
    s_mov_b64 exec, -1
    s_mov_b32 s48, 200000
    s_mov_b32 s45, 65536
    s_waitcnt vmcnt(0)
    s_branch L_pc_100042
L_pt_100040:
    buffer_load_dwordx4 v[28:31], v3, s[24:27], s45 offen sc1
    s_waitcnt vmcnt(0)
L_pc_100042:
    v_cmp_ne_u64_e64 vcc, s[32:33], v[28:29]
    v_cmp_ne_u64_e64 s[46:47], s[32:33], v[30:31]
    s_nop 0
    s_or_b64 vcc, vcc, s[46:47]
    s_cbranch_vccz L_pn_100041
    s_mov_b64 exec, vcc
    s_sleep 8
    s_sub_u32 s48, s48, 1
    s_cmp_lg_u32 s48, 0
    s_cbranch_scc1 L_pt_100040
L_pn_100041:
    s_mov_b64 exec, -1
    v_add_u32 v8, 1024, v3
    s_mov_b64 exec, -1
    s_mov_b32 s48, 200000
    s_mov_b32 s45, 65536
    s_branch L_pc_100045
L_pt_100043:
    buffer_load_dwordx4 v[32:35], v8, s[24:27], s45 offen sc1
    s_waitcnt vmcnt(0)
L_pc_100045:
    v_cmp_ne_u64_e64 vcc, s[32:33], v[32:33]
    v_cmp_ne_u64_e64 s[46:47], s[32:33], v[34:35]
    s_nop 0
    s_or_b64 vcc, vcc, s[46:47]
    s_cbranch_vccz L_pn_100044
    s_mov_b64 exec, vcc
    s_sleep 8
    s_sub_u32 s48, s48, 1
    s_cmp_lg_u32 s48, 0
    s_cbranch_scc1 L_pt_100043
L_pn_100044:
    s_mov_b64 exec, -1
    v_mov_b32 v10, 1
    ds_write_b32 v26, v10 offset:1008
    ds_read_b32 v12, v27 offset:96
    s_waitcnt lgkmcnt(0)
    v_cmp_gt_u32 vcc, 11, v12
    s_cbranch_vccnz L_cw_100046
L_cn_100047:
    ds_read_b32 v12, v27 offset:112
    s_waitcnt lgkmcnt(0)
    v_cmp_gt_u32 vcc, 10, v12
    s_cbranch_vccnz L_cw_100049
L_cn_100050:
    s_add_u32 s51, s64, 0
    s_add_u32 m0, s53, 53248
    s_nop 0
    buffer_load_dwordx4 v3, s[24:27], s51 offen sc1 lds
    s_add_u32 s51, s64, 4096
    s_add_u32 m0, s53, 57344
    s_nop 0
    buffer_load_dwordx4 v3, s[24:27], s51 offen sc1 lds
    s_add_u32 s51, s64, 8192
    s_add_u32 m0, s53, 61440
    s_nop 0
    buffer_load_dwordx4 v3, s[24:27], s51 offen sc1 lds
    s_add_u32 s51, s64, 12288
    s_add_u32 m0, s53, 65536
    s_nop 0
    buffer_load_dwordx4 v3, s[24:27], s51 offen sc1 lds
    s_add_u32 s51, s64, 16384
    s_add_u32 m0, s53, 69632
    s_nop 0
    buffer_load_dwordx4 v3, s[24:27], s51 offen sc1 lds
    s_add_u32 s51, s64, 20480
    s_add_u32 m0, s53, 73728
    s_nop 0
    buffer_load_dwordx4 v3, s[24:27], s51 offen sc1 lds
    s_add_u32 s51, s64, 24576
    s_add_u32 m0, s53, 77824
    s_nop 0
    buffer_load_dwordx4 v3, s[24:27], s51 offen sc1 lds
    s_add_u32 s51, s64, 28672
    s_add_u32 m0, s53, 81920
    s_nop 0
    buffer_load_dwordx4 v3, s[24:27], s51 offen sc1 lds
    s_add_u32 s51, s64, 32768
    s_add_u32 m0, s53, 86016
    s_nop 0
    buffer_load_dwordx4 v3, s[24:27], s51 offen sc1 lds
    s_add_u32 s51, s64, 36864
    s_add_u32 m0, s53, 90112
    s_nop 0
    buffer_load_dwordx4 v3, s[24:27], s51 offen sc1 lds
    s_add_u32 s51, s64, 40960
    s_add_u32 m0, s53, 106496
    s_nop 0
    buffer_load_dwordx4 v3, s[24:27], s51 offen sc1 lds
    s_add_u32 s51, s64, 45056
    s_add_u32 m0, s53, 122880
    s_nop 0
    buffer_load_dwordx4 v3, s[24:27], s51 offen sc1 lds
    ds_read_b32 v12, v27 offset:80
    s_waitcnt lgkmcnt(0)
    v_cmp_gt_u32 vcc, 20, v12
    s_cbranch_vccnz L_cw_100052
L_cn_100053:
    ds_read_b64_tr_b16 v[28:29], v78 offset:32768
    ds_read_b64_tr_b16 v[30:31], v78 offset:33536
    ds_read_b64_tr_b16 v[32:33], v78 offset:32808
    ds_read_b64_tr_b16 v[34:35], v78 offset:33576
    ds_read_b64_tr_b16 v[36:37], v79 offset:32768
    ds_read_b64_tr_b16 v[38:39], v79 offset:33536
    ds_read_b64_tr_b16 v[60:61], v78 offset:35840
    ds_read_b64_tr_b16 v[62:63], v78 offset:36608
    ds_read_b64_tr_b16 v[64:65], v78 offset:35880
    ds_read_b64_tr_b16 v[66:67], v78 offset:36648
    ds_read_b64_tr_b16 v[68:69], v79 offset:35840
    ds_read_b64_tr_b16 v[70:71], v79 offset:36608
    ds_read_b32 v12, v26 offset:32
    s_waitcnt lgkmcnt(0)
    v_cmp_gt_u32 vcc, 1, v12
    s_cbranch_vccnz L_cw_100055
L_cn_100056:
    v_mfma_f32_16x16x32_bf16 v[124:127], v[28:31], a[4:7], 0
    v_mfma_f32_16x16x32_bf16 v[136:139], v[28:31], a[8:11], 0
    ds_read_b64_tr_b16 v[72:73], v78 offset:38912
    ds_read_b64_tr_b16 v[74:75], v78 offset:39680
    v_mfma_f32_16x16x32_bf16 v[128:131], v[32:35], a[4:7], 0
    v_mfma_f32_16x16x32_bf16 v[140:143], v[32:35], a[8:11], 0
    ds_read_b64_tr_b16 v[116:117], v78 offset:38952
    ds_read_b64_tr_b16 v[118:119], v78 offset:39720
    v_mfma_f32_16x16x32_bf16 v[132:135], v[36:39], a[4:7], 0
    v_mfma_f32_16x16x32_bf16 v[144:147], v[36:39], a[8:11], 0
    ds_read_b64_tr_b16 v[120:121], v79 offset:38912
    ds_read_b64_tr_b16 v[122:123], v79 offset:39680
    v_mfma_f32_16x16x32_bf16 v[124:127], v[60:63], a[12:15], v[124:127]
    v_mfma_f32_16x16x32_bf16 v[136:139], v[60:63], a[16:19], v[136:139]
    ds_read_b64_tr_b16 v[28:29], v78 offset:41984
    ds_read_b64_tr_b16 v[30:31], v78 offset:42752
    v_mfma_f32_16x16x32_bf16 v[128:131], v[64:67], a[12:15], v[128:131]
    v_mfma_f32_16x16x32_bf16 v[140:143], v[64:67], a[16:19], v[140:143]
    ds_read_b64_tr_b16 v[32:33], v78 offset:42024
    ds_read_b64_tr_b16 v[34:35], v78 offset:42792
    v_mfma_f32_16x16x32_bf16 v[132:135], v[68:71], a[12:15], v[132:135]
    v_mfma_f32_16x16x32_bf16 v[144:147], v[68:71], a[16:19], v[144:147]
    ds_read_b64_tr_b16 v[36:37], v79 offset:41984
    ds_read_b64_tr_b16 v[38:39], v79 offset:42752
    s_waitcnt lgkmcnt(6)
    v_mfma_f32_16x16x32_bf16 v[124:127], v[72:75], a[20:23], v[124:127]
    v_mfma_f32_16x16x32_bf16 v[136:139], v[72:75], a[24:27], v[136:139]
    ds_read_b64_tr_b16 v[60:61], v78 offset:45056
    ds_read_b64_tr_b16 v[62:63], v78 offset:45824
    v_mfma_f32_16x16x32_bf16 v[128:131], v[116:119], a[20:23], v[128:131]
    v_mfma_f32_16x16x32_bf16 v[140:143], v[116:119], a[24:27], v[140:143]
    ds_read_b64_tr_b16 v[64:65], v78 offset:45096
    ds_read_b64_tr_b16 v[66:67], v78 offset:45864
    v_mfma_f32_16x16x32_bf16 v[132:135], v[120:123], a[20:23], v[132:135]
    v_mfma_f32_16x16x32_bf16 v[144:147], v[120:123], a[24:27], v[144:147]
    ds_read_b64_tr_b16 v[68:69], v79 offset:45056
    ds_read_b64_tr_b16 v[70:71], v79 offset:45824
    s_waitcnt lgkmcnt(6)
    v_mfma_f32_16x16x32_bf16 v[124:127], v[28:31], a[28:31], v[124:127]
    v_mfma_f32_16x16x32_bf16 v[136:139], v[28:31], a[32:35], v[136:139]
    ds_read_b64_tr_b16 v[72:73], v78 offset:48128
    ds_read_b64_tr_b16 v[74:75], v78 offset:48896
    v_mfma_f32_16x16x32_bf16 v[128:131], v[32:35], a[28:31], v[128:131]
    v_mfma_f32_16x16x32_bf16 v[140:143], v[32:35], a[32:35], v[140:143]
    ds_read_b64_tr_b16 v[116:117], v78 offset:48168
    ds_read_b64_tr_b16 v[118:119], v78 offset:48936
    v_mfma_f32_16x16x32_bf16 v[132:135], v[36:39], a[28:31], v[132:135]
    v_mfma_f32_16x16x32_bf16 v[144:147], v[36:39], a[32:35], v[144:147]
    ds_read_b64_tr_b16 v[120:121], v79 offset:48128
    ds_read_b64_tr_b16 v[122:123], v79 offset:48896
    s_waitcnt lgkmcnt(6)
    v_mfma_f32_16x16x32_bf16 v[124:127], v[60:63], a[36:39], v[124:127]
    v_mfma_f32_16x16x32_bf16 v[136:139], v[60:63], a[40:43], v[136:139]
    ds_read_b64_tr_b16 v[28:29], v78 offset:51200
    ds_read_b64_tr_b16 v[30:31], v78 offset:51968
    v_mfma_f32_16x16x32_bf16 v[128:131], v[64:67], a[36:39], v[128:131]
    v_mfma_f32_16x16x32_bf16 v[140:143], v[64:67], a[40:43], v[140:143]
    ds_read_b64_tr_b16 v[32:33], v78 offset:51240
    ds_read_b64_tr_b16 v[34:35], v78 offset:52008
    v_mfma_f32_16x16x32_bf16 v[132:135], v[68:71], a[36:39], v[132:135]
    v_mfma_f32_16x16x32_bf16 v[144:147], v[68:71], a[40:43], v[144:147]
    ds_read_b64_tr_b16 v[36:37], v79 offset:51200
    ds_read_b64_tr_b16 v[38:39], v79 offset:51968
    s_waitcnt lgkmcnt(6)
    v_mfma_f32_16x16x32_bf16 v[124:127], v[72:75], a[44:47], v[124:127]
    v_mfma_f32_16x16x32_bf16 v[136:139], v[72:75], a[48:51], v[136:139]
    ds_read_b64_tr_b16 v[60:61], v78 offset:54272
    ds_read_b64_tr_b16 v[62:63], v78 offset:55040
    v_mfma_f32_16x16x32_bf16 v[128:131], v[116:119], a[44:47], v[128:131]
    v_mfma_f32_16x16x32_bf16 v[140:143], v[116:119], a[48:51], v[140:143]
    ds_read_b64_tr_b16 v[64:65], v78 offset:54312
    ds_read_b64_tr_b16 v[66:67], v78 offset:55080
    v_mfma_f32_16x16x32_bf16 v[132:135], v[120:123], a[44:47], v[132:135]
    v_mfma_f32_16x16x32_bf16 v[144:147], v[120:123], a[48:51], v[144:147]
    ds_read_b64_tr_b16 v[68:69], v79 offset:54272
    ds_read_b64_tr_b16 v[70:71], v79 offset:55040
    s_waitcnt lgkmcnt(6)
    v_mfma_f32_16x16x32_bf16 v[124:127], v[28:31], a[52:55], v[124:127]
    v_mfma_f32_16x16x32_bf16 v[136:139], v[28:31], a[56:59], v[136:139]
    ds_read_b64_tr_b16 v[72:73], v23 offset:40960
    ds_read_b64_tr_b16 v[74:75], v23 offset:41728
    v_mfma_f32_16x16x32_bf16 v[128:131], v[32:35], a[52:55], v[128:131]
    v_mfma_f32_16x16x32_bf16 v[140:143], v[32:35], a[56:59], v[140:143]
    ds_read_b64_tr_b16 v[116:117], v23 offset:41000
    ds_read_b64_tr_b16 v[118:119], v23 offset:41768
    v_mfma_f32_16x16x32_bf16 v[132:135], v[36:39], a[52:55], v[132:135]
    v_mfma_f32_16x16x32_bf16 v[144:147], v[36:39], a[56:59], v[144:147]
    ds_read_b64_tr_b16 v[120:121], v24 offset:40960
    ds_read_b64_tr_b16 v[122:123], v24 offset:41728
    s_waitcnt lgkmcnt(6)
    v_mfma_f32_16x16x32_bf16 v[124:127], v[60:63], a[60:63], v[124:127]
    v_mfma_f32_16x16x32_bf16 v[136:139], v[60:63], a[64:67], v[136:139]
    ds_read_b64_tr_b16 v[28:29], v23 offset:44032
    ds_read_b64_tr_b16 v[30:31], v23 offset:44800
    v_mfma_f32_16x16x32_bf16 v[128:131], v[64:67], a[60:63], v[128:131]
    v_mfma_f32_16x16x32_bf16 v[140:143], v[64:67], a[64:67], v[140:143]
    ds_read_b64_tr_b16 v[32:33], v23 offset:44072
    ds_read_b64_tr_b16 v[34:35], v23 offset:44840
    v_mfma_f32_16x16x32_bf16 v[132:135], v[68:71], a[60:63], v[132:135]
    v_mfma_f32_16x16x32_bf16 v[144:147], v[68:71], a[64:67], v[144:147]
    ds_read_b64_tr_b16 v[36:37], v24 offset:44032
    ds_read_b64_tr_b16 v[38:39], v24 offset:44800
    s_waitcnt lgkmcnt(6)
    v_mfma_f32_16x16x32_bf16 v[124:127], v[72:75], a[68:71], v[124:127]
    v_mfma_f32_16x16x32_bf16 v[136:139], v[72:75], a[72:75], v[136:139]
    ds_read_b64_tr_b16 v[60:61], v23 offset:47104
    ds_read_b64_tr_b16 v[62:63], v23 offset:47872
    v_mfma_f32_16x16x32_bf16 v[128:131], v[116:119], a[68:71], v[128:131]
    v_mfma_f32_16x16x32_bf16 v[140:143], v[116:119], a[72:75], v[140:143]
    ds_read_b64_tr_b16 v[64:65], v23 offset:47144
    ds_read_b64_tr_b16 v[66:67], v23 offset:47912
    v_mfma_f32_16x16x32_bf16 v[132:135], v[120:123], a[68:71], v[132:135]
    v_mfma_f32_16x16x32_bf16 v[144:147], v[120:123], a[72:75], v[144:147]
    ds_read_b64_tr_b16 v[68:69], v24 offset:47104
    ds_read_b64_tr_b16 v[70:71], v24 offset:47872
    s_waitcnt lgkmcnt(6)
    v_mfma_f32_16x16x32_bf16 v[124:127], v[28:31], a[76:79], v[124:127]
    v_mfma_f32_16x16x32_bf16 v[136:139], v[28:31], a[80:83], v[136:139]
    ds_read_b64_tr_b16 v[72:73], v23 offset:50176
    ds_read_b64_tr_b16 v[74:75], v23 offset:50944
    v_mfma_f32_16x16x32_bf16 v[128:131], v[32:35], a[76:79], v[128:131]
    v_mfma_f32_16x16x32_bf16 v[140:143], v[32:35], a[80:83], v[140:143]
    ds_read_b64_tr_b16 v[116:117], v23 offset:50216
    ds_read_b64_tr_b16 v[118:119], v23 offset:50984
    v_mfma_f32_16x16x32_bf16 v[132:135], v[36:39], a[76:79], v[132:135]
    v_mfma_f32_16x16x32_bf16 v[144:147], v[36:39], a[80:83], v[144:147]
    ds_read_b64_tr_b16 v[120:121], v24 offset:50176
    ds_read_b64_tr_b16 v[122:123], v24 offset:50944
    s_waitcnt lgkmcnt(6)
    v_mfma_f32_16x16x32_bf16 v[124:127], v[60:63], a[84:87], v[124:127]
    v_mfma_f32_16x16x32_bf16 v[136:139], v[60:63], a[88:91], v[136:139]
    ds_read_b64_tr_b16 v[28:29], v78
    ds_read_b64_tr_b16 v[30:31], v78 offset:768
    v_mfma_f32_16x16x32_bf16 v[128:131], v[64:67], a[84:87], v[128:131]
    v_mfma_f32_16x16x32_bf16 v[140:143], v[64:67], a[88:91], v[140:143]
    ds_read_b64_tr_b16 v[32:33], v78 offset:40
    ds_read_b64_tr_b16 v[34:35], v78 offset:808
    v_mfma_f32_16x16x32_bf16 v[132:135], v[68:71], a[84:87], v[132:135]
    v_mfma_f32_16x16x32_bf16 v[144:147], v[68:71], a[88:91], v[144:147]
    ds_read_b64_tr_b16 v[36:37], v79
    ds_read_b64_tr_b16 v[38:39], v79 offset:768
    s_waitcnt lgkmcnt(6)
    v_mfma_f32_16x16x32_bf16 v[124:127], v[72:75], a[92:95], v[124:127]
    v_mfma_f32_16x16x32_bf16 v[136:139], v[72:75], a[96:99], v[136:139]
    ds_read_b64_tr_b16 v[60:61], v78 offset:3072
    ds_read_b64_tr_b16 v[62:63], v78 offset:3840
    v_mfma_f32_16x16x32_bf16 v[128:131], v[116:119], a[92:95], v[128:131]
    v_mfma_f32_16x16x32_bf16 v[140:143], v[116:119], a[96:99], v[140:143]
    ds_read_b64_tr_b16 v[64:65], v78 offset:3112
    ds_read_b64_tr_b16 v[66:67], v78 offset:3880
    v_mfma_f32_16x16x32_bf16 v[132:135], v[120:123], a[92:95], v[132:135]
    v_mfma_f32_16x16x32_bf16 v[144:147], v[120:123], a[96:99], v[144:147]
    ds_read_b64_tr_b16 v[68:69], v79 offset:3072
    ds_read_b64_tr_b16 v[70:71], v79 offset:3840
    s_waitcnt lgkmcnt(6)
    v_mfma_f32_16x16x32_bf16 v[124:127], v[28:31], a[100:103], v[124:127]
    v_mfma_f32_16x16x32_bf16 v[136:139], v[28:31], a[104:107], v[136:139]
    ds_read_b64_tr_b16 v[72:73], v78 offset:6144
    ds_read_b64_tr_b16 v[74:75], v78 offset:6912
    v_mfma_f32_16x16x32_bf16 v[128:131], v[32:35], a[100:103], v[128:131]
    v_mfma_f32_16x16x32_bf16 v[140:143], v[32:35], a[104:107], v[140:143]
    ds_read_b64_tr_b16 v[116:117], v78 offset:6184
    ds_read_b64_tr_b16 v[118:119], v78 offset:6952
    v_mfma_f32_16x16x32_bf16 v[132:135], v[36:39], a[100:103], v[132:135]
    v_mfma_f32_16x16x32_bf16 v[144:147], v[36:39], a[104:107], v[144:147]
    ds_read_b64_tr_b16 v[120:121], v79 offset:6144
    ds_read_b64_tr_b16 v[122:123], v79 offset:6912
    s_waitcnt lgkmcnt(6)
    v_mfma_f32_16x16x32_bf16 v[124:127], v[60:63], v[80:83], v[124:127]
    v_mfma_f32_16x16x32_bf16 v[136:139], v[60:63], v[84:87], v[136:139]
    ds_read_b64_tr_b16 v[28:29], v78 offset:9216
    ds_read_b64_tr_b16 v[30:31], v78 offset:9984
    v_mfma_f32_16x16x32_bf16 v[128:131], v[64:67], v[80:83], v[128:131]
    v_mfma_f32_16x16x32_bf16 v[140:143], v[64:67], v[84:87], v[140:143]
    ds_read_b64_tr_b16 v[32:33], v78 offset:9256
    ds_read_b64_tr_b16 v[34:35], v78 offset:10024
    v_mfma_f32_16x16x32_bf16 v[132:135], v[68:71], v[80:83], v[132:135]
    v_mfma_f32_16x16x32_bf16 v[144:147], v[68:71], v[84:87], v[144:147]
    ds_read_b64_tr_b16 v[36:37], v79 offset:9216
    ds_read_b64_tr_b16 v[38:39], v79 offset:9984
    s_waitcnt lgkmcnt(6)
    v_mfma_f32_16x16x32_bf16 v[124:127], v[72:75], v[88:91], v[124:127]
    v_mfma_f32_16x16x32_bf16 v[136:139], v[72:75], v[92:95], v[136:139]
    ds_read_b64_tr_b16 v[60:61], v78 offset:16384
    ds_read_b64_tr_b16 v[62:63], v78 offset:17152
    v_mfma_f32_16x16x32_bf16 v[128:131], v[116:119], v[88:91], v[128:131]
    v_mfma_f32_16x16x32_bf16 v[140:143], v[116:119], v[92:95], v[140:143]
    ds_read_b64_tr_b16 v[64:65], v78 offset:16424
    ds_read_b64_tr_b16 v[66:67], v78 offset:17192
    v_mfma_f32_16x16x32_bf16 v[132:135], v[120:123], v[88:91], v[132:135]
    v_mfma_f32_16x16x32_bf16 v[144:147], v[120:123], v[92:95], v[144:147]
    ds_read_b64_tr_b16 v[68:69], v79 offset:16384
    ds_read_b64_tr_b16 v[70:71], v79 offset:17152
    s_waitcnt lgkmcnt(6)
    v_mfma_f32_16x16x32_bf16 v[124:127], v[28:31], v[96:99], v[124:127]
    v_mfma_f32_16x16x32_bf16 v[136:139], v[28:31], v[100:103], v[136:139]
    ds_read_b64_tr_b16 v[72:73], v78 offset:19456
    ds_read_b64_tr_b16 v[74:75], v78 offset:20224
    v_mfma_f32_16x16x32_bf16 v[128:131], v[32:35], v[96:99], v[128:131]
    v_mfma_f32_16x16x32_bf16 v[140:143], v[32:35], v[100:103], v[140:143]
    ds_read_b64_tr_b16 v[116:117], v78 offset:19496
    ds_read_b64_tr_b16 v[118:119], v78 offset:20264
    v_mfma_f32_16x16x32_bf16 v[132:135], v[36:39], v[96:99], v[132:135]
    v_mfma_f32_16x16x32_bf16 v[144:147], v[36:39], v[100:103], v[144:147]
    ds_read_b64_tr_b16 v[120:121], v79 offset:19456
    ds_read_b64_tr_b16 v[122:123], v79 offset:20224
    s_waitcnt lgkmcnt(6)
    v_mfma_f32_16x16x32_bf16 v[124:127], v[60:63], v[40:43], v[124:127]
    v_mfma_f32_16x16x32_bf16 v[136:139], v[60:63], v[44:47], v[136:139]
    ds_read_b64_tr_b16 v[28:29], v78 offset:22528
    ds_read_b64_tr_b16 v[30:31], v78 offset:23296
    v_mfma_f32_16x16x32_bf16 v[128:131], v[64:67], v[40:43], v[128:131]
    v_mfma_f32_16x16x32_bf16 v[140:143], v[64:67], v[44:47], v[140:143]
    ds_read_b64_tr_b16 v[32:33], v78 offset:22568
    ds_read_b64_tr_b16 v[34:35], v78 offset:23336
    v_mfma_f32_16x16x32_bf16 v[132:135], v[68:71], v[40:43], v[132:135]
    v_mfma_f32_16x16x32_bf16 v[144:147], v[68:71], v[44:47], v[144:147]
    ds_read_b64_tr_b16 v[36:37], v79 offset:22528
    ds_read_b64_tr_b16 v[38:39], v79 offset:23296
    s_waitcnt lgkmcnt(6)
    v_mfma_f32_16x16x32_bf16 v[124:127], v[72:75], v[48:51], v[124:127]
    v_mfma_f32_16x16x32_bf16 v[136:139], v[72:75], v[52:55], v[136:139]
    ds_read_b64_tr_b16 v[60:61], v78 offset:25600
    ds_read_b64_tr_b16 v[62:63], v78 offset:26368
    v_mfma_f32_16x16x32_bf16 v[128:131], v[116:119], v[48:51], v[128:131]
    v_mfma_f32_16x16x32_bf16 v[140:143], v[116:119], v[52:55], v[140:143]
    ds_read_b64_tr_b16 v[64:65], v78 offset:25640
    ds_read_b64_tr_b16 v[66:67], v78 offset:26408
    v_mfma_f32_16x16x32_bf16 v[132:135], v[120:123], v[48:51], v[132:135]
    v_mfma_f32_16x16x32_bf16 v[144:147], v[120:123], v[52:55], v[144:147]
    ds_read_b64_tr_b16 v[68:69], v79 offset:25600
    ds_read_b64_tr_b16 v[70:71], v79 offset:26368
    s_waitcnt lgkmcnt(6)
    v_mfma_f32_16x16x32_bf16 v[124:127], v[28:31], v[56:59], v[124:127]
    v_mfma_f32_16x16x32_bf16 v[136:139], v[28:31], v[104:107], v[136:139]
    v_mfma_f32_16x16x32_bf16 v[128:131], v[32:35], v[56:59], v[128:131]
    v_mfma_f32_16x16x32_bf16 v[140:143], v[32:35], v[104:107], v[140:143]
    v_mfma_f32_16x16x32_bf16 v[132:135], v[36:39], v[56:59], v[132:135]
    v_mfma_f32_16x16x32_bf16 v[144:147], v[36:39], v[104:107], v[144:147]
    s_waitcnt lgkmcnt(0)
    v_mfma_f32_16x16x32_bf16 v[124:127], v[60:63], v[108:111], v[124:127]
    v_mfma_f32_16x16x32_bf16 v[136:139], v[60:63], v[112:115], v[136:139]
    v_mfma_f32_16x16x32_bf16 v[128:131], v[64:67], v[108:111], v[128:131]
    v_mfma_f32_16x16x32_bf16 v[140:143], v[64:67], v[112:115], v[140:143]
    v_mfma_f32_16x16x32_bf16 v[132:135], v[68:71], v[108:111], v[132:135]
    v_mfma_f32_16x16x32_bf16 v[144:147], v[68:71], v[112:115], v[144:147]
    ds_read_b32 v12, v27 offset:176
    s_waitcnt lgkmcnt(0)
    v_cmp_gt_u32 vcc, 3, v12
    s_cbranch_vccnz L_cw_100058
L_cn_100059:
    v_add_u32 v8, 151552, v3
    ds_read_b128 a[4:7], v8
    ds_read_b128 a[8:11], v8 offset:1024
    ds_read_b128 a[12:15], v8 offset:2048
    ds_read_b128 a[16:19], v8 offset:3072
    s_lshl_b32 s38, s36, 8
    s_add_u32 s38, s38, 160768
    v_lshl_add_u32 v8, v7, 3, s38
    ds_read_b64 v[22:23], v8
    ds_read_b64 v[24:25], v8 offset:128
    ds_read_b32 v12, v27 offset:160
    s_waitcnt lgkmcnt(0)
    v_cmp_gt_u32 vcc, 2, v12
    s_cbranch_vccnz L_cw_100061
L_cn_100062:
    v_lshlrev_b32 v8, 4, v6
    v_add_u32 v8, 162112, v8
    ds_read_b128 v[28:31], v8
    ds_read_b128 v[32:35], v8 offset:64
    ds_read_b128 v[36:39], v8 offset:128
    ds_read_b128 v[40:43], v8 offset:512
    ds_read_b128 v[44:47], v8 offset:576
    ds_read_b128 v[48:51], v8 offset:640
    ds_read_b128 v[52:55], v8 offset:1024
    ds_read_b128 v[56:59], v8 offset:1088
    ds_read_b128 v[60:63], v8 offset:1152
    ds_read_b128 v[64:67], v8 offset:1536
    ds_read_b128 v[68:71], v8 offset:1600
    ds_read_b128 v[72:75], v8 offset:1664
    v_mov_b32 v10, 1
    ds_write_b32 v26, v10 offset:48
    s_waitcnt lgkmcnt(0)
    v_pk_add_f32 v[28:29], v[28:29], v[40:41]
    v_pk_add_f32 v[52:53], v[52:53], v[64:65]
    v_pk_add_f32 v[30:31], v[30:31], v[42:43]
    v_pk_add_f32 v[54:55], v[54:55], v[66:67]
    v_pk_add_f32 v[32:33], v[32:33], v[44:45]
    v_pk_add_f32 v[56:57], v[56:57], v[68:69]
    v_pk_add_f32 v[34:35], v[34:35], v[46:47]
    v_pk_add_f32 v[58:59], v[58:59], v[70:71]
    v_pk_add_f32 v[36:37], v[36:37], v[48:49]
    v_pk_add_f32 v[60:61], v[60:61], v[72:73]
    v_pk_add_f32 v[38:39], v[38:39], v[50:51]
    v_pk_add_f32 v[62:63], v[62:63], v[74:75]
    v_pk_add_f32 v[28:29], v[28:29], v[52:53]
    v_pk_add_f32 v[30:31], v[30:31], v[54:55]
    v_pk_add_f32 v[32:33], v[32:33], v[56:57]
    v_pk_add_f32 v[34:35], v[34:35], v[58:59]
    v_pk_add_f32 v[36:37], v[36:37], v[60:61]
    v_pk_add_f32 v[38:39], v[38:39], v[62:63]
    v_pk_fma_f32 v[132:133], v[22:23], v[36:37], v[132:133] op_sel_hi:[0,1,1] neg_lo:[1,0,0] neg_hi:[1,0,0]
    v_pk_fma_f32 v[134:135], v[22:23], v[38:39], v[134:135] op_sel_hi:[0,1,1] neg_lo:[1,0,0] neg_hi:[1,0,0]
    v_pk_fma_f32 v[124:125], v[22:23], v[28:29], v[124:125] op_sel_hi:[0,1,1] neg_lo:[1,0,0] neg_hi:[1,0,0]
    v_pk_fma_f32 v[126:127], v[22:23], v[30:31], v[126:127] op_sel_hi:[0,1,1] neg_lo:[1,0,0] neg_hi:[1,0,0]
    v_pk_fma_f32 v[128:129], v[22:23], v[32:33], v[128:129] op_sel_hi:[0,1,1] neg_lo:[1,0,0] neg_hi:[1,0,0]
    v_pk_fma_f32 v[130:131], v[22:23], v[34:35], v[130:131] op_sel_hi:[0,1,1] neg_lo:[1,0,0] neg_hi:[1,0,0]
    v_cvt_pk_bf16_f32 v76, v124, v125
    v_cvt_pk_bf16_f32 v77, v126, v127
    v_cvt_pk_bf16_f32 v78, v132, v133
    v_cvt_pk_bf16_f32 v79, v134, v135
    v_cvt_pk_bf16_f32 v80, v128, v129
    v_cvt_pk_bf16_f32 v81, v130, v131
    v_cvt_pk_bf16_f32 v82, v132, v133
    v_cvt_pk_bf16_f32 v83, v134, v135
    v_pk_fma_f32 v[144:145], v[24:25], v[36:37], v[144:145] op_sel_hi:[0,1,1] neg_lo:[1,0,0] neg_hi:[1,0,0]
    v_pk_fma_f32 v[146:147], v[24:25], v[38:39], v[146:147] op_sel_hi:[0,1,1] neg_lo:[1,0,0] neg_hi:[1,0,0]
    v_pk_fma_f32 v[136:137], v[24:25], v[28:29], v[136:137] op_sel_hi:[0,1,1] neg_lo:[1,0,0] neg_hi:[1,0,0]
    v_pk_fma_f32 v[138:139], v[24:25], v[30:31], v[138:139] op_sel_hi:[0,1,1] neg_lo:[1,0,0] neg_hi:[1,0,0]
    v_pk_fma_f32 v[140:141], v[24:25], v[32:33], v[140:141] op_sel_hi:[0,1,1] neg_lo:[1,0,0] neg_hi:[1,0,0]
    v_pk_fma_f32 v[142:143], v[24:25], v[34:35], v[142:143] op_sel_hi:[0,1,1] neg_lo:[1,0,0] neg_hi:[1,0,0]
    v_cvt_pk_bf16_f32 v84, v136, v137
    v_cvt_pk_bf16_f32 v85, v138, v139
    v_cvt_pk_bf16_f32 v86, v144, v145
    v_cvt_pk_bf16_f32 v87, v146, v147
    v_cvt_pk_bf16_f32 v88, v140, v141
    v_cvt_pk_bf16_f32 v89, v142, v143
    v_cvt_pk_bf16_f32 v90, v144, v145
    v_cvt_pk_bf16_f32 v91, v146, v147
    v_mfma_f32_16x16x32_bf16 v[28:31], a[4:7], v[76:79], 0
    v_mfma_f32_16x16x32_bf16 v[32:35], a[12:15], v[80:83], 0
    v_mfma_f32_16x16x32_bf16 v[36:39], a[4:7], v[84:87], 0
    v_mfma_f32_16x16x32_bf16 v[40:43], a[12:15], v[88:91], 0
    v_mfma_f32_16x16x32_bf16 v[44:47], a[8:11], v[76:79], 0
    v_mfma_f32_16x16x32_bf16 v[48:51], a[8:11], v[84:87], 0
    v_mfma_f32_16x16x32_bf16 v[44:47], a[16:19], v[80:83], v[44:47]
    v_mfma_f32_16x16x32_bf16 v[48:51], a[16:19], v[88:91], v[48:51]
    s_nop 0
    v_max3_f32 v78, v28, v29, v30
    v_max3_f32 v79, -v28, -v29, -v30
    v_max3_f32 v80, v32, v33, v34
    v_max3_f32 v81, -v32, -v33, -v34
    v_max3_f32 v82, v36, v37, v38
    v_max3_f32 v83, -v36, -v37, -v38
    v_max3_f32 v84, v40, v41, v42
    v_max3_f32 v85, -v40, -v41, -v42
    v_max3_f32 v78, v78, v31, v44
    v_max3_f32 v79, v79, -v31, -v44
    v_max3_f32 v80, v80, v35, v45
    v_max3_f32 v81, v81, -v35, -v45
    v_max3_f32 v82, v82, v39, v48
    v_max3_f32 v83, v83, -v39, -v48
    v_max3_f32 v84, v84, v43, v49
    v_max3_f32 v85, v85, -v43, -v49
    v_permlane16_swap_b32 v78, v79
    v_permlane16_swap_b32 v80, v81
    v_permlane16_swap_b32 v82, v83
    v_permlane16_swap_b32 v84, v85
    v_max_f32 v78, v78, v79
    v_max_f32 v80, v80, v81
    v_max_f32 v82, v82, v83
    v_max_f32 v84, v84, v85
    v_permlane32_swap_b32 v78, v80
    s_nop 0
    v_permlane32_swap_b32 v82, v84
    v_max_f32 v78, v78, v80
    v_max_f32 v82, v82, v84
    v_mul_f32 v78, v23, v78
    v_mul_f32 v82, v25, v82
    v_mov_b32 v80, v78
    v_mov_b32 v84, v82
    s_nop 0
    v_permlane32_swap_b32 v78, v80
    v_permlane32_swap_b32 v82, v84
    v_mov_b32 v79, v78
    v_mov_b32 v81, v80
    v_mov_b32 v83, v82
    v_mov_b32 v85, v84
    v_permlane16_swap_b32 v78, v79
    v_permlane16_swap_b32 v80, v81
    v_permlane16_swap_b32 v82, v83
    v_permlane16_swap_b32 v84, v85
    v_pk_fma_f32 v[86:87], v[28:29], v[22:23], v[78:79] op_sel:[0,1,1] neg_lo:[1,0,1] neg_hi:[1,0,1]
    v_pk_fma_f32 v[88:89], v[30:31], v[22:23], v[78:79] op_sel:[0,1,1] neg_lo:[1,0,1] neg_hi:[1,0,1]
    v_fma_f32 v102, v44, v23, -v78
    v_fma_f32 v103, -v44, v23, -v79
    v_pk_fma_f32 v[28:29], v[28:29], v[22:23], v[78:79] op_sel:[0,1,0] op_sel_hi:[1,1,0] neg_lo:[0,0,1] neg_hi:[0,0,1]
    v_pk_fma_f32 v[30:31], v[30:31], v[22:23], v[78:79] op_sel:[0,1,0] op_sel_hi:[1,1,0] neg_lo:[0,0,1] neg_hi:[0,0,1]
    v_exp_f32 v86, v86
    v_exp_f32 v87, v87
    v_exp_f32 v88, v88
    v_exp_f32 v89, v89
    v_exp_f32 v102, v102
    v_exp_f32 v103, v103
    v_exp_f32 v28, v28
    v_exp_f32 v29, v29
    v_exp_f32 v30, v30
    v_exp_f32 v31, v31
    v_pk_fma_f32 v[90:91], v[32:33], v[22:23], v[80:81] op_sel:[0,1,1] neg_lo:[1,0,1] neg_hi:[1,0,1]
    v_pk_fma_f32 v[92:93], v[34:35], v[22:23], v[80:81] op_sel:[0,1,1] neg_lo:[1,0,1] neg_hi:[1,0,1]
    v_fma_f32 v104, v45, v23, -v80
    v_fma_f32 v105, -v45, v23, -v81
    v_pk_fma_f32 v[32:33], v[32:33], v[22:23], v[80:81] op_sel:[0,1,0] op_sel_hi:[1,1,0] neg_lo:[0,0,1] neg_hi:[0,0,1]
    v_pk_fma_f32 v[34:35], v[34:35], v[22:23], v[80:81] op_sel:[0,1,0] op_sel_hi:[1,1,0] neg_lo:[0,0,1] neg_hi:[0,0,1]
    v_exp_f32 v90, v90
    v_exp_f32 v91, v91
    v_exp_f32 v92, v92
    v_exp_f32 v93, v93
    v_exp_f32 v104, v104
    v_exp_f32 v105, v105
    v_exp_f32 v32, v32
    v_exp_f32 v33, v33
    v_exp_f32 v34, v34
    v_exp_f32 v35, v35
    v_pk_fma_f32 v[94:95], v[36:37], v[24:25], v[82:83] op_sel:[0,1,1] neg_lo:[1,0,1] neg_hi:[1,0,1]
    v_pk_fma_f32 v[96:97], v[38:39], v[24:25], v[82:83] op_sel:[0,1,1] neg_lo:[1,0,1] neg_hi:[1,0,1]
    v_fma_f32 v106, v48, v25, -v82
    v_fma_f32 v107, -v48, v25, -v83
    v_pk_fma_f32 v[36:37], v[36:37], v[24:25], v[82:83] op_sel:[0,1,0] op_sel_hi:[1,1,0] neg_lo:[0,0,1] neg_hi:[0,0,1]
    v_pk_fma_f32 v[38:39], v[38:39], v[24:25], v[82:83] op_sel:[0,1,0] op_sel_hi:[1,1,0] neg_lo:[0,0,1] neg_hi:[0,0,1]
    v_exp_f32 v94, v94
    v_exp_f32 v95, v95
    v_exp_f32 v96, v96
    v_exp_f32 v97, v97
    v_exp_f32 v106, v106
    v_exp_f32 v107, v107
    v_exp_f32 v36, v36
    v_exp_f32 v37, v37
    v_exp_f32 v38, v38
    v_exp_f32 v39, v39
    v_pk_fma_f32 v[98:99], v[40:41], v[24:25], v[84:85] op_sel:[0,1,1] neg_lo:[1,0,1] neg_hi:[1,0,1]
    v_pk_fma_f32 v[100:101], v[42:43], v[24:25], v[84:85] op_sel:[0,1,1] neg_lo:[1,0,1] neg_hi:[1,0,1]
    v_fma_f32 v108, v49, v25, -v84
    v_fma_f32 v109, -v49, v25, -v85
    v_pk_fma_f32 v[40:41], v[40:41], v[24:25], v[84:85] op_sel:[0,1,0] op_sel_hi:[1,1,0] neg_lo:[0,0,1] neg_hi:[0,0,1]
    v_pk_fma_f32 v[42:43], v[42:43], v[24:25], v[84:85] op_sel:[0,1,0] op_sel_hi:[1,1,0] neg_lo:[0,0,1] neg_hi:[0,0,1]
    v_exp_f32 v98, v98
    v_exp_f32 v99, v99
    v_exp_f32 v100, v100
    v_exp_f32 v101, v101
    v_exp_f32 v108, v108
    v_exp_f32 v109, v109
    v_exp_f32 v40, v40
    v_exp_f32 v41, v41
    v_exp_f32 v42, v42
    v_exp_f32 v43, v43
    v_pk_add_f32 v[44:45], v[28:29], v[30:31]
    v_pk_add_f32 v[52:53], v[86:87], v[88:89]
    v_pk_add_f32 v[46:47], v[32:33], v[34:35]
    v_pk_add_f32 v[58:59], v[90:91], v[92:93]
    v_pk_add_f32 v[48:49], v[36:37], v[38:39]
    v_pk_add_f32 v[64:65], v[94:95], v[96:97]
    v_pk_add_f32 v[50:51], v[40:41], v[42:43]
    v_pk_add_f32 v[70:71], v[98:99], v[100:101]
    v_add_f32 v78, v44, v45
    v_add_f32 v79, v52, v53
    v_add_f32 v80, v46, v47
    v_add_f32 v81, v58, v59
    v_add_f32 v82, v48, v49
    v_add_f32 v83, v64, v65
    v_add_f32 v84, v50, v51
    v_add_f32 v85, v70, v71
    v_pk_add_f32 v[78:79], v[78:79], v[102:103]
    v_pk_add_f32 v[80:81], v[80:81], v[104:105]
    v_pk_add_f32 v[82:83], v[82:83], v[106:107]
    v_pk_add_f32 v[84:85], v[84:85], v[108:109]
    v_permlane16_swap_b32 v78, v79
    v_permlane16_swap_b32 v80, v81
    v_permlane16_swap_b32 v82, v83
    v_permlane16_swap_b32 v84, v85
    v_add_f32 v78, v78, v79
    v_add_f32 v80, v80, v81
    v_add_f32 v82, v82, v83
    v_add_f32 v84, v84, v85
    v_permlane32_swap_b32 v78, v80
    s_nop 0
    v_permlane32_swap_b32 v82, v84
    v_add_f32 v78, v78, v80
    v_add_f32 v82, v82, v84
    v_rcp_f32 v78, v78
    v_rcp_f32 v82, v82
    v_mov_b32 v80, v78
    v_mov_b32 v84, v82
    s_nop 0
    v_permlane32_swap_b32 v78, v80
    v_permlane32_swap_b32 v82, v84
    v_mov_b32 v79, v78
    v_mov_b32 v81, v80
    v_mov_b32 v83, v82
    v_mov_b32 v85, v84
    v_permlane16_swap_b32 v78, v79
    v_permlane16_swap_b32 v80, v81
    v_permlane16_swap_b32 v82, v83
    v_permlane16_swap_b32 v84, v85
    v_pk_mul_f32 v[28:29], v[28:29], v[78:79] op_sel_hi:[1,0]
    v_pk_mul_f32 v[86:87], v[86:87], v[78:79] op_sel:[0,1]
    v_pk_mul_f32 v[30:31], v[30:31], v[78:79] op_sel_hi:[1,0]
    v_pk_mul_f32 v[88:89], v[88:89], v[78:79] op_sel:[0,1]
    v_pk_mul_f32 v[102:103], v[102:103], v[78:79]
    v_pk_mul_f32 v[32:33], v[32:33], v[80:81] op_sel_hi:[1,0]
    v_pk_mul_f32 v[90:91], v[90:91], v[80:81] op_sel:[0,1]
    v_pk_mul_f32 v[34:35], v[34:35], v[80:81] op_sel_hi:[1,0]
    v_pk_mul_f32 v[92:93], v[92:93], v[80:81] op_sel:[0,1]
    v_pk_mul_f32 v[104:105], v[104:105], v[80:81]
    v_pk_mul_f32 v[36:37], v[36:37], v[82:83] op_sel_hi:[1,0]
    v_pk_mul_f32 v[94:95], v[94:95], v[82:83] op_sel:[0,1]
    v_pk_mul_f32 v[38:39], v[38:39], v[82:83] op_sel_hi:[1,0]
    v_pk_mul_f32 v[96:97], v[96:97], v[82:83] op_sel:[0,1]
    v_pk_mul_f32 v[106:107], v[106:107], v[82:83]
    v_pk_mul_f32 v[40:41], v[40:41], v[84:85] op_sel_hi:[1,0]
    v_pk_mul_f32 v[98:99], v[98:99], v[84:85] op_sel:[0,1]
    v_pk_mul_f32 v[42:43], v[42:43], v[84:85] op_sel_hi:[1,0]
    v_pk_mul_f32 v[100:101], v[100:101], v[84:85] op_sel:[0,1]
    v_pk_mul_f32 v[108:109], v[108:109], v[84:85]
    v_cvt_pk_bf16_f32 v52, v28, v29
    v_cvt_pk_bf16_f32 v53, v30, v31
    v_cvt_pk_bf16_f32 v54, v86, v87
    v_cvt_pk_bf16_f32 v55, v88, v89
    v_cvt_pk_bf16_f32 v56, v102, v103
    v_mov_b32 v57, 0
    v_cvt_pk_bf16_f32 v58, v32, v33
    v_cvt_pk_bf16_f32 v59, v34, v35
    v_cvt_pk_bf16_f32 v60, v90, v91
    v_cvt_pk_bf16_f32 v61, v92, v93
    v_cvt_pk_bf16_f32 v62, v104, v105
    v_mov_b32 v63, 0
    v_cvt_pk_bf16_f32 v64, v36, v37
    v_cvt_pk_bf16_f32 v65, v38, v39
    v_cvt_pk_bf16_f32 v66, v94, v95
    v_cvt_pk_bf16_f32 v67, v96, v97
    v_cvt_pk_bf16_f32 v68, v106, v107
    v_mov_b32 v69, 0
    v_cvt_pk_bf16_f32 v70, v40, v41
    v_cvt_pk_bf16_f32 v71, v42, v43
    v_cvt_pk_bf16_f32 v72, v98, v99
    v_cvt_pk_bf16_f32 v73, v100, v101
    v_cvt_pk_bf16_f32 v74, v108, v109
    v_mov_b32 v75, 0
    v_mov_b32 v76, 0
    v_mov_b32 v77, 0
    v_mov_b32 v37, 0
    v_mov_b32 v38, 0
    v_mov_b32 v39, 0
    v_mov_b32 v41, 0
    v_mov_b32 v42, 0
    v_mov_b32 v43, 0
    v_mov_b32 v45, 0
    v_mov_b32 v46, 0
    v_mov_b32 v47, 0
    ds_read_b32 v12, v26 offset:192
    s_waitcnt lgkmcnt(0)
    v_cmp_gt_u32 vcc, 1, v12
    s_cbranch_vccnz L_cw_100064
L_cn_100065:
    v_readfirstlane_b32 s49, v12
    s_nop 0
    s_sub_u32 s49, s49, 1
    s_lshl_b32 s38, s69, 7
    v_lshl_add_u32 v20, v7, 11, s38
    v_lshl_add_u32 v20, v6, 5, v20
    s_mov_b64 exec, 0xffff
    s_mov_b32 s48, 200000
    s_mov_b32 s45, 98304
L_pt_100067:
    buffer_load_dwordx2 v[12:13], v20, s[24:27], s45 offen sc1
    s_waitcnt vmcnt(0)
L_pc_100069:
    v_cmp_ne_u64_e64 vcc, s[32:33], v[12:13]
    s_cbranch_vccz L_pn_100068
    s_mov_b64 exec, vcc
    s_sleep 2
    s_sub_u32 s48, s48, 1
    s_cmp_lg_u32 s48, 0
    s_cbranch_scc1 L_pt_100067
L_pn_100068:
    s_mov_b64 exec, -1
    s_lshl_b32 s38, s36, 11
    s_add_u32 s61, s61, s38
    buffer_load_dword v78, v4, s[24:27], s61 offen sc1
    buffer_load_dword v79, v4, s[24:27], s61 offen offset:256 sc1
    buffer_load_dword v80, v4, s[24:27], s61 offen offset:512 sc1
    buffer_load_dword v81, v4, s[24:27], s61 offen offset:768 sc1
    buffer_load_dword v82, v4, s[24:27], s61 offen offset:1024 sc1
    buffer_load_dword v83, v4, s[24:27], s61 offen offset:1280 sc1
    buffer_load_dword v84, v4, s[24:27], s61 offen offset:1536 sc1
    buffer_load_dword v85, v4, s[24:27], s61 offen offset:1792 sc1
    s_add_u32 s61, s61, 8192
    buffer_load_dword v86, v4, s[24:27], s61 offen sc1
    buffer_load_dword v87, v4, s[24:27], s61 offen offset:256 sc1
    buffer_load_dword v88, v4, s[24:27], s61 offen offset:512 sc1
    buffer_load_dword v89, v4, s[24:27], s61 offen offset:768 sc1
    buffer_load_dword v90, v4, s[24:27], s61 offen offset:1024 sc1
    buffer_load_dword v91, v4, s[24:27], s61 offen offset:1280 sc1
    buffer_load_dword v92, v4, s[24:27], s61 offen offset:1536 sc1
    buffer_load_dword v93, v4, s[24:27], s61 offen offset:1792 sc1
    s_add_u32 s61, s61, 8192
    buffer_load_dword v94, v4, s[24:27], s61 offen sc1
    buffer_load_dword v95, v4, s[24:27], s61 offen offset:256 sc1
    buffer_load_dword v96, v4, s[24:27], s61 offen offset:512 sc1
    buffer_load_dword v97, v4, s[24:27], s61 offen offset:768 sc1
    buffer_load_dword v98, v4, s[24:27], s61 offen offset:1024 sc1
    buffer_load_dword v99, v4, s[24:27], s61 offen offset:1280 sc1
    buffer_load_dword v100, v4, s[24:27], s61 offen offset:1536 sc1
    buffer_load_dword v101, v4, s[24:27], s61 offen offset:1792 sc1
    s_add_u32 s61, s61, 8192
    buffer_load_dword v102, v4, s[24:27], s61 offen sc1
    buffer_load_dword v103, v4, s[24:27], s61 offen offset:256 sc1
    buffer_load_dword v104, v4, s[24:27], s61 offen offset:512 sc1
    buffer_load_dword v105, v4, s[24:27], s61 offen offset:768 sc1
    buffer_load_dword v106, v4, s[24:27], s61 offen offset:1024 sc1
    buffer_load_dword v107, v4, s[24:27], s61 offen offset:1280 sc1
    buffer_load_dword v108, v4, s[24:27], s61 offen offset:1536 sc1
    buffer_load_dword v109, v4, s[24:27], s61 offen offset:1792 sc1
    s_add_u32 s38, s67, 20480
    s_add_u32 s39, s68, 20480
    s_add_u32 s40, s53, 155648
    v_add_u32 v8, s40, v3
    v_add_u32 v9, 155648, v3
    s_waitcnt vmcnt(0)
    v_mov_b32 v10, 1
    ds_write_b32 v26, v10 offset:208
    v_mov_b32 v10, 21
    ds_write_b32 v26, v10 offset:80
    v_pk_add_f32 v[78:79], v[78:79], v[86:87]
    v_pk_add_f32 v[94:95], v[94:95], v[102:103]
    v_pk_add_f32 v[80:81], v[80:81], v[88:89]
    v_pk_add_f32 v[96:97], v[96:97], v[104:105]
    v_pk_add_f32 v[82:83], v[82:83], v[90:91]
    v_pk_add_f32 v[98:99], v[98:99], v[106:107]
    v_pk_add_f32 v[84:85], v[84:85], v[92:93]
    v_pk_add_f32 v[100:101], v[100:101], v[108:109]
    v_pk_add_f32 v[78:79], v[78:79], v[94:95]
    v_pk_add_f32 v[80:81], v[80:81], v[96:97]
    v_pk_add_f32 v[82:83], v[82:83], v[98:99]
    v_pk_add_f32 v[84:85], v[84:85], v[100:101]
    v_cvt_pk_bf16_f32 v86, v78, v79
    v_cvt_pk_bf16_f32 v87, v80, v81
    v_cvt_pk_bf16_f32 v88, v82, v83
    v_cvt_pk_bf16_f32 v89, v84, v85
    ds_write_b128 v8, v[86:89]
    v_mov_b32 v10, 1
    ds_write_b32 v26, v10 offset:240
    ds_read_b32 v12, v27 offset:240
    s_waitcnt lgkmcnt(0)
    v_cmp_gt_u32 vcc, 1, v12
    s_cbranch_vccnz L_cw_100070
L_cn_100071:
    ds_read_b128 v[110:113], v9
    ds_read_b128 v[114:117], v9 offset:1024
    ds_read_b128 v[118:121], v9 offset:2048
    ds_read_b128 v[122:125], v9 offset:3072
    v_mov_b32 v10, 11
    ds_write_b32 v26, v10 offset:112
    s_waitcnt lgkmcnt(0)
    v_mov_b32 v22, v110
    v_mov_b32 v23, v111
    v_mov_b32 v24, v112
    v_mov_b32 v25, v113
    v_mov_b32 v36, v114
    v_mov_b32 v28, v115
    v_mov_b32 v29, v116
    v_mov_b32 v30, v117
    v_mov_b32 v31, v118
    v_mov_b32 v40, v119
    v_mov_b32 v32, v120
    v_mov_b32 v33, v121
    v_mov_b32 v34, v122
    v_mov_b32 v35, v123
    v_mov_b32 v44, v124
    s_nop 0
    v_mfma_f32_16x16x32_bf16 v[90:93], v[32:35], v[52:55], 0
    v_mfma_f32_16x16x32_bf16 v[94:97], v[32:35], v[58:61], 0
    v_mfma_f32_16x16x32_bf16 v[98:101], v[32:35], v[64:67], 0
    v_mfma_f32_16x16x32_bf16 v[102:105], v[32:35], v[70:73], 0
    v_mfma_f32_16x16x32_bf16 v[90:93], v[44:47], v[56:59], v[90:93]
    v_mfma_f32_16x16x32_bf16 v[94:97], v[44:47], v[62:65], v[94:97]
    v_mfma_f32_16x16x32_bf16 v[98:101], v[44:47], v[68:71], v[98:101]
    v_mfma_f32_16x16x32_bf16 v[102:105], v[44:47], v[74:77], v[102:105]
    v_mfma_f32_16x16x32_bf16 v[48:51], v[22:25], v[52:55], 0
    v_mfma_f32_16x16x32_bf16 v[78:81], v[28:31], v[58:61], 0
    v_mfma_f32_16x16x32_bf16 v[82:85], v[22:25], v[64:67], 0
    v_mfma_f32_16x16x32_bf16 v[86:89], v[28:31], v[70:73], 0
    v_mfma_f32_16x16x32_bf16 v[48:51], v[36:39], v[56:59], v[48:51]
    v_mfma_f32_16x16x32_bf16 v[78:81], v[40:43], v[62:65], v[78:81]
    v_mfma_f32_16x16x32_bf16 v[82:85], v[36:39], v[68:71], v[82:85]
    v_mfma_f32_16x16x32_bf16 v[86:89], v[40:43], v[74:77], v[86:89]
    v_add_f32 v91, 0x358637bd, v91
    v_add_f32 v97, 0x358637bd, v97
    v_add_f32 v99, 0x358637bd, v99
    v_add_f32 v105, 0x358637bd, v105
    v_rcp_f32 v91, v91
    v_rcp_f32 v97, v97
    v_rcp_f32 v99, v99
    v_rcp_f32 v105, v105
    v_mul_f32 v90, v90, v91
    v_mul_f32 v96, v96, v97
    v_cvt_pk_bf16_f32 v21, v90, v96
    v_mul_f32 v98, v98, v99
    v_mul_f32 v104, v104, v105
    v_cvt_pk_bf16_f32 v32, v98, v104
    v_pk_mul_f32 v[48:49], v[48:49], v[90:91] op_sel:[0,1]
    v_pk_mul_f32 v[50:51], v[50:51], v[90:91] op_sel:[0,1]
    v_cvt_pk_bf16_f32 v22, v48, v49
    v_cvt_pk_bf16_f32 v23, v50, v51
    v_pk_mul_f32 v[78:79], v[78:79], v[96:97] op_sel:[0,1]
    v_pk_mul_f32 v[80:81], v[80:81], v[96:97] op_sel:[0,1]
    v_cvt_pk_bf16_f32 v24, v78, v79
    v_cvt_pk_bf16_f32 v25, v80, v81
    v_pk_mul_f32 v[82:83], v[82:83], v[98:99] op_sel:[0,1]
    v_pk_mul_f32 v[84:85], v[84:85], v[98:99] op_sel:[0,1]
    v_cvt_pk_bf16_f32 v28, v82, v83
    v_cvt_pk_bf16_f32 v29, v84, v85
    v_pk_mul_f32 v[86:87], v[86:87], v[104:105] op_sel:[0,1]
    v_pk_mul_f32 v[88:89], v[88:89], v[104:105] op_sel:[0,1]
    v_cvt_pk_bf16_f32 v30, v86, v87
    v_cvt_pk_bf16_f32 v31, v88, v89
    s_cmp_eq_u32 s49, 0
    s_cbranch_scc1 L_sl_100073
    buffer_store_dwordx4 v[22:25], v3, s[24:27], s67 offen
    buffer_store_dword v21, v4, s[24:27], s68 offen
    buffer_store_dwordx4 v[28:31], v3, s[24:27], s38 offen
    buffer_store_dword v32, v4, s[24:27], s39 offen
    s_waitcnt vmcnt(0)
    s_lshl_b32 s45, s36, 5
    s_add_u32 s45, s45, s56
    s_add_u32 s45, s45, 65536
    s_mov_b64 exec, 1
    buffer_store_dwordx2 v[16:17], v11, s[24:27], s45 offen
    s_mov_b64 exec, -1
    s_branch L_dn_100074
L_sl_100073:
    buffer_store_dwordx4 v[22:25], v3, s[24:27], s67 offen sc1
    buffer_store_dword v21, v4, s[24:27], s68 offen sc1
    buffer_store_dwordx4 v[28:31], v3, s[24:27], s38 offen sc1
    buffer_store_dword v32, v4, s[24:27], s39 offen sc1
    s_waitcnt vmcnt(0)
    s_lshl_b32 s45, s36, 5
    s_add_u32 s45, s45, s56
    s_add_u32 s45, s45, 65536
    s_mov_b64 exec, 1
    buffer_store_dwordx2 v[16:17], v11, s[24:27], s45 offen sc1
    s_mov_b64 exec, -1
L_dn_100074:
    s_getpc_b64 s[96:97]
L_pcL:
    s_sub_u32 s96, s96, L_pcL-sequential_preLN__linear_kernel_hedgehog__dense_activation_relu__prompt_kernel
    s_subb_u32 s97, s97, 0
    s_lshr_b32 s38, s2, 3
    s_lshl_b32 s38, s38, 11
    s_lshl_b32 s39, s36, 9
    s_add_u32 s38, s38, s39
    v_and_b32 v8, 3, v2
    v_lshlrev_b32 v8, 7, v8
    v_add_u32 v0, s38, v8
    v_min_u32 v0, L_last-sequential_preLN__linear_kernel_hedgehog__dense_activation_relu__prompt_kernel, v0
    global_load_dword v5, v0, s[96:97]
    ds_read_b32 v12, v27 offset:112
    s_waitcnt lgkmcnt(0)
    v_cmp_gt_u32 vcc, 11, v12
    s_cbranch_vccnz L_cw_100075
L_cn_100076:
    ds_read_b32 v12, v27 offset:64
    s_waitcnt lgkmcnt(0)
    v_cmp_gt_u32 vcc, 1, v12
    s_cbranch_vccnz L_cw_100078
L_cn_100079:
    v_add_u32 v21, s53, v3
    s_add_u32 s51, s65, 49152
    s_add_u32 m0, s53, 151552
    s_nop 0
    buffer_load_dwordx4 v3, s[24:27], s51 offen sc1 lds
    s_add_u32 s51, s65, 53248
    s_add_u32 m0, s53, 155648
    s_nop 0
    buffer_load_dwordx4 v3, s[24:27], s51 offen sc1 lds
    ds_read_b32 v12, v27 offset:96
    s_waitcnt lgkmcnt(0)
    v_cmp_gt_u32 vcc, 13, v12
    s_cbranch_vccnz L_cw_100081
L_cn_100082:
    s_add_u32 s51, s65, 57344
    s_add_u32 m0, s53, 53248
    s_nop 0
    buffer_load_dwordx4 v3, s[24:27], s51 offen sc1 lds
    s_add_u32 s51, s65, 61440
    s_add_u32 m0, s53, 57344
    s_nop 0
    buffer_load_dwordx4 v3, s[24:27], s51 offen sc1 lds
    ds_read_b32 v12, v27 offset:96
    s_waitcnt lgkmcnt(0)
    v_cmp_gt_u32 vcc, 16, v12
    s_cbranch_vccnz L_cw_100084
L_cn_100085:
    s_add_u32 s51, s65, 65536
    s_add_u32 m0, s53, 61440
    s_nop 0
    buffer_load_dwordx4 v3, s[24:27], s51 offen sc1 lds
    s_add_u32 s51, s65, 69632
    s_add_u32 m0, s53, 65536
    s_nop 0
    buffer_load_dwordx4 v3, s[24:27], s51 offen sc1 lds
    global_load_dword v5, v0, s[96:97]
    s_waitcnt vmcnt(6)
    v_mov_b32 v10, 22
    ds_write_b32 v26, v10 offset:80
    s_add_u32 s51, s65, 73728
    s_add_u32 m0, s53, 69632
    s_nop 0
    buffer_load_dwordx4 v3, s[24:27], s51 offen sc1 lds
    ds_read_b32 v12, v27 offset:96
    s_waitcnt lgkmcnt(0)
    v_cmp_gt_u32 vcc, 18, v12
    s_cbranch_vccnz L_cw_100087
L_cn_100088:
    s_add_u32 s51, s65, 77824
    s_add_u32 m0, s53, 73728
    s_nop 0
    buffer_load_dwordx4 v3, s[24:27], s51 offen sc1 lds
    s_waitcnt vmcnt(7)
    v_mov_b32 v10, 23
    ds_write_b32 v26, v10 offset:80
    s_add_u32 s51, s65, 81920
    s_add_u32 m0, s53, 77824
    s_nop 0
    buffer_load_dwordx4 v3, s[24:27], s51 offen sc1 lds
    s_waitcnt vmcnt(7)
    v_mov_b32 v10, 24
    ds_write_b32 v26, v10 offset:80
    ds_read_b32 v12, v27 offset:96
    s_waitcnt lgkmcnt(0)
    v_cmp_gt_u32 vcc, 21, v12
    s_cbranch_vccnz L_cw_100090
L_cn_100091:
    s_add_u32 s51, s65, 86016
    s_add_u32 m0, s53, 81920
    s_nop 0
    buffer_load_dwordx4 v3, s[24:27], s51 offen sc1 lds
    s_waitcnt vmcnt(7)
    v_mov_b32 v10, 25
    ds_write_b32 v26, v10 offset:80
    s_add_u32 s51, s65, 90112
    s_add_u32 m0, s53, 86016
    s_nop 0
    buffer_load_dwordx4 v3, s[24:27], s51 offen sc1 lds
    s_waitcnt vmcnt(7)
    v_mov_b32 v10, 26
    ds_write_b32 v26, v10 offset:80
    s_add_u32 s51, s65, 94208
    s_add_u32 m0, s53, 90112
    s_nop 0
    buffer_load_dwordx4 v3, s[24:27], s51 offen sc1 lds
    s_waitcnt vmcnt(7)
    v_mov_b32 v10, 27
    ds_write_b32 v26, v10 offset:80
    ds_read_b32 v12, v27 offset:96
    s_waitcnt lgkmcnt(0)
    v_cmp_gt_u32 vcc, 23, v12
    s_cbranch_vccnz L_cw_100093
L_cn_100094:
    s_add_u32 s51, s65, 98304
    s_add_u32 m0, s53, 106496
    s_nop 0
    buffer_load_dwordx4 v3, s[24:27], s51 offen sc1 lds
    s_waitcnt vmcnt(6)
    v_mov_b32 v10, 28
    ds_write_b32 v26, v10 offset:80
    s_add_u32 s51, s65, 102400
    s_add_u32 m0, s53, 122880
    s_nop 0
    buffer_load_dwordx4 v3, s[24:27], s51 offen sc1 lds
    ds_read_b32 v12, v27 offset:96
    s_waitcnt lgkmcnt(0)
    v_cmp_gt_u32 vcc, 26, v12
    s_cbranch_vccnz L_cw_100096
L_cn_100097:
    s_add_u32 s51, s65, 106496
    s_add_u32 m0, s53, 0
    s_nop 0
    buffer_load_dwordx4 v3, s[24:27], s51 offen sc1 lds
    s_waitcnt vmcnt(7)
    v_mov_b32 v10, 29
    ds_write_b32 v26, v10 offset:80
    s_add_u32 s51, s65, 110592
    s_add_u32 m0, s53, 4096
    s_nop 0
    buffer_load_dwordx4 v3, s[24:27], s51 offen sc1 lds
    s_waitcnt vmcnt(7)
    v_mov_b32 v10, 30
    ds_write_b32 v26, v10 offset:80
    s_add_u32 s51, s65, 114688
    s_add_u32 m0, s53, 8192
    s_nop 0
    buffer_load_dwordx4 v3, s[24:27], s51 offen sc1 lds
    s_waitcnt vmcnt(7)
    v_mov_b32 v10, 31
    ds_write_b32 v26, v10 offset:80
    ds_read_b32 v12, v27 offset:96
    s_waitcnt lgkmcnt(0)
    v_cmp_gt_u32 vcc, 28, v12
    s_cbranch_vccnz L_cw_100099
L_cn_100100:
    s_add_u32 s51, s65, 118784
    s_add_u32 m0, s53, 12288
    s_nop 0
    buffer_load_dwordx4 v3, s[24:27], s51 offen sc1 lds
    global_load_dword v5, v0, s[96:97]
    s_waitcnt vmcnt(8)
    v_mov_b32 v10, 32
    ds_write_b32 v26, v10 offset:80
    s_waitcnt vmcnt(7)
    v_mov_b32 v10, 33
    ds_write_b32 v26, v10 offset:80
    s_add_u32 s51, s65, 122880
    s_add_u32 m0, s53, 16384
    s_nop 0
    buffer_load_dwordx4 v3, s[24:27], s51 offen sc1 lds
    s_waitcnt vmcnt(7)
    v_mov_b32 v10, 34
    ds_write_b32 v26, v10 offset:80
    ds_read_b32 v12, v27 offset:96
    s_waitcnt lgkmcnt(0)
    v_cmp_gt_u32 vcc, 31, v12
    s_cbranch_vccnz L_cw_100102
L_cn_100103:
    s_add_u32 s51, s65, 126976
    s_add_u32 m0, s53, 20480
    s_nop 0
    buffer_load_dwordx4 v3, s[24:27], s51 offen sc1 lds
    s_waitcnt vmcnt(7)
    v_mov_b32 v10, 35
    ds_write_b32 v26, v10 offset:80
    s_add_u32 s51, s65, 131072
    s_add_u32 m0, s53, 24576
    s_nop 0
    buffer_load_dwordx4 v3, s[24:27], s51 offen sc1 lds
    s_waitcnt vmcnt(7)
    v_mov_b32 v10, 36
    ds_write_b32 v26, v10 offset:80
    s_add_u32 s51, s65, 135168
    s_add_u32 m0, s53, 28672
    s_nop 0
    buffer_load_dwordx4 v3, s[24:27], s51 offen sc1 lds
    s_waitcnt vmcnt(7)
    v_mov_b32 v10, 37
    ds_write_b32 v26, v10 offset:80
    ds_read_b32 v12, v27 offset:96
    s_waitcnt lgkmcnt(0)
    v_cmp_gt_u32 vcc, 32, v12
    s_cbranch_vccnz L_cw_100105
L_cn_100106:
    s_add_u32 s51, s65, 139264
    s_add_u32 m0, s53, 32768
    s_nop 0
    buffer_load_dwordx4 v3, s[24:27], s51 offen sc1 lds
    s_waitcnt vmcnt(7)
    v_mov_b32 v10, 38
    ds_write_b32 v26, v10 offset:80
    ds_read_b32 v12, v27 offset:96
    s_waitcnt lgkmcnt(0)
    v_cmp_gt_u32 vcc, 33, v12
    s_cbranch_vccnz L_cw_100108
L_cn_100109:
    s_add_u32 s51, s66, 0
    s_add_u32 m0, s53, 36864
    s_nop 0
    buffer_load_dwordx4 v3, s[24:27], s51 offen sc1 lds
    s_waitcnt vmcnt(7)
    v_mov_b32 v10, 39
    ds_write_b32 v26, v10 offset:80
    ds_read_b32 v12, v27 offset:96
    s_waitcnt lgkmcnt(0)
    v_cmp_gt_u32 vcc, 34, v12
    s_cbranch_vccnz L_cw_100111
L_cn_100112:
    s_add_u32 s51, s66, 4096
    s_add_u32 m0, s53, 126976
    s_nop 0
    buffer_load_dwordx4 v3, s[24:27], s51 offen sc1 lds
    s_waitcnt vmcnt(6)
    v_mov_b32 v10, 40
    ds_write_b32 v26, v10 offset:80
    ds_read_b32 v12, v27 offset:96
    s_waitcnt lgkmcnt(0)
    v_cmp_gt_u32 vcc, 36, v12
    s_cbranch_vccnz L_cw_100114
L_cn_100115:
    s_add_u32 s51, s66, 8192
    s_add_u32 m0, s53, 131072
    s_nop 0
    buffer_load_dwordx4 v3, s[24:27], s51 offen sc1 lds
    s_add_u32 s51, s66, 12288
    s_add_u32 m0, s53, 135168
    s_nop 0
    buffer_load_dwordx4 v3, s[24:27], s51 offen sc1 lds
    s_waitcnt vmcnt(7)
    v_mov_b32 v10, 41
    ds_write_b32 v26, v10 offset:80
    ds_read_b32 v12, v27 offset:96
    s_waitcnt lgkmcnt(0)
    v_cmp_gt_u32 vcc, 40, v12
    s_cbranch_vccnz L_cw_100117
L_cn_100118:
    s_add_u32 s51, s66, 16384
    s_add_u32 m0, s53, 139264
    s_nop 0
    buffer_load_dwordx4 v3, s[24:27], s51 offen sc1 lds
    s_waitcnt vmcnt(7)
    v_mov_b32 v10, 42
    ds_write_b32 v26, v10 offset:80
    s_add_u32 s51, s66, 20480
    s_add_u32 m0, s53, 143360
    s_nop 0
    buffer_load_dwordx4 v3, s[24:27], s51 offen sc1 lds
    s_waitcnt vmcnt(7)
    v_mov_b32 v10, 43
    ds_write_b32 v26, v10 offset:80
    s_add_u32 s51, s66, 24576
    s_add_u32 m0, s53, 147456
    s_nop 0
    buffer_load_dwordx4 v3, s[24:27], s51 offen sc1 lds
    global_load_dword v5, v0, s[96:97]
    s_waitcnt vmcnt(8)
    v_mov_b32 v10, 44
    ds_write_b32 v26, v10 offset:80
    s_waitcnt vmcnt(7)
    v_mov_b32 v10, 45
    ds_write_b32 v26, v10 offset:80
    s_add_u32 s51, s66, 28672
    s_add_u32 m0, s53, 40960
    s_nop 0
    buffer_load_dwordx4 v3, s[24:27], s51 offen sc1 lds
    s_waitcnt vmcnt(7)
    v_mov_b32 v10, 46
    ds_write_b32 v26, v10 offset:80
    ds_read_b32 v12, v27 offset:96
    s_waitcnt lgkmcnt(0)
    v_cmp_gt_u32 vcc, 44, v12
    s_cbranch_vccnz L_cw_100120
L_cn_100121:
    s_add_u32 s51, s66, 32768
    s_add_u32 m0, s53, 45056
    s_nop 0
    buffer_load_dwordx4 v3, s[24:27], s51 offen sc1 lds
    s_waitcnt vmcnt(7)
    v_mov_b32 v10, 47
    ds_write_b32 v26, v10 offset:80
    s_add_u32 s51, s66, 36864
    s_add_u32 m0, s53, 49152
    s_nop 0
    buffer_load_dwordx4 v3, s[24:27], s51 offen sc1 lds
    s_waitcnt vmcnt(7)
    v_mov_b32 v10, 48
    ds_write_b32 v26, v10 offset:80
    s_add_u32 s51, s66, 40960
    s_add_u32 m0, s53, 94208
    s_nop 0
    buffer_load_dwordx4 v3, s[24:27], s51 offen sc1 lds
    s_waitcnt vmcnt(7)
    v_mov_b32 v10, 49
    ds_write_b32 v26, v10 offset:80
    s_add_u32 s51, s66, 45056
    s_add_u32 m0, s53, 98304
    s_nop 0
    buffer_load_dwordx4 v3, s[24:27], s51 offen sc1 lds
    s_waitcnt vmcnt(7)
    v_mov_b32 v10, 50
    ds_write_b32 v26, v10 offset:80
    ds_read_b32 v12, v27 offset:96
    s_waitcnt lgkmcnt(0)
    v_cmp_gt_u32 vcc, 48, v12
    s_cbranch_vccnz L_cw_100123
L_cn_100124:
    s_add_u32 s51, s66, 49152
    s_add_u32 m0, s53, 102400
    s_nop 0
    buffer_load_dwordx4 v3, s[24:27], s51 offen sc1 lds
    s_waitcnt vmcnt(7)
    v_mov_b32 v10, 51
    ds_write_b32 v26, v10 offset:80
    s_add_u32 s51, s66, 53248
    s_add_u32 m0, s53, 110592
    s_nop 0
    buffer_load_dwordx4 v3, s[24:27], s51 offen sc1 lds
    s_waitcnt vmcnt(6)
    v_mov_b32 v10, 52
    ds_write_b32 v26, v10 offset:80
    s_add_u32 s51, s66, 57344
    s_add_u32 m0, s53, 114688
    s_nop 0
    buffer_load_dwordx4 v3, s[24:27], s51 offen sc1 lds
    s_add_u32 s51, s66, 61440
    s_add_u32 m0, s53, 118784
    s_nop 0
    buffer_load_dwordx4 v3, s[24:27], s51 offen sc1 lds
    s_waitcnt vmcnt(7)
    v_mov_b32 v10, 53
    ds_write_b32 v26, v10 offset:80
    ds_read_b32 v12, v27 offset:96
    s_waitcnt lgkmcnt(0)
    v_cmp_gt_u32 vcc, 52, v12
    s_cbranch_vccnz L_cw_100126
L_cn_100127:
    s_add_u32 s51, s66, 65536
    s_add_u32 m0, s53, 151552
    s_nop 0
    buffer_load_dwordx4 v3, s[24:27], s51 offen sc1 lds
    s_waitcnt vmcnt(7)
    v_mov_b32 v10, 54
    ds_write_b32 v26, v10 offset:80
    s_add_u32 s51, s66, 69632
    s_add_u32 m0, s53, 155648
    s_nop 0
    buffer_load_dwordx4 v3, s[24:27], s51 offen sc1 lds
    s_waitcnt vmcnt(7)
    v_mov_b32 v10, 55
    ds_write_b32 v26, v10 offset:80
    s_add_u32 s51, s66, 73728
    s_add_u32 m0, s53, 53248
    s_nop 0
    buffer_load_dwordx4 v3, s[24:27], s51 offen sc1 lds
    global_load_dword v5, v0, s[96:97]
    s_waitcnt vmcnt(8)
    v_mov_b32 v10, 56
    ds_write_b32 v26, v10 offset:80
    s_waitcnt vmcnt(7)
    v_mov_b32 v10, 57
    ds_write_b32 v26, v10 offset:80
    s_add_u32 s51, s66, 77824
    s_add_u32 m0, s53, 57344
    s_nop 0
    buffer_load_dwordx4 v3, s[24:27], s51 offen sc1 lds
    s_waitcnt vmcnt(7)
    v_mov_b32 v10, 58
    ds_write_b32 v26, v10 offset:80
    ds_read_b32 v12, v27 offset:96
    s_waitcnt lgkmcnt(0)
    v_cmp_gt_u32 vcc, 56, v12
    s_cbranch_vccnz L_cw_100129
L_cn_100130:
    s_add_u32 s51, s66, 81920
    s_add_u32 m0, s53, 61440
    s_nop 0
    buffer_load_dwordx4 v3, s[24:27], s51 offen sc1 lds
    s_waitcnt vmcnt(7)
    v_mov_b32 v10, 59
    ds_write_b32 v26, v10 offset:80
    s_add_u32 s51, s66, 86016
    s_add_u32 m0, s53, 65536
    s_nop 0
    buffer_load_dwordx4 v3, s[24:27], s51 offen sc1 lds
    s_waitcnt vmcnt(7)
    v_mov_b32 v10, 60
    ds_write_b32 v26, v10 offset:80
    s_add_u32 s51, s66, 90112
    s_add_u32 m0, s53, 69632
    s_nop 0
    buffer_load_dwordx4 v3, s[24:27], s51 offen sc1 lds
    s_waitcnt vmcnt(7)
    v_mov_b32 v10, 61
    ds_write_b32 v26, v10 offset:80
    s_add_u32 s51, s66, 94208
    s_add_u32 m0, s53, 73728
    s_nop 0
    buffer_load_dwordx4 v3, s[24:27], s51 offen sc1 lds
    s_waitcnt vmcnt(7)
    v_mov_b32 v10, 62
    ds_write_b32 v26, v10 offset:80
    ds_read_b32 v12, v27 offset:96
    s_waitcnt lgkmcnt(0)
    v_cmp_gt_u32 vcc, 59, v12
    s_cbranch_vccnz L_cw_100132
L_cn_100133:
    s_add_u32 s51, s66, 98304
    s_add_u32 m0, s53, 77824
    s_nop 0
    buffer_load_dwordx4 v3, s[24:27], s51 offen sc1 lds
    s_waitcnt vmcnt(7)
    v_mov_b32 v10, 63
    ds_write_b32 v26, v10 offset:80
    s_add_u32 s51, s66, 102400
    s_add_u32 m0, s53, 81920
    s_nop 0
    buffer_load_dwordx4 v3, s[24:27], s51 offen sc1 lds
    s_waitcnt vmcnt(6)
    v_mov_b32 v10, 64
    ds_write_b32 v26, v10 offset:80
    s_add_u32 s51, s66, 106496
    s_add_u32 m0, s53, 86016
    s_nop 0
    buffer_load_dwordx4 v3, s[24:27], s51 offen sc1 lds
    ds_read_b32 v12, v27 offset:96
    s_waitcnt lgkmcnt(0)
    v_cmp_gt_u32 vcc, 62, v12
    s_cbranch_vccnz L_cw_100135
L_cn_100136:
    s_add_u32 s51, s66, 110592
    s_add_u32 m0, s53, 90112
    s_nop 0
    buffer_load_dwordx4 v3, s[24:27], s51 offen sc1 lds
    s_waitcnt vmcnt(7)
    v_mov_b32 v10, 65
    ds_write_b32 v26, v10 offset:80
    s_add_u32 s51, s66, 114688
    s_add_u32 m0, s53, 106496
    s_nop 0
    buffer_load_dwordx4 v3, s[24:27], s51 offen sc1 lds
    s_waitcnt vmcnt(7)
    v_mov_b32 v10, 66
    ds_write_b32 v26, v10 offset:80
    s_add_u32 s51, s66, 118784
    s_add_u32 m0, s53, 122880
    s_nop 0
    buffer_load_dwordx4 v3, s[24:27], s51 offen sc1 lds
    s_waitcnt vmcnt(7)
    v_mov_b32 v10, 67
    ds_write_b32 v26, v10 offset:80
    ds_read_b32 v12, v27 offset:96
    s_waitcnt lgkmcnt(0)
    v_cmp_gt_u32 vcc, 65, v12
    s_cbranch_vccnz L_cw_100138
L_cn_100139:
    s_add_u32 s51, s66, 122880
    s_add_u32 m0, s53, 0
    s_nop 0
    buffer_load_dwordx4 v3, s[24:27], s51 offen sc1 lds
    global_load_dword v5, v0, s[96:97]
    s_waitcnt vmcnt(8)
    v_mov_b32 v10, 68
    ds_write_b32 v26, v10 offset:80
    s_waitcnt vmcnt(7)
    v_mov_b32 v10, 69
    ds_write_b32 v26, v10 offset:80
    s_add_u32 s51, s66, 126976
    s_add_u32 m0, s53, 4096
    s_nop 0
    buffer_load_dwordx4 v3, s[24:27], s51 offen sc1 lds
    s_waitcnt vmcnt(7)
    v_mov_b32 v10, 70
    ds_write_b32 v26, v10 offset:80
    s_add_u32 s51, s66, 131072
    s_add_u32 m0, s53, 8192
    s_nop 0
    buffer_load_dwordx4 v3, s[24:27], s51 offen sc1 lds
    s_waitcnt vmcnt(7)
    v_mov_b32 v10, 71
    ds_write_b32 v26, v10 offset:80
    ds_read_b32 v12, v27 offset:96
    s_waitcnt lgkmcnt(0)
    v_cmp_gt_u32 vcc, 68, v12
    s_cbranch_vccnz L_cw_100141
L_cn_100142:
    s_add_u32 s51, s66, 135168
    s_add_u32 m0, s53, 12288
    s_nop 0
    buffer_load_dwordx4 v3, s[24:27], s51 offen sc1 lds
    s_waitcnt vmcnt(7)
    v_mov_b32 v10, 72
    ds_write_b32 v26, v10 offset:80
    s_add_u32 s51, s66, 139264
    s_add_u32 m0, s53, 16384
    s_nop 0
    buffer_load_dwordx4 v3, s[24:27], s51 offen sc1 lds
    s_waitcnt vmcnt(7)
    v_mov_b32 v10, 73
    ds_write_b32 v26, v10 offset:80
    s_add_u32 s51, s66, 143360
    s_add_u32 m0, s53, 20480
    s_nop 0
    buffer_load_dwordx4 v3, s[24:27], s51 offen sc1 lds
    s_waitcnt vmcnt(7)
    v_mov_b32 v10, 74
    ds_write_b32 v26, v10 offset:80
    ds_read_b32 v12, v27 offset:96
    s_waitcnt lgkmcnt(0)
    v_cmp_gt_u32 vcc, 71, v12
    s_cbranch_vccnz L_cw_100144
L_cn_100145:
    s_add_u32 s51, s66, 147456
    s_add_u32 m0, s53, 24576
    s_nop 0
    buffer_load_dwordx4 v3, s[24:27], s51 offen sc1 lds
    s_waitcnt vmcnt(7)
    v_mov_b32 v10, 75
    ds_write_b32 v26, v10 offset:80
    s_add_u32 s51, s66, 151552
    s_add_u32 m0, s53, 28672
    s_nop 0
    buffer_load_dwordx4 v3, s[24:27], s51 offen sc1 lds
    s_waitcnt vmcnt(6)
    v_mov_b32 v10, 76
    ds_write_b32 v26, v10 offset:80
    s_add_u32 s51, s66, 155648
    s_add_u32 m0, s53, 32768
    s_nop 0
    buffer_load_dwordx4 v3, s[24:27], s51 offen sc1 lds
    ds_read_b32 v12, v27 offset:96
    s_waitcnt lgkmcnt(0)
    v_cmp_gt_u32 vcc, 76, v12
    s_cbranch_vccnz L_cw_100147
L_cn_100148:
    s_add_u32 s51, s66, 159744
    s_add_u32 m0, s53, 36864
    s_nop 0
    buffer_load_dwordx4 v3, s[24:27], s51 offen sc1 lds
    s_waitcnt vmcnt(7)
    v_mov_b32 v10, 77
    ds_write_b32 v26, v10 offset:80
    s_add_u32 s51, s66, 163840
    s_add_u32 m0, s53, 126976
    s_nop 0
    buffer_load_dwordx4 v3, s[24:27], s51 offen sc1 lds
    s_waitcnt vmcnt(7)
    v_mov_b32 v10, 78
    ds_write_b32 v26, v10 offset:80
    s_add_u32 s51, s66, 167936
    s_add_u32 m0, s53, 131072
    s_nop 0
    buffer_load_dwordx4 v3, s[24:27], s51 offen sc1 lds
    s_waitcnt vmcnt(7)
    v_mov_b32 v10, 79
    ds_write_b32 v26, v10 offset:80
    s_add_u32 s51, s66, 172032
    s_add_u32 m0, s53, 135168
    s_nop 0
    buffer_load_dwordx4 v3, s[24:27], s51 offen sc1 lds
    global_load_dword v5, v0, s[96:97]
    s_waitcnt vmcnt(8)
    v_mov_b32 v10, 80
    ds_write_b32 v26, v10 offset:80
    s_waitcnt vmcnt(7)
    v_mov_b32 v10, 81
    ds_write_b32 v26, v10 offset:80
    s_add_u32 s51, s66, 176128
    s_add_u32 m0, s53, 139264
    s_nop 0
    buffer_load_dwordx4 v3, s[24:27], s51 offen sc1 lds
    s_waitcnt vmcnt(7)
    v_mov_b32 v10, 82
    ds_write_b32 v26, v10 offset:80
    ds_read_b32 v12, v27 offset:96
    s_waitcnt lgkmcnt(0)
    v_cmp_gt_u32 vcc, 81, v12
    s_cbranch_vccnz L_cw_100150
L_cn_100151:
    s_add_u32 s51, s66, 180224
    s_add_u32 m0, s53, 143360
    s_nop 0
    buffer_load_dwordx4 v3, s[24:27], s51 offen sc1 lds
    s_waitcnt vmcnt(7)
    v_mov_b32 v10, 83
    ds_write_b32 v26, v10 offset:80
    s_add_u32 s51, s66, 184320
    s_add_u32 m0, s53, 147456
    s_nop 0
    buffer_load_dwordx4 v3, s[24:27], s51 offen sc1 lds
    s_waitcnt vmcnt(7)
    v_mov_b32 v10, 84
    ds_write_b32 v26, v10 offset:80
    s_add_u32 s51, s66, 188416
    s_add_u32 m0, s53, 40960
    s_nop 0
    buffer_load_dwordx4 v3, s[24:27], s51 offen sc1 lds
    s_waitcnt vmcnt(7)
    v_mov_b32 v10, 85
    ds_write_b32 v26, v10 offset:80
    s_add_u32 s51, s66, 192512
    s_add_u32 m0, s53, 45056
    s_nop 0
    buffer_load_dwordx4 v3, s[24:27], s51 offen sc1 lds
    s_waitcnt vmcnt(7)
    v_mov_b32 v10, 86
    ds_write_b32 v26, v10 offset:80
    s_add_u32 s51, s66, 196608
    s_add_u32 m0, s53, 49152
    s_nop 0
    buffer_load_dwordx4 v3, s[24:27], s51 offen sc1 lds
    s_waitcnt vmcnt(7)
    v_mov_b32 v10, 87
    ds_write_b32 v26, v10 offset:80
    ds_read_b32 v12, v27 offset:96
    s_waitcnt lgkmcnt(0)
    v_cmp_gt_u32 vcc, 86, v12
    s_cbranch_vccnz L_cw_100153
L_cn_100154:
    s_add_u32 s51, s66, 200704
    s_add_u32 m0, s53, 94208
    s_nop 0
    buffer_load_dwordx4 v3, s[24:27], s51 offen sc1 lds
    s_waitcnt vmcnt(6)
    v_mov_b32 v10, 88
    ds_write_b32 v26, v10 offset:80
    s_add_u32 s51, s66, 204800
    s_add_u32 m0, s53, 98304
    s_nop 0
    buffer_load_dwordx4 v3, s[24:27], s51 offen sc1 lds
    s_add_u32 s51, s66, 208896
    s_add_u32 m0, s53, 102400
    s_nop 0
    buffer_load_dwordx4 v3, s[24:27], s51 offen sc1 lds
    s_waitcnt vmcnt(7)
    v_mov_b32 v10, 89
    ds_write_b32 v26, v10 offset:80
    s_add_u32 s51, s66, 212992
    s_add_u32 m0, s53, 110592
    s_nop 0
    buffer_load_dwordx4 v3, s[24:27], s51 offen sc1 lds
    s_waitcnt vmcnt(7)
    v_mov_b32 v10, 90
    ds_write_b32 v26, v10 offset:80
    s_add_u32 s51, s66, 217088
    s_add_u32 m0, s53, 114688
    s_nop 0
    buffer_load_dwordx4 v3, s[24:27], s51 offen sc1 lds
    s_waitcnt vmcnt(7)
    v_mov_b32 v10, 91
    ds_write_b32 v26, v10 offset:80
    ds_read_b32 v12, v27 offset:96
    s_waitcnt lgkmcnt(0)
    v_cmp_gt_u32 vcc, 91, v12
    s_cbranch_vccnz L_cw_100156
L_cn_100157:
    s_add_u32 s51, s66, 221184
    s_add_u32 m0, s53, 118784
    s_nop 0
    buffer_load_dwordx4 v3, s[24:27], s51 offen sc1 lds
    s_waitcnt vmcnt(7)
    v_mov_b32 v10, 92
    ds_write_b32 v26, v10 offset:80
    s_add_u32 s51, s66, 225280
    s_add_u32 m0, s53, 151552
    s_nop 0
    buffer_load_dwordx4 v3, s[24:27], s51 offen sc1 lds
    s_waitcnt vmcnt(7)
    v_mov_b32 v10, 93
    ds_write_b32 v26, v10 offset:80
    s_add_u32 s51, s66, 229376
    s_add_u32 m0, s53, 155648
    s_nop 0
    buffer_load_dwordx4 v3, s[24:27], s51 offen sc1 lds
    s_waitcnt vmcnt(7)
    v_mov_b32 v10, 94
    ds_write_b32 v26, v10 offset:80
    s_add_u32 s51, s66, 233472
    s_add_u32 m0, s53, 53248
    s_nop 0
    buffer_load_dwordx4 v3, s[24:27], s51 offen sc1 lds
    s_waitcnt vmcnt(7)
    v_mov_b32 v10, 95
    ds_write_b32 v26, v10 offset:80
    s_add_u32 s51, s66, 237568
    s_add_u32 m0, s53, 57344
    s_nop 0
    buffer_load_dwordx4 v3, s[24:27], s51 offen sc1 lds
    s_waitcnt vmcnt(7)
    v_mov_b32 v10, 96
    ds_write_b32 v26, v10 offset:80
    ds_read_b32 v12, v27 offset:96
    s_waitcnt lgkmcnt(0)
    v_cmp_gt_u32 vcc, 96, v12
    s_cbranch_vccnz L_cw_100159
L_cn_100160:
    s_add_u32 s51, s66, 241664
    s_add_u32 m0, s53, 61440
    s_nop 0
    buffer_load_dwordx4 v3, s[24:27], s51 offen sc1 lds
    s_waitcnt vmcnt(7)
    v_mov_b32 v10, 97
    ds_write_b32 v26, v10 offset:80
    s_add_u32 s51, s66, 245760
    s_add_u32 m0, s53, 65536
    s_nop 0
    buffer_load_dwordx4 v3, s[24:27], s51 offen sc1 lds
    s_waitcnt vmcnt(7)
    v_mov_b32 v10, 98
    ds_write_b32 v26, v10 offset:80
    s_add_u32 s51, s66, 249856
    s_add_u32 m0, s53, 69632
    s_nop 0
    buffer_load_dwordx4 v3, s[24:27], s51 offen sc1 lds
    s_waitcnt vmcnt(7)
    v_mov_b32 v10, 99
    ds_write_b32 v26, v10 offset:80
    s_add_u32 s51, s66, 253952
    s_add_u32 m0, s53, 73728
    s_nop 0
    buffer_load_dwordx4 v3, s[24:27], s51 offen sc1 lds
    s_waitcnt vmcnt(7)
    v_mov_b32 v10, 100
    ds_write_b32 v26, v10 offset:80
    s_add_u32 s51, s66, 258048
    s_add_u32 m0, s53, 77824
    s_nop 0
    buffer_load_dwordx4 v3, s[24:27], s51 offen sc1 lds
    s_waitcnt vmcnt(7)
    v_mov_b32 v10, 101
    ds_write_b32 v26, v10 offset:80
    ds_read_b32 v12, v27 offset:96
    s_waitcnt lgkmcnt(0)
    v_cmp_gt_u32 vcc, 101, v12
    s_cbranch_vccnz L_cw_100162
L_cn_100163:
    s_add_u32 s51, s66, 262144
    s_add_u32 m0, s53, 81920
    s_nop 0
    buffer_load_dwordx4 v3, s[24:27], s51 offen sc1 lds
    s_waitcnt vmcnt(7)
    v_mov_b32 v10, 102
    ds_write_b32 v26, v10 offset:80
    s_add_u32 s51, s66, 266240
    s_add_u32 m0, s53, 86016
    s_nop 0
    buffer_load_dwordx4 v3, s[24:27], s51 offen sc1 lds
    s_waitcnt vmcnt(7)
    v_mov_b32 v10, 103
    ds_write_b32 v26, v10 offset:80
    s_add_u32 s51, s66, 270336
    s_add_u32 m0, s53, 90112
    s_nop 0
    buffer_load_dwordx4 v3, s[24:27], s51 offen sc1 lds
    s_waitcnt vmcnt(7)
    v_mov_b32 v10, 104
    ds_write_b32 v26, v10 offset:80
    s_add_u32 s51, s66, 274432
    s_add_u32 m0, s53, 106496
    s_nop 0
    buffer_load_dwordx4 v3, s[24:27], s51 offen sc1 lds
    s_waitcnt vmcnt(7)
    v_mov_b32 v10, 105
    ds_write_b32 v26, v10 offset:80
    s_waitcnt vmcnt(6)
    v_mov_b32 v10, 106
    ds_write_b32 v26, v10 offset:80
    s_waitcnt vmcnt(5)
    v_mov_b32 v10, 107
    ds_write_b32 v26, v10 offset:80
    s_waitcnt vmcnt(4)
    v_mov_b32 v10, 108
    ds_write_b32 v26, v10 offset:80
    s_waitcnt vmcnt(3)
    v_mov_b32 v10, 109
    ds_write_b32 v26, v10 offset:80
    s_waitcnt vmcnt(2)
    v_mov_b32 v10, 110
    ds_write_b32 v26, v10 offset:80
    s_waitcnt vmcnt(1)
    v_mov_b32 v10, 111
    ds_write_b32 v26, v10 offset:80
    s_waitcnt vmcnt(0)
    v_mov_b32 v10, 112
    ds_write_b32 v26, v10 offset:80
L_end:
    s_endpgm
L_cw_100001:
    s_mov_b32 s48, 200000
L_ct_100003:
    s_sleep 1
    ds_read_b32 v12, v27 offset:176
    s_waitcnt lgkmcnt(0)
    v_cmp_gt_u32 vcc, 2, v12
    s_cbranch_vccz L_cn_100002
    s_sub_u32 s48, s48, 1
    s_cmp_lg_u32 s48, 0
    s_cbranch_scc1 L_ct_100003
    s_branch L_cn_100002
L_cw_100004:
    s_mov_b32 s48, 200000
L_ct_100006:
    s_sleep 1
    ds_read_b32 v12, v26 offset:96
    s_waitcnt lgkmcnt(0)
    v_cmp_gt_u32 vcc, 1, v12
    s_cbranch_vccz L_cn_100005
    s_sub_u32 s48, s48, 1
    s_cmp_lg_u32 s48, 0
    s_cbranch_scc1 L_ct_100006
    s_branch L_cn_100005
L_cw_100007:
    s_mov_b32 s48, 200000
L_ct_100009:
    s_sleep 1
    ds_read_b32 v12, v26 offset:96
    s_waitcnt lgkmcnt(0)
    v_cmp_gt_u32 vcc, 2, v12
    s_cbranch_vccz L_cn_100008
    s_sub_u32 s48, s48, 1
    s_cmp_lg_u32 s48, 0
    s_cbranch_scc1 L_ct_100009
    s_branch L_cn_100008
L_cw_100010:
    s_mov_b32 s48, 200000
L_ct_100012:
    s_sleep 1
    ds_read_b32 v12, v27 offset:96
    s_waitcnt lgkmcnt(0)
    v_cmp_gt_u32 vcc, 3, v12
    s_cbranch_vccz L_cn_100011
    s_sub_u32 s48, s48, 1
    s_cmp_lg_u32 s48, 0
    s_cbranch_scc1 L_ct_100012
    s_branch L_cn_100011
L_cw_100013:
    s_mov_b32 s48, 200000
L_ct_100015:
    s_sleep 1
    ds_read_b32 v12, v26 offset:96
    s_waitcnt lgkmcnt(0)
    v_cmp_gt_u32 vcc, 4, v12
    s_cbranch_vccz L_cn_100014
    s_sub_u32 s48, s48, 1
    s_cmp_lg_u32 s48, 0
    s_cbranch_scc1 L_ct_100015
    s_branch L_cn_100014
L_cw_100016:
    s_mov_b32 s48, 200000
L_ct_100018:
    s_sleep 1
    ds_read_b32 v12, v27 offset:96
    s_waitcnt lgkmcnt(0)
    v_cmp_gt_u32 vcc, 5, v12
    s_cbranch_vccz L_cn_100017
    s_sub_u32 s48, s48, 1
    s_cmp_lg_u32 s48, 0
    s_cbranch_scc1 L_ct_100018
    s_branch L_cn_100017
L_cw_100019:
    s_mov_b32 s48, 200000
L_ct_100021:
    s_sleep 1
    ds_read_b32 v12, v26 offset:96
    s_waitcnt lgkmcnt(0)
    v_cmp_gt_u32 vcc, 6, v12
    s_cbranch_vccz L_cn_100020
    s_sub_u32 s48, s48, 1
    s_cmp_lg_u32 s48, 0
    s_cbranch_scc1 L_ct_100021
    s_branch L_cn_100020
L_cw_100022:
    s_mov_b32 s48, 200000
L_ct_100024:
    s_sleep 1
    ds_read_b32 v12, v27 offset:144
    s_waitcnt lgkmcnt(0)
    v_cmp_gt_u32 vcc, 1, v12
    s_cbranch_vccz L_cn_100023
    s_sub_u32 s48, s48, 1
    s_cmp_lg_u32 s48, 0
    s_cbranch_scc1 L_ct_100024
    s_branch L_cn_100023
L_cw_100025:
    s_mov_b32 s48, 200000
L_ct_100027:
    s_sleep 1
    ds_read_b32 v12, v27 offset:160
    s_waitcnt lgkmcnt(0)
    v_cmp_gt_u32 vcc, 1, v12
    s_cbranch_vccz L_cn_100026
    s_sub_u32 s48, s48, 1
    s_cmp_lg_u32 s48, 0
    s_cbranch_scc1 L_ct_100027
    s_branch L_cn_100026
L_cw_100028:
    s_mov_b32 s48, 200000
L_ct_100030:
    s_sleep 1
    ds_read_b32 v12, v27 offset:96
    s_waitcnt lgkmcnt(0)
    v_cmp_gt_u32 vcc, 7, v12
    s_cbranch_vccz L_cn_100029
    s_sub_u32 s48, s48, 1
    s_cmp_lg_u32 s48, 0
    s_cbranch_scc1 L_ct_100030
    s_branch L_cn_100029
L_cw_100031:
    s_mov_b32 s48, 200000
L_ct_100033:
    s_sleep 1
    ds_read_b32 v12, v27 offset:112
    s_waitcnt lgkmcnt(0)
    v_cmp_gt_u32 vcc, 7, v12
    s_cbranch_vccz L_cn_100032
    s_sub_u32 s48, s48, 1
    s_cmp_lg_u32 s48, 0
    s_cbranch_scc1 L_ct_100033
    s_branch L_cn_100032
L_cw_100034:
    s_mov_b32 s48, 200000
L_ct_100036:
    s_sleep 1
    ds_read_b32 v12, v27 offset:112
    s_waitcnt lgkmcnt(0)
    v_cmp_gt_u32 vcc, 8, v12
    s_cbranch_vccz L_cn_100035
    s_sub_u32 s48, s48, 1
    s_cmp_lg_u32 s48, 0
    s_cbranch_scc1 L_ct_100036
    s_branch L_cn_100035
L_cw_100037:
    s_mov_b32 s48, 200000
L_ct_100039:
    s_sleep 1
    ds_read_b32 v12, v27 offset:96
    s_waitcnt lgkmcnt(0)
    v_cmp_gt_u32 vcc, 8, v12
    s_cbranch_vccz L_cn_100038
    s_sub_u32 s48, s48, 1
    s_cmp_lg_u32 s48, 0
    s_cbranch_scc1 L_ct_100039
    s_branch L_cn_100038
L_cw_100046:
    s_mov_b32 s48, 200000
L_ct_100048:
    s_sleep 1
    ds_read_b32 v12, v27 offset:96
    s_waitcnt lgkmcnt(0)
    v_cmp_gt_u32 vcc, 11, v12
    s_cbranch_vccz L_cn_100047
    s_sub_u32 s48, s48, 1
    s_cmp_lg_u32 s48, 0
    s_cbranch_scc1 L_ct_100048
    s_branch L_cn_100047
L_cw_100049:
    s_mov_b32 s48, 200000
L_ct_100051:
    s_sleep 1
    ds_read_b32 v12, v27 offset:112
    s_waitcnt lgkmcnt(0)
    v_cmp_gt_u32 vcc, 10, v12
    s_cbranch_vccz L_cn_100050
    s_sub_u32 s48, s48, 1
    s_cmp_lg_u32 s48, 0
    s_cbranch_scc1 L_ct_100051
    s_branch L_cn_100050
L_cw_100052:
    s_mov_b32 s48, 200000
L_ct_100054:
    s_sleep 1
    ds_read_b32 v12, v27 offset:80
    s_waitcnt lgkmcnt(0)
    v_cmp_gt_u32 vcc, 20, v12
    s_cbranch_vccz L_cn_100053
    s_sub_u32 s48, s48, 1
    s_cmp_lg_u32 s48, 0
    s_cbranch_scc1 L_ct_100054
    s_branch L_cn_100053
L_cw_100055:
    s_mov_b32 s48, 200000
L_ct_100057:
    s_sleep 1
    ds_read_b32 v12, v26 offset:32
    s_waitcnt lgkmcnt(0)
    v_cmp_gt_u32 vcc, 1, v12
    s_cbranch_vccz L_cn_100056
    s_sub_u32 s48, s48, 1
    s_cmp_lg_u32 s48, 0
    s_cbranch_scc1 L_ct_100057
    s_branch L_cn_100056
L_cw_100058:
    s_mov_b32 s48, 200000
L_ct_100060:
    s_sleep 1
    ds_read_b32 v12, v27 offset:176
    s_waitcnt lgkmcnt(0)
    v_cmp_gt_u32 vcc, 3, v12
    s_cbranch_vccz L_cn_100059
    s_sub_u32 s48, s48, 1
    s_cmp_lg_u32 s48, 0
    s_cbranch_scc1 L_ct_100060
    s_branch L_cn_100059
L_cw_100061:
    s_mov_b32 s48, 200000
L_ct_100063:
    s_sleep 1
    ds_read_b32 v12, v27 offset:160
    s_waitcnt lgkmcnt(0)
    v_cmp_gt_u32 vcc, 2, v12
    s_cbranch_vccz L_cn_100062
    s_sub_u32 s48, s48, 1
    s_cmp_lg_u32 s48, 0
    s_cbranch_scc1 L_ct_100063
    s_branch L_cn_100062
L_cw_100064:
    s_mov_b32 s48, 200000
L_ct_100066:
    s_sleep 1
    ds_read_b32 v12, v26 offset:192
    s_waitcnt lgkmcnt(0)
    v_cmp_gt_u32 vcc, 1, v12
    s_cbranch_vccz L_cn_100065
    s_sub_u32 s48, s48, 1
    s_cmp_lg_u32 s48, 0
    s_cbranch_scc1 L_ct_100066
    s_branch L_cn_100065
L_cw_100070:
    s_mov_b32 s48, 200000
L_ct_100072:
    s_sleep 1
    ds_read_b32 v12, v27 offset:240
    s_waitcnt lgkmcnt(0)
    v_cmp_gt_u32 vcc, 1, v12
    s_cbranch_vccz L_cn_100071
    s_sub_u32 s48, s48, 1
    s_cmp_lg_u32 s48, 0
    s_cbranch_scc1 L_ct_100072
    s_branch L_cn_100071
L_cw_100075:
    s_mov_b32 s48, 200000
L_ct_100077:
    s_sleep 1
    ds_read_b32 v12, v27 offset:112
    s_waitcnt lgkmcnt(0)
    v_cmp_gt_u32 vcc, 11, v12
    s_cbranch_vccz L_cn_100076
    s_sub_u32 s48, s48, 1
    s_cmp_lg_u32 s48, 0
    s_cbranch_scc1 L_ct_100077
    s_branch L_cn_100076
L_cw_100078:
    s_mov_b32 s48, 200000
L_ct_100080:
    s_sleep 1
    ds_read_b32 v12, v27 offset:64
    s_waitcnt lgkmcnt(0)
    v_cmp_gt_u32 vcc, 1, v12
    s_cbranch_vccz L_cn_100079
    s_sub_u32 s48, s48, 1
    s_cmp_lg_u32 s48, 0
    s_cbranch_scc1 L_ct_100080
    s_branch L_cn_100079
L_cw_100081:
    s_mov_b32 s48, 200000
L_ct_100083:
    s_sleep 1
    ds_read_b32 v12, v27 offset:96
    s_waitcnt lgkmcnt(0)
    v_cmp_gt_u32 vcc, 13, v12
    s_cbranch_vccz L_cn_100082
    s_sub_u32 s48, s48, 1
    s_cmp_lg_u32 s48, 0
    s_cbranch_scc1 L_ct_100083
    s_branch L_cn_100082
L_cw_100084:
    s_mov_b32 s48, 200000
L_ct_100086:
    s_sleep 1
    ds_read_b32 v12, v27 offset:96
    s_waitcnt lgkmcnt(0)
    v_cmp_gt_u32 vcc, 16, v12
    s_cbranch_vccz L_cn_100085
    s_sub_u32 s48, s48, 1
    s_cmp_lg_u32 s48, 0
    s_cbranch_scc1 L_ct_100086
    s_branch L_cn_100085
L_cw_100087:
    s_mov_b32 s48, 200000
L_ct_100089:
    s_sleep 1
    ds_read_b32 v12, v27 offset:96
    s_waitcnt lgkmcnt(0)
    v_cmp_gt_u32 vcc, 18, v12
    s_cbranch_vccz L_cn_100088
    s_sub_u32 s48, s48, 1
    s_cmp_lg_u32 s48, 0
    s_cbranch_scc1 L_ct_100089
    s_branch L_cn_100088
L_cw_100090:
    s_mov_b32 s48, 200000
L_ct_100092:
    s_sleep 1
    ds_read_b32 v12, v27 offset:96
    s_waitcnt lgkmcnt(0)
    v_cmp_gt_u32 vcc, 21, v12
    s_cbranch_vccz L_cn_100091
    s_sub_u32 s48, s48, 1
    s_cmp_lg_u32 s48, 0
    s_cbranch_scc1 L_ct_100092
    s_branch L_cn_100091
L_cw_100093:
    s_mov_b32 s48, 200000
L_ct_100095:
    s_sleep 1
    ds_read_b32 v12, v27 offset:96
    s_waitcnt lgkmcnt(0)
    v_cmp_gt_u32 vcc, 23, v12
    s_cbranch_vccz L_cn_100094
    s_sub_u32 s48, s48, 1
    s_cmp_lg_u32 s48, 0
    s_cbranch_scc1 L_ct_100095
    s_branch L_cn_100094
L_cw_100096:
    s_mov_b32 s48, 200000
L_ct_100098:
    s_sleep 1
    ds_read_b32 v12, v27 offset:96
    s_waitcnt lgkmcnt(0)
    v_cmp_gt_u32 vcc, 26, v12
    s_cbranch_vccz L_cn_100097
    s_sub_u32 s48, s48, 1
    s_cmp_lg_u32 s48, 0
    s_cbranch_scc1 L_ct_100098
    s_branch L_cn_100097
L_cw_100099:
    s_mov_b32 s48, 200000
L_ct_100101:
    s_sleep 1
    ds_read_b32 v12, v27 offset:96
    s_waitcnt lgkmcnt(0)
    v_cmp_gt_u32 vcc, 28, v12
    s_cbranch_vccz L_cn_100100
    s_sub_u32 s48, s48, 1
    s_cmp_lg_u32 s48, 0
    s_cbranch_scc1 L_ct_100101
    s_branch L_cn_100100
L_cw_100102:
    s_mov_b32 s48, 200000
L_ct_100104:
    s_sleep 1
    ds_read_b32 v12, v27 offset:96
    s_waitcnt lgkmcnt(0)
    v_cmp_gt_u32 vcc, 31, v12
    s_cbranch_vccz L_cn_100103
    s_sub_u32 s48, s48, 1
    s_cmp_lg_u32 s48, 0
    s_cbranch_scc1 L_ct_100104
    s_branch L_cn_100103
L_cw_100105:
    s_mov_b32 s48, 200000
L_ct_100107:
    s_sleep 1
    ds_read_b32 v12, v27 offset:96
    s_waitcnt lgkmcnt(0)
    v_cmp_gt_u32 vcc, 32, v12
    s_cbranch_vccz L_cn_100106
    s_sub_u32 s48, s48, 1
    s_cmp_lg_u32 s48, 0
    s_cbranch_scc1 L_ct_100107
    s_branch L_cn_100106
L_cw_100108:
    s_mov_b32 s48, 200000
L_ct_100110:
    s_sleep 1
    ds_read_b32 v12, v27 offset:96
    s_waitcnt lgkmcnt(0)
    v_cmp_gt_u32 vcc, 33, v12
    s_cbranch_vccz L_cn_100109
    s_sub_u32 s48, s48, 1
    s_cmp_lg_u32 s48, 0
    s_cbranch_scc1 L_ct_100110
    s_branch L_cn_100109
L_cw_100111:
    s_mov_b32 s48, 200000
L_ct_100113:
    s_sleep 1
    ds_read_b32 v12, v27 offset:96
    s_waitcnt lgkmcnt(0)
    v_cmp_gt_u32 vcc, 34, v12
    s_cbranch_vccz L_cn_100112
    s_sub_u32 s48, s48, 1
    s_cmp_lg_u32 s48, 0
    s_cbranch_scc1 L_ct_100113
    s_branch L_cn_100112
L_cw_100114:
    s_mov_b32 s48, 200000
L_ct_100116:
    s_sleep 1
    ds_read_b32 v12, v27 offset:96
    s_waitcnt lgkmcnt(0)
    v_cmp_gt_u32 vcc, 36, v12
    s_cbranch_vccz L_cn_100115
    s_sub_u32 s48, s48, 1
    s_cmp_lg_u32 s48, 0
    s_cbranch_scc1 L_ct_100116
    s_branch L_cn_100115
L_cw_100117:
    s_mov_b32 s48, 200000
L_ct_100119:
    s_sleep 1
    ds_read_b32 v12, v27 offset:96
    s_waitcnt lgkmcnt(0)
    v_cmp_gt_u32 vcc, 40, v12
    s_cbranch_vccz L_cn_100118
    s_sub_u32 s48, s48, 1
    s_cmp_lg_u32 s48, 0
    s_cbranch_scc1 L_ct_100119
    s_branch L_cn_100118
L_cw_100120:
    s_mov_b32 s48, 200000
L_ct_100122:
    s_sleep 1
    ds_read_b32 v12, v27 offset:96
    s_waitcnt lgkmcnt(0)
    v_cmp_gt_u32 vcc, 44, v12
    s_cbranch_vccz L_cn_100121
    s_sub_u32 s48, s48, 1
    s_cmp_lg_u32 s48, 0
    s_cbranch_scc1 L_ct_100122
    s_branch L_cn_100121
L_cw_100123:
    s_mov_b32 s48, 200000
L_ct_100125:
    s_sleep 1
    ds_read_b32 v12, v27 offset:96
    s_waitcnt lgkmcnt(0)
    v_cmp_gt_u32 vcc, 48, v12
    s_cbranch_vccz L_cn_100124
    s_sub_u32 s48, s48, 1
    s_cmp_lg_u32 s48, 0
    s_cbranch_scc1 L_ct_100125
    s_branch L_cn_100124
L_cw_100126:
    s_mov_b32 s48, 200000
L_ct_100128:
    s_sleep 1
    ds_read_b32 v12, v27 offset:96
    s_waitcnt lgkmcnt(0)
    v_cmp_gt_u32 vcc, 52, v12
    s_cbranch_vccz L_cn_100127
    s_sub_u32 s48, s48, 1
    s_cmp_lg_u32 s48, 0
    s_cbranch_scc1 L_ct_100128
    s_branch L_cn_100127
L_cw_100129:
    s_mov_b32 s48, 200000
L_ct_100131:
    s_sleep 1
    ds_read_b32 v12, v27 offset:96
    s_waitcnt lgkmcnt(0)
    v_cmp_gt_u32 vcc, 56, v12
    s_cbranch_vccz L_cn_100130
    s_sub_u32 s48, s48, 1
    s_cmp_lg_u32 s48, 0
    s_cbranch_scc1 L_ct_100131
    s_branch L_cn_100130
L_cw_100132:
    s_mov_b32 s48, 200000
L_ct_100134:
    s_sleep 1
    ds_read_b32 v12, v27 offset:96
    s_waitcnt lgkmcnt(0)
    v_cmp_gt_u32 vcc, 59, v12
    s_cbranch_vccz L_cn_100133
    s_sub_u32 s48, s48, 1
    s_cmp_lg_u32 s48, 0
    s_cbranch_scc1 L_ct_100134
    s_branch L_cn_100133
L_cw_100135:
    s_mov_b32 s48, 200000
L_ct_100137:
    s_sleep 1
    ds_read_b32 v12, v27 offset:96
    s_waitcnt lgkmcnt(0)
    v_cmp_gt_u32 vcc, 62, v12
    s_cbranch_vccz L_cn_100136
    s_sub_u32 s48, s48, 1
    s_cmp_lg_u32 s48, 0
    s_cbranch_scc1 L_ct_100137
    s_branch L_cn_100136
L_cw_100138:
    s_mov_b32 s48, 200000
L_ct_100140:
    s_sleep 1
    ds_read_b32 v12, v27 offset:96
    s_waitcnt lgkmcnt(0)
    v_cmp_gt_u32 vcc, 65, v12
    s_cbranch_vccz L_cn_100139
    s_sub_u32 s48, s48, 1
    s_cmp_lg_u32 s48, 0
    s_cbranch_scc1 L_ct_100140
    s_branch L_cn_100139
L_cw_100141:
    s_mov_b32 s48, 200000
L_ct_100143:
    s_sleep 1
    ds_read_b32 v12, v27 offset:96
    s_waitcnt lgkmcnt(0)
    v_cmp_gt_u32 vcc, 68, v12
    s_cbranch_vccz L_cn_100142
    s_sub_u32 s48, s48, 1
    s_cmp_lg_u32 s48, 0
    s_cbranch_scc1 L_ct_100143
    s_branch L_cn_100142
L_cw_100144:
    s_mov_b32 s48, 200000
L_ct_100146:
    s_sleep 1
    ds_read_b32 v12, v27 offset:96
    s_waitcnt lgkmcnt(0)
    v_cmp_gt_u32 vcc, 71, v12
    s_cbranch_vccz L_cn_100145
    s_sub_u32 s48, s48, 1
    s_cmp_lg_u32 s48, 0
    s_cbranch_scc1 L_ct_100146
    s_branch L_cn_100145
L_cw_100147:
    s_mov_b32 s48, 200000
L_ct_100149:
    s_sleep 1
    ds_read_b32 v12, v27 offset:96
    s_waitcnt lgkmcnt(0)
    v_cmp_gt_u32 vcc, 76, v12
    s_cbranch_vccz L_cn_100148
    s_sub_u32 s48, s48, 1
    s_cmp_lg_u32 s48, 0
    s_cbranch_scc1 L_ct_100149
    s_branch L_cn_100148
L_cw_100150:
    s_mov_b32 s48, 200000
L_ct_100152:
    s_sleep 1
    ds_read_b32 v12, v27 offset:96
    s_waitcnt lgkmcnt(0)
    v_cmp_gt_u32 vcc, 81, v12
    s_cbranch_vccz L_cn_100151
    s_sub_u32 s48, s48, 1
    s_cmp_lg_u32 s48, 0
    s_cbranch_scc1 L_ct_100152
    s_branch L_cn_100151
L_cw_100153:
    s_mov_b32 s48, 200000
L_ct_100155:
    s_sleep 1
    ds_read_b32 v12, v27 offset:96
    s_waitcnt lgkmcnt(0)
    v_cmp_gt_u32 vcc, 86, v12
    s_cbranch_vccz L_cn_100154
    s_sub_u32 s48, s48, 1
    s_cmp_lg_u32 s48, 0
    s_cbranch_scc1 L_ct_100155
    s_branch L_cn_100154
L_cw_100156:
    s_mov_b32 s48, 200000
L_ct_100158:
    s_sleep 1
    ds_read_b32 v12, v27 offset:96
    s_waitcnt lgkmcnt(0)
    v_cmp_gt_u32 vcc, 91, v12
    s_cbranch_vccz L_cn_100157
    s_sub_u32 s48, s48, 1
    s_cmp_lg_u32 s48, 0
    s_cbranch_scc1 L_ct_100158
    s_branch L_cn_100157
L_cw_100159:
    s_mov_b32 s48, 200000
L_ct_100161:
    s_sleep 1
    ds_read_b32 v12, v27 offset:96
    s_waitcnt lgkmcnt(0)
    v_cmp_gt_u32 vcc, 96, v12
    s_cbranch_vccz L_cn_100160
    s_sub_u32 s48, s48, 1
    s_cmp_lg_u32 s48, 0
    s_cbranch_scc1 L_ct_100161
    s_branch L_cn_100160
L_cw_100162:
    s_mov_b32 s48, 200000
L_ct_100164:
    s_sleep 1
    ds_read_b32 v12, v27 offset:96
    s_waitcnt lgkmcnt(0)
    v_cmp_gt_u32 vcc, 101, v12
    s_cbranch_vccz L_cn_100163
    s_sub_u32 s48, s48, 1
    s_cmp_lg_u32 s48, 0
    s_cbranch_scc1 L_ct_100164
    s_branch L_cn_100163
.p2align 6
L_compute:
    v_lshlrev_b32 v3, 4, v2
    v_lshlrev_b32 v4, 2, v2
    v_mov_b32 v11, 0
    v_add_u32 v8, 159744, v4
    ds_write_b32 v8, v11
    ds_write_b32 v8, v11 offset:768
    s_waitcnt lgkmcnt(0)
    s_load_dwordx2 s[32:33], s[22:23], 0
    s_mov_b32 s24, s22
    s_and_b32 s25, s23, 0xffff
    s_mov_b32 s26, 268435456
    s_mov_b32 s27, 0x20000
    s_getpc_b64 s[96:97]
L_pcC:
    s_sub_u32 s96, s96, L_pcC-sequential_preLN__linear_kernel_hedgehog__dense_activation_relu__prompt_kernel
    s_subb_u32 s97, s97, 0
    s_lshr_b32 s38, s2, 3
    s_lshl_b32 s38, s38, 11
    s_lshl_b32 s39, s36, 9
    s_add_u32 s38, s38, s39
    v_and_b32 v8, 3, v2
    v_lshlrev_b32 v8, 7, v8
    v_add_u32 v0, s38, v8
    v_min_u32 v0, L_last-sequential_preLN__linear_kernel_hedgehog__dense_activation_relu__prompt_kernel, v0
    global_load_dword v28, v0, s[96:97]
    v_lshlrev_b32 v3, 4, v2
    v_lshlrev_b32 v4, 2, v2
    v_lshlrev_b32 v5, 3, v2
    v_lshrrev_b32 v6, 4, v2
    v_and_b32 v7, 15, v2
    v_mov_b32 v11, 0
    s_getreg_b32 s50, hwreg(HW_REG_XCC_ID)
    s_lshl_b32 s53, s36, 10
    s_lshl_b32 s56, s34, 4
    s_add_u32 s56, s56, s35
    s_mul_i32 s56, s56, 128
    s_add_u32 s56, s56, 65536
    s_lshl_b32 s38, s34, 3
    s_lshl_b32 s39, s36, 1
    s_add_u32 s57, s38, s39
    s_and_b32 s58, s35, 7
    s_lshr_b32 s59, s35, 3
    s_lshl_b32 s40, s59, 2
    s_add_u32 s60, s38, s40
    s_add_u32 s60, s60, s36
    s_mul_i32 s64, s58, 102400
    s_add_u32 s64, s64, 1048576
    s_add_u32 s64, s64, s53
    s_mul_i32 s65, s35, 143360
    s_add_u32 s65, s65, 1900544
    s_add_u32 s65, s65, s53
    s_mul_i32 s66, s58, 276480
    s_add_u32 s66, s66, 4194304
    s_add_u32 s66, s66, s53
    s_xor_b32 s69, s35, 1
    s_mul_i32 s38, s57, 20480
    s_add_u32 s38, s38, 6422528
    s_lshl_b32 s39, s69, 10
    s_add_u32 s67, s38, s39
    s_lshl_b32 s39, s69, 8
    s_add_u32 s68, s38, s39
    s_add_u32 s68, s68, 16384
    s_mul_i32 s61, s35, 32768
    s_add_u32 s61, s61, 18874368
    v_mov_b32 v8, 0x3f803f80
    v_accvgpr_write_b32 a0, v8
    v_accvgpr_write_b32 a1, v8
    v_accvgpr_write_b32 a2, v8
    v_accvgpr_write_b32 a3, v8
    v_lshrrev_b32 v8, 1, v7
    v_xor_b32 v8, v8, v6
    v_lshlrev_b32 v8, 4, v8
    v_lshl_add_u32 v8, v7, 7, v8
    v_add_u32 v21, s63, v8
    v_xor_b32 v22, 64, v21
    v_bfe_u32 v25, v2, 2, 3
    v_and_b32 v8, 32, v2
    v_lshrrev_b32 v8, 1, v8
    v_add_u32 v25, v25, v8
    v_and_b32 v9, 3, v2
    v_mul_u32_u24 v8, 160, v25
    v_lshl_add_u32 v23, v9, 3, v8
    v_mul_u32_u24 v9, 40, v9
    v_add3_u32 v24, v8, v9, 32
    s_lshl_b32 s38, s36, 2
    s_add_u32 s38, s38, 159744
    v_mov_b32 v26, s38
    v_and_b32 v8, 3, v2
    v_lshlrev_b32 v8, 2, v8
    v_add_u32 v27, 159744, v8
    s_mov_b32 s76, s8
    s_and_b32 s77, s9, 0xffff
    s_mov_b32 s78, 25600
    s_mov_b32 s79, 0x20000
    s_mov_b32 s28, s4
    s_and_b32 s29, s5, 0xffff
    s_mov_b32 s30, 2621440
    s_mov_b32 s31, 0x20000
    s_mov_b32 s72, s18
    s_and_b32 s73, s19, 0xffff
    s_mov_b32 s74, 2621440
    s_mov_b32 s75, 0x20000
    s_lshr_b32 s38, s35, 1
    s_mul_i32 s38, s38, 3200
    s_add_u32 s38, s38, s53
    s_add_u32 m0, s53, 40960
    s_nop 0
    buffer_load_dwordx4 v3, s[76:79], s38 offen lds
    v_mov_b32 v30, 0
    v_mov_b32 v31, 0
    v_mov_b32 v32, 0
    v_mov_b32 v33, 0
    s_lshl_b32 s39, s34, 11
    s_add_u32 s38, s61, s39
    s_cmp_eq_u32 s36, 3
    s_cselect_b32 s38, s38, 0x40000000
    buffer_store_dwordx4 v[30:33], v3, s[24:27], s38 offen sc1
    buffer_store_dwordx4 v[30:33], v3, s[24:27], s38 offen offset:1024 sc1
    s_and_b32 s38, s35, 7
    s_lshl_b32 s38, s38, 2
    s_mov_b32 s39, 0x3b2a9180
    s_lshr_b32 s39, s39, s38
    s_and_b32 s39, s39, 15
    s_lshr_b32 s40, s35, 3
    s_lshl_b32 s40, s40, 2
    s_add_u32 s40, s40, s39
    s_lshl_b32 s40, s40, 4
    s_add_u32 s78, s40, s34
    s_cmp_ge_u32 s78, 80
    s_cbranch_scc1 L_u_wo
    s_mov_b32 s80, s16
    s_and_b32 s81, s17, 0xffff
    s_mov_b32 s82, 2211840
    s_mov_b32 s83, 0x20000
    s_and_b32 s70, s78, 7
    s_lshr_b32 s71, s78, 3
    s_mov_b32 s76, 1280
    s_mov_b32 s79, 7
    s_mul_i32 s77, s70, 286720
    s_cmp_eq_u32 s70, 7
    s_cselect_b32 s77, 1966080, s77
    s_branch L_u_go
L_u_wo:
    s_cmp_ge_u32 s78, 120
    s_cbranch_scc1 L_u_w1
    s_mov_b32 s80, s10
    s_and_b32 s81, s11, 0xffff
    s_mov_b32 s82, 819200
    s_mov_b32 s83, 0x20000
    s_sub_u32 s38, s78, 80
    s_and_b32 s70, s38, 3
    s_lshr_b32 s71, s38, 2
    s_mov_b32 s76, 1280
    s_mul_i32 s77, s70, 204800
    s_mov_b32 s79, 5
    s_branch L_u_go
L_u_w1:
    s_mov_b32 s80, s14
    s_and_b32 s81, s15, 0xffff
    s_mov_b32 s82, 2211840
    s_mov_b32 s83, 0x20000
    s_sub_u32 s38, s78, 120
    s_and_b32 s70, s38, 3
    s_lshr_b32 s71, s38, 2
    s_mov_b32 s76, 3456
    s_mul_i32 s77, s70, 552960
    s_mov_b32 s79, 5
L_u_go:
    s_mul_i32 s38, s60, 20480
    s_add_u32 s38, s38, 9043968
    s_lshl_b32 s39, s58, 10
    s_add_u32 s84, s38, s39
    s_lshl_b32 s39, s58, 9
    s_add_u32 s85, s38, s39
    s_add_u32 s85, s85, 16384
    s_lshl_b32 s38, s60, 10
    s_lshl_b32 s39, s58, 7
    s_add_u32 s86, s38, s39
    s_add_u32 s86, s86, 458752
    s_mul_i32 s38, s57, 55296
    s_add_u32 s38, s38, 11665408
    s_lshl_b32 s39, s35, 10
    s_add_u32 s87, s38, s39
    s_lshl_b32 s39, s35, 9
    s_add_u32 s88, s38, s39
    s_add_u32 s88, s88, 49152
    s_cmp_ge_u32 s35, 12
    s_cselect_b32 s88, 0x40000000, s88
    s_barrier
    s_waitcnt lgkmcnt(0)
    v_mov_b32 v30, s32
    v_mov_b32 v31, s33
    v_mov_b32 v32, s32
    v_mov_b32 v33, s33
    v_lshrrev_b32 v8, 3, v2
    v_add_u32 v8, 1, v8
    v_lshlrev_b32 v8, 15, v8
    v_and_b32 v9, 7, v2
    v_lshl_add_u32 v8, v9, 4, v8
    s_cmp_eq_u32 s36, 3
    s_cselect_b32 s38, s56, 0x40000000
    s_mov_b32 exec_lo, 0xffffffff
    s_mov_b32 exec_hi, 0x0
    buffer_store_dwordx4 v[30:33], v8, s[24:27], s38 offen sc1
    s_mov_b64 exec, -1
    s_nop 1
    s_add_u32 s32, s32, 1
    s_addc_u32 s33, s33, 0
    v_mov_b32 v16, s32
    v_mov_b32 v17, s33
    v_mov_b32 v18, s50
    v_mov_b32 v19, 0
    s_waitcnt vmcnt(0)
    v_mov_b32 v10, 1
    ds_write_b32 v26, v10 offset:176
    s_cmp_lg_u32 s36, 3
    s_cbranch_scc1 L_pub_1
    s_add_u32 s45, s56, 163840
    s_mov_b64 exec, 1
    buffer_store_dwordx4 v[16:19], v11, s[24:27], s45 offen sc1
    s_mov_b64 exec, -1
L_pub_1:
    s_cmp_ge_u32 s78, 228
    s_cbranch_scc1 L_cd_2
    s_lshl_b32 s38, s71, 7
    s_add_u32 s77, s77, s38
    v_lshrrev_b32 v8, 3, v2
    v_mul_lo_u32 v8, v8, s76
    v_and_b32 v9, 7, v2
    v_lshl_add_u32 v8, v9, 4, v8
    s_lshl_b32 s42, s76, 3
    s_mul_i32 s38, s42, s36
    s_add_u32 s38, s38, s77
    s_lshl_b32 s42, s42, 2
    s_add_u32 m0, s53, 126976
    s_nop 0
    buffer_load_dwordx4 v8, s[80:83], s38 offen nt lds
    s_add_u32 s38, s38, s42
    s_add_u32 m0, s53, 131072
    s_nop 0
    buffer_load_dwordx4 v8, s[80:83], s38 offen nt lds
    s_add_u32 s38, s38, s42
    s_add_u32 m0, s53, 135168
    s_nop 0
    buffer_load_dwordx4 v8, s[80:83], s38 offen nt lds
    s_add_u32 s38, s38, s42
    s_add_u32 m0, s53, 139264
    s_nop 0
    buffer_load_dwordx4 v8, s[80:83], s38 offen nt lds
    s_add_u32 s38, s38, s42
    s_add_u32 m0, s53, 143360
    s_nop 0
    buffer_load_dwordx4 v8, s[80:83], s38 offen nt lds
    s_add_u32 s38, s38, s42
    s_add_u32 m0, s53, 147456
    s_cmp_eq_u32 s79, 5
    s_cbranch_scc1 L_p2few
    buffer_load_dwordx4 v8, s[80:83], s38 offen nt lds
    s_add_u32 s38, s38, s42
    s_add_u32 m0, s53, 151552
    s_nop 0
    buffer_load_dwordx4 v8, s[80:83], s38 offen nt lds
L_p2few:
L_cd_2:
    s_nop 1
    ds_read_b32 v12, v27 offset:176
    s_waitcnt lgkmcnt(0)
    v_cmp_gt_u32 vcc, 1, v12
    s_cbranch_vccnz L_cw_3
L_cn_4:
    s_lshr_b32 s38, s36, 1
    s_and_b32 s39, s36, 1
    v_lshrrev_b32 v8, 2, v7
    v_add_u32 v8, 16, v8
    s_cmp_eq_u32 s39, 0
    s_cselect_b32 s46, -1, 0
    s_mov_b32 s47, s46
    v_cndmask_b32_e64 v8, v8, v7, s[46:47]
    v_lshlrev_b32 v8, 1, v8
    s_and_b32 s41, s35, 1
    s_mul_i32 s41, s41, 1600
    s_mul_i32 s40, s38, 800
    s_add_u32 s40, s40, 40960
    s_add_u32 s40, s40, s41
    v_add_u32 v29, s40, v8
    v_mul_u32_u24 v9, 160, v6
    v_add_u32 v25, v29, v9
    ds_read_u16 v30, v25
    ds_read_u16 v31, v25 offset:40
    ds_read_u16 v32, v25 offset:80
    ds_read_u16 v33, v25 offset:120
    ds_read_u16 v34, v29 offset:640
    ds_read_u16 v35, v29 offset:680
    ds_read_u16 v36, v29 offset:720
    ds_read_u16 v37, v29 offset:760
    s_waitcnt lgkmcnt(0)
    v_lshl_or_b32 v38, v31, 16, v30
    v_lshl_or_b32 v39, v33, 16, v32
    v_lshl_or_b32 v40, v35, 16, v34
    v_lshl_or_b32 v41, v37, 16, v36
    v_cmp_eq_u32 vcc, s38, v6
    s_nop 1
    v_cndmask_b32 v40, 0, v40, vcc
    v_cndmask_b32 v41, 0, v41, vcc
    v_and_b32 v9, 3, v7
    v_cmp_eq_u32 vcc, s38, v9
    s_nop 0
    s_or_b64 vcc, vcc, s[46:47]
    v_cndmask_b32 v38, 0, v38, vcc
    v_cndmask_b32 v39, 0, v39, vcc
    v_cndmask_b32 v40, 0, v40, vcc
    v_cndmask_b32 v41, 0, v41, vcc
    s_add_u32 s40, s53, 155648
    v_add_u32 v8, s40, v3
    ds_write_b128 v8, v[38:41]
    s_lshr_b32 s38, s36, 1
    s_and_b32 s39, s36, 1
    v_lshrrev_b32 v8, 2, v7
    v_add_u32 v8, 16, v8
    s_cmp_eq_u32 s39, 0
    s_cselect_b32 s46, -1, 0
    s_mov_b32 s47, s46
    v_cndmask_b32_e64 v8, v8, v7, s[46:47]
    v_lshlrev_b32 v8, 1, v8
    s_and_b32 s41, s69, 1
    s_mul_i32 s41, s41, 1600
    s_mul_i32 s40, s38, 800
    s_add_u32 s40, s40, 40960
    s_add_u32 s40, s40, s41
    v_add_u32 v29, s40, v8
    v_mul_u32_u24 v9, 160, v6
    v_add_u32 v25, v29, v9
    ds_read_u16 v30, v25
    ds_read_u16 v31, v25 offset:40
    ds_read_u16 v32, v25 offset:80
    ds_read_u16 v33, v25 offset:120
    ds_read_u16 v34, v29 offset:640
    ds_read_u16 v35, v29 offset:680
    ds_read_u16 v36, v29 offset:720
    ds_read_u16 v37, v29 offset:760
    s_waitcnt lgkmcnt(0)
    v_lshl_or_b32 v38, v31, 16, v30
    v_lshl_or_b32 v39, v33, 16, v32
    v_lshl_or_b32 v40, v35, 16, v34
    v_lshl_or_b32 v41, v37, 16, v36
    v_cmp_eq_u32 vcc, s38, v6
    s_nop 1
    v_cndmask_b32 v40, 0, v40, vcc
    v_cndmask_b32 v41, 0, v41, vcc
    v_and_b32 v9, 3, v7
    v_cmp_eq_u32 vcc, s38, v9
    s_nop 0
    s_or_b64 vcc, vcc, s[46:47]
    v_cndmask_b32 v38, 0, v38, vcc
    v_cndmask_b32 v39, 0, v39, vcc
    v_cndmask_b32 v40, 0, v40, vcc
    v_cndmask_b32 v41, 0, v41, vcc
    v_mov_b32 v10, 2
    ds_write_b32 v26, v10 offset:176
    ds_read_b32 v12, v27 offset:80
    s_waitcnt lgkmcnt(0)
    v_cmp_gt_u32 vcc, 2, v12
    s_cbranch_vccnz L_cw_6
L_cn_7:
    ds_read_b128 a[44:47], v21
    ds_read_b128 a[48:51], v21 offset:2048
    ds_read_b128 a[52:55], v22
    ds_read_b128 a[56:59], v22 offset:2048
    ds_read_b64_tr_b16 a[4:5], v23
    ds_read_b64_tr_b16 a[6:7], v23 offset:1280
    ds_read_b64_tr_b16 a[8:9], v23 offset:40
    ds_read_b64_tr_b16 a[10:11], v23 offset:1320
    ds_read_b64_tr_b16 a[12:13], v24
    ds_read_b64_tr_b16 a[14:15], v24 offset:1280
    ds_read_b64_tr_b16 a[16:17], v23 offset:80
    ds_read_b64_tr_b16 a[18:19], v23 offset:1360
    ds_read_b64_tr_b16 a[20:21], v23 offset:120
    ds_read_b64_tr_b16 a[22:23], v23 offset:1400
    s_waitcnt lgkmcnt(10)
    v_mov_b32 v10, 1
    ds_write_b32 v26, v10 offset:96
    ds_read_b32 v12, v27 offset:80
    s_waitcnt lgkmcnt(0)
    v_cmp_gt_u32 vcc, 3, v12
    s_cbranch_vccnz L_cw_9
L_cn_10:
    ds_read_b128 a[60:63], v21 offset:16384
    ds_read_b128 a[64:67], v21 offset:18432
    ds_read_b128 a[68:71], v22 offset:16384
    ds_read_b128 a[72:75], v22 offset:18432
    v_mfma_f32_16x16x32_bf16 v[30:33], a[4:7], a[44:47], 0
    v_mfma_f32_16x16x32_bf16 v[54:57], a[4:7], a[48:51], 0
    ds_read_b64_tr_b16 a[24:25], v23 offset:5120
    ds_read_b64_tr_b16 a[26:27], v23 offset:6400
    v_mfma_f32_16x16x32_bf16 v[34:37], a[8:11], a[44:47], 0
    v_mfma_f32_16x16x32_bf16 v[58:61], a[8:11], a[48:51], 0
    ds_read_b64_tr_b16 a[28:29], v23 offset:5160
    ds_read_b64_tr_b16 a[30:31], v23 offset:6440
    v_mfma_f32_16x16x32_bf16 v[42:45], a[12:15], a[44:47], 0
    v_mfma_f32_16x16x32_bf16 v[62:65], a[12:15], a[48:51], 0
    ds_read_b64_tr_b16 a[32:33], v24 offset:5120
    ds_read_b64_tr_b16 a[34:35], v24 offset:6400
    v_mfma_f32_16x16x32_bf16 v[46:49], a[16:19], a[44:47], 0
    v_mfma_f32_16x16x32_bf16 v[66:69], a[16:19], a[48:51], 0
    ds_read_b64_tr_b16 a[36:37], v23 offset:5200
    ds_read_b64_tr_b16 a[38:39], v23 offset:6480
    v_mfma_f32_16x16x32_bf16 v[50:53], a[20:23], a[44:47], 0
    v_mfma_f32_16x16x32_bf16 v[70:73], a[20:23], a[48:51], 0
    ds_read_b64_tr_b16 a[40:41], v23 offset:5240
    ds_read_b64_tr_b16 a[42:43], v23 offset:6520
    s_waitcnt lgkmcnt(8)
    v_mfma_f32_16x16x32_bf16 v[30:33], a[24:27], a[52:55], v[30:33]
    v_mfma_f32_16x16x32_bf16 v[54:57], a[24:27], a[56:59], v[54:57]
    ds_read_b64_tr_b16 a[4:5], v23 offset:10240
    ds_read_b64_tr_b16 a[6:7], v23 offset:11520
    s_waitcnt lgkmcnt(8)
    v_mfma_f32_16x16x32_bf16 v[34:37], a[28:31], a[52:55], v[34:37]
    v_mfma_f32_16x16x32_bf16 v[58:61], a[28:31], a[56:59], v[58:61]
    ds_read_b64_tr_b16 a[8:9], v23 offset:10280
    ds_read_b64_tr_b16 a[10:11], v23 offset:11560
    s_waitcnt lgkmcnt(8)
    v_mfma_f32_16x16x32_bf16 v[42:45], a[32:35], a[52:55], v[42:45]
    v_mfma_f32_16x16x32_bf16 v[62:65], a[32:35], a[56:59], v[62:65]
    ds_read_b64_tr_b16 a[12:13], v24 offset:10240
    ds_read_b64_tr_b16 a[14:15], v24 offset:11520
    ds_read_b32 v12, v27 offset:80
    s_waitcnt lgkmcnt(9)
    v_mfma_f32_16x16x32_bf16 v[46:49], a[36:39], a[52:55], v[46:49]
    v_mfma_f32_16x16x32_bf16 v[66:69], a[36:39], a[56:59], v[66:69]
    ds_read_b64_tr_b16 a[16:17], v23 offset:10320
    ds_read_b64_tr_b16 a[18:19], v23 offset:11600
    s_waitcnt lgkmcnt(9)
    v_mfma_f32_16x16x32_bf16 v[50:53], a[40:43], a[52:55], v[50:53]
    v_mfma_f32_16x16x32_bf16 v[70:73], a[40:43], a[56:59], v[70:73]
    ds_read_b64_tr_b16 a[20:21], v23 offset:10360
    ds_read_b64_tr_b16 a[22:23], v23 offset:11640
    v_mov_b32 v10, 2
    ds_write_b32 v26, v10 offset:96
    s_waitcnt lgkmcnt(5)
    v_cmp_gt_u32 vcc, 5, v12
    s_cbranch_vccnz L_cw_12
L_cn_13:
    ds_read_b128 a[44:47], v21 offset:32768
    ds_read_b128 a[48:51], v21 offset:34816
    ds_read_b128 a[52:55], v22 offset:32768
    ds_read_b128 a[56:59], v22 offset:34816
    s_waitcnt vmcnt(0)
    v_mov_b32 v10, 1
    ds_write_b32 v26, v10 offset:128
    v_mfma_f32_16x16x32_bf16 v[30:33], a[4:7], a[60:63], v[30:33]
    v_mfma_f32_16x16x32_bf16 v[54:57], a[4:7], a[64:67], v[54:57]
    ds_read_b64_tr_b16 a[24:25], v23 offset:15360
    ds_read_b64_tr_b16 a[26:27], v23 offset:16640
    v_mfma_f32_16x16x32_bf16 v[34:37], a[8:11], a[60:63], v[34:37]
    v_mfma_f32_16x16x32_bf16 v[58:61], a[8:11], a[64:67], v[58:61]
    ds_read_b64_tr_b16 a[28:29], v23 offset:15400
    ds_read_b64_tr_b16 a[30:31], v23 offset:16680
    v_mfma_f32_16x16x32_bf16 v[42:45], a[12:15], a[60:63], v[42:45]
    v_mfma_f32_16x16x32_bf16 v[62:65], a[12:15], a[64:67], v[62:65]
    ds_read_b64_tr_b16 a[32:33], v24 offset:15360
    ds_read_b64_tr_b16 a[34:35], v24 offset:16640
    s_waitcnt lgkmcnt(14)
    v_mfma_f32_16x16x32_bf16 v[46:49], a[16:19], a[60:63], v[46:49]
    v_mfma_f32_16x16x32_bf16 v[66:69], a[16:19], a[64:67], v[66:69]
    ds_read_b64_tr_b16 a[36:37], v23 offset:15440
    ds_read_b64_tr_b16 a[38:39], v23 offset:16720
    s_waitcnt lgkmcnt(14)
    v_mfma_f32_16x16x32_bf16 v[50:53], a[20:23], a[60:63], v[50:53]
    v_mfma_f32_16x16x32_bf16 v[70:73], a[20:23], a[64:67], v[70:73]
    ds_read_b64_tr_b16 a[40:41], v23 offset:15480
    ds_read_b64_tr_b16 a[42:43], v23 offset:16760
    s_waitcnt lgkmcnt(8)
    v_mfma_f32_16x16x32_bf16 v[30:33], a[24:27], a[68:71], v[30:33]
    v_mfma_f32_16x16x32_bf16 v[54:57], a[24:27], a[72:75], v[54:57]
    ds_read_b64_tr_b16 a[4:5], v23 offset:20480
    ds_read_b64_tr_b16 a[6:7], v23 offset:21760
    s_waitcnt lgkmcnt(8)
    v_mfma_f32_16x16x32_bf16 v[34:37], a[28:31], a[68:71], v[34:37]
    v_mfma_f32_16x16x32_bf16 v[58:61], a[28:31], a[72:75], v[58:61]
    ds_read_b64_tr_b16 a[8:9], v23 offset:20520
    ds_read_b64_tr_b16 a[10:11], v23 offset:21800
    s_waitcnt lgkmcnt(8)
    v_mfma_f32_16x16x32_bf16 v[42:45], a[32:35], a[68:71], v[42:45]
    v_mfma_f32_16x16x32_bf16 v[62:65], a[32:35], a[72:75], v[62:65]
    ds_read_b64_tr_b16 a[12:13], v24 offset:20480
    ds_read_b64_tr_b16 a[14:15], v24 offset:21760
    ds_read_b32 v12, v27 offset:80
    s_waitcnt lgkmcnt(9)
    v_mfma_f32_16x16x32_bf16 v[46:49], a[36:39], a[68:71], v[46:49]
    v_mfma_f32_16x16x32_bf16 v[66:69], a[36:39], a[72:75], v[66:69]
    ds_read_b64_tr_b16 a[16:17], v23 offset:20560
    ds_read_b64_tr_b16 a[18:19], v23 offset:21840
    s_waitcnt lgkmcnt(9)
    v_mfma_f32_16x16x32_bf16 v[50:53], a[40:43], a[68:71], v[50:53]
    v_mfma_f32_16x16x32_bf16 v[70:73], a[40:43], a[72:75], v[70:73]
    ds_read_b64_tr_b16 a[20:21], v23 offset:20600
    ds_read_b64_tr_b16 a[22:23], v23 offset:21880
    v_mov_b32 v10, 3
    ds_write_b32 v26, v10 offset:96
    s_waitcnt lgkmcnt(5)
    v_cmp_gt_u32 vcc, 6, v12
    s_cbranch_vccnz L_cw_15
L_cn_16:
    ds_read_b128 a[60:63], v21 offset:49152
    ds_read_b128 a[64:67], v21 offset:51200
    ds_read_b128 a[68:71], v22 offset:49152
    ds_read_b128 a[72:75], v22 offset:51200
    s_cmp_ge_u32 s78, 228
    s_cbranch_scc1 L_cd_18
    ds_read_b32 v12, v27 offset:128
    s_waitcnt lgkmcnt(0)
    v_cmp_gt_u32 vcc, 1, v12
    s_cbranch_vccnz L_cw_19
L_cn_20:
    v_lshrrev_b32 v8, 2, v2
    v_lshlrev_b32 v8, 7, v8
    v_and_b32 v9, 3, v2
    v_lshl_add_u32 v25, v9, 3, v8
    s_lshl_b32 s38, s36, 5
    s_add_u32 s38, s38, 126976
    v_add_u32 v25, s38, v25
    s_lshl_b32 s39, s71, 2
    s_add_u32 s39, s39, s36
    s_cmp_lt_u32 s78, 80
    s_cbranch_scc1 L_p_w2
    s_cmp_lt_u32 s78, 120
    s_cbranch_scc1 L_p_wo
    ds_read_b64_tr_b16 v[74:75], v25
    ds_read_b64_tr_b16 v[76:77], v25 offset:2048
    ds_read_b64_tr_b16 v[78:79], v25 offset:4096
    ds_read_b64_tr_b16 v[80:81], v25 offset:6144
    ds_read_b64_tr_b16 v[82:83], v25 offset:10240
    ds_read_b64_tr_b16 v[84:85], v25 offset:12288
    ds_read_b64_tr_b16 v[86:87], v25 offset:14336
    ds_read_b64_tr_b16 v[88:89], v25 offset:16384
    ds_read_b64_tr_b16 v[90:91], v25 offset:8192
    ds_read_b64_tr_b16 v[92:93], v25 offset:18432
    s_mul_i32 s40, s39, 9363
    s_lshr_b32 s40, s40, 16
    s_mul_i32 s41, s40, 7
    s_sub_u32 s41, s39, s41
    s_sub_u32 s42, s39, 84
    s_mul_i32 s43, s42, 10923
    s_lshr_b32 s43, s43, 16
    s_mul_i32 s44, s43, 6
    s_sub_u32 s42, s42, s44
    s_add_u32 s43, s43, 12
    s_cmp_ge_u32 s39, 84
    s_cselect_b32 s40, s43, s40
    s_cselect_b32 s41, s42, s41
    s_mul_i32 s40, s40, 143360
    s_add_u32 s40, s40, 1900544
    s_add_u32 s43, s41, 76
    s_cmp_lt_u32 s41, 4
    s_cselect_b32 s43, s41, s43
    s_cselect_b32 s44, 4, 3
    s_lshl_b32 s43, s43, 10
    s_add_u32 s40, s40, s43
    s_lshl_b32 s43, s44, 10
    s_waitcnt lgkmcnt(0)
    s_lshl_b32 s41, s70, 1
    s_add_u32 s41, s41, 0
    s_mul_i32 s41, s41, s43
    s_add_u32 s41, s41, s40
    buffer_store_dwordx4 v[74:77], v3, s[24:27], s41 offen sc1
    v_mfma_f32_16x16x32_bf16 v[102:105], v[74:77], a[0:3], 0
    s_lshl_b32 s41, s70, 1
    s_add_u32 s41, s41, 8
    s_mul_i32 s41, s41, s43
    s_add_u32 s41, s41, s40
    buffer_store_dwordx4 v[78:81], v3, s[24:27], s41 offen sc1
    v_mfma_f32_16x16x32_bf16 v[102:105], v[78:81], a[0:3], v[102:105]
    s_lshl_b32 s41, s70, 1
    s_add_u32 s41, s41, 1
    s_mul_i32 s41, s41, s43
    s_add_u32 s41, s41, s40
    buffer_store_dwordx4 v[82:85], v3, s[24:27], s41 offen sc1
    v_mfma_f32_16x16x32_bf16 v[102:105], v[82:85], a[0:3], v[102:105]
    s_lshl_b32 s41, s70, 1
    s_add_u32 s41, s41, 9
    s_mul_i32 s41, s41, s43
    s_add_u32 s41, s41, s40
    buffer_store_dwordx4 v[86:89], v3, s[24:27], s41 offen sc1
    v_mfma_f32_16x16x32_bf16 v[102:105], v[86:89], a[0:3], v[102:105]
    s_add_u32 s41, s70, 16
    s_mul_i32 s41, s41, s43
    s_add_u32 s41, s41, s40
    buffer_store_dwordx4 v[90:93], v3, s[24:27], s41 offen sc1
    v_mfma_f32_16x16x32_bf16 v[102:105], v[90:93], a[0:3], v[102:105]
    s_lshl_b32 s41, s70, 13
    s_lshl_b32 s42, s39, 6
    s_add_u32 s41, s41, s42
    s_add_u32 s41, s41, 393216
    v_lshlrev_b32 v8, 4, v6
    s_mov_b32 exec_lo, 0x10001
    s_mov_b32 exec_hi, 0x10001
    s_nop 0
    buffer_store_dwordx4 v[102:105], v8, s[24:27], s41 offen sc1
    s_mov_b64 exec, -1
    s_branch L_p_done
L_p_w2:
    s_mul_i32 s40, s39, 13108
    s_lshr_b32 s40, s40, 16
    s_mul_i32 s41, s40, 5
    s_sub_u32 s41, s39, s41
    s_mul_i32 s40, s40, 276480
    s_add_u32 s40, s40, 4194304
    s_lshl_b32 s41, s41, 10
    s_add_u32 s40, s40, s41
    s_cmp_ge_u32 s70, 6
    s_cbranch_scc1 L_p_w2b
    ds_read_b64_tr_b16 v[74:75], v25
    ds_read_b64_tr_b16 v[76:77], v25 offset:2048
    ds_read_b64_tr_b16 v[78:79], v25 offset:4096
    ds_read_b64_tr_b16 v[80:81], v25 offset:6144
    ds_read_b64_tr_b16 v[82:83], v25 offset:8192
    ds_read_b64_tr_b16 v[84:85], v25 offset:10240
    ds_read_b64_tr_b16 v[86:87], v25 offset:14336
    ds_read_b64_tr_b16 v[88:89], v25 offset:16384
    ds_read_b64_tr_b16 v[90:91], v25 offset:18432
    ds_read_b64_tr_b16 v[92:93], v25 offset:20480
    ds_read_b64_tr_b16 v[94:95], v25 offset:22528
    ds_read_b64_tr_b16 v[96:97], v25 offset:24576
    ds_read_b64_tr_b16 v[98:99], v25 offset:12288
    ds_read_b64_tr_b16 v[100:101], v25 offset:26624
    s_waitcnt lgkmcnt(0)
    s_mul_i32 s41, s70, 10240
    s_add_u32 s41, s41, 0
    s_add_u32 s41, s41, s40
    buffer_store_dwordx4 v[74:77], v3, s[24:27], s41 offen sc1
    s_mul_i32 s41, s70, 10240
    s_add_u32 s41, s41, 81920
    s_add_u32 s41, s41, s40
    buffer_store_dwordx4 v[78:81], v3, s[24:27], s41 offen sc1
    s_mul_i32 s41, s70, 10240
    s_add_u32 s41, s41, 163840
    s_add_u32 s41, s41, s40
    buffer_store_dwordx4 v[82:85], v3, s[24:27], s41 offen sc1
    s_mul_i32 s41, s70, 10240
    s_add_u32 s41, s41, 5120
    s_add_u32 s41, s41, s40
    buffer_store_dwordx4 v[86:89], v3, s[24:27], s41 offen sc1
    s_mul_i32 s41, s70, 10240
    s_add_u32 s41, s41, 87040
    s_add_u32 s41, s41, s40
    buffer_store_dwordx4 v[90:93], v3, s[24:27], s41 offen sc1
    s_mul_i32 s41, s70, 10240
    s_add_u32 s41, s41, 168960
    s_add_u32 s41, s41, s40
    buffer_store_dwordx4 v[94:97], v3, s[24:27], s41 offen sc1
    s_mul_i32 s41, s70, 5120
    s_add_u32 s41, s41, 245760
    s_add_u32 s41, s41, s40
    buffer_store_dwordx4 v[98:101], v3, s[24:27], s41 offen sc1
    s_branch L_p_done
L_p_w2b:
    ds_read_b64_tr_b16 v[74:75], v25
    ds_read_b64_tr_b16 v[76:77], v25 offset:2048
    ds_read_b64_tr_b16 v[78:79], v25 offset:4096
    ds_read_b64_tr_b16 v[80:81], v25 offset:6144
    ds_read_b64_tr_b16 v[82:83], v25 offset:8192
    ds_read_b64_tr_b16 v[84:85], v25 offset:10240
    ds_read_b64_tr_b16 v[86:87], v25 offset:12288
    ds_read_b64_tr_b16 v[88:89], v25 offset:14336
    ds_read_b64_tr_b16 v[90:91], v25 offset:16384
    ds_read_b64_tr_b16 v[92:93], v25 offset:18432
    ds_read_b64_tr_b16 v[94:95], v25 offset:20480
    ds_read_b64_tr_b16 v[96:97], v25 offset:22528
    s_waitcnt lgkmcnt(0)
    s_mul_i32 s41, s70, 10240
    s_add_u32 s41, s41, 0
    s_add_u32 s41, s41, s40
    buffer_store_dwordx4 v[74:77], v3, s[24:27], s41 offen sc1
    s_mul_i32 s41, s70, 10240
    s_add_u32 s41, s41, 81920
    s_add_u32 s41, s41, s40
    buffer_store_dwordx4 v[78:81], v3, s[24:27], s41 offen sc1
    s_mul_i32 s41, s70, 10240
    s_add_u32 s41, s41, 163840
    s_add_u32 s41, s41, s40
    buffer_store_dwordx4 v[82:85], v3, s[24:27], s41 offen sc1
    s_mul_i32 s41, s70, 10240
    s_add_u32 s41, s41, 5120
    s_add_u32 s41, s41, s40
    buffer_store_dwordx4 v[86:89], v3, s[24:27], s41 offen sc1
    s_mul_i32 s41, s70, 10240
    s_add_u32 s41, s41, 87040
    s_add_u32 s41, s41, s40
    buffer_store_dwordx4 v[90:93], v3, s[24:27], s41 offen sc1
    s_mul_i32 s41, s70, 10240
    s_add_u32 s41, s41, 168960
    s_add_u32 s41, s41, s40
    buffer_store_dwordx4 v[94:97], v3, s[24:27], s41 offen sc1
    s_branch L_p_done
L_p_wo:
    v_bfe_u32 v8, v2, 3, 1
    v_mul_u32_u24 v8, 40, v8
    v_bfe_u32 v9, v2, 2, 1
    v_mul_u32_u24 v9, 20, v9
    v_add3_u32 v8, v8, v9, v6
    v_lshlrev_b32 v8, 7, v8
    v_and_b32 v9, 3, v2
    v_lshl_add_u32 v29, v9, 3, v8
    v_add_u32 v29, s38, v29
    ds_read_b64_tr_b16 v[74:75], v25
    ds_read_b64_tr_b16 v[76:77], v25 offset:2560
    ds_read_b64_tr_b16 v[78:79], v25 offset:5120
    ds_read_b64_tr_b16 v[80:81], v25 offset:7680
    ds_read_b64_tr_b16 v[82:83], v25 offset:10240
    ds_read_b64_tr_b16 v[84:85], v25 offset:12800
    ds_read_b64_tr_b16 v[86:87], v25 offset:15360
    ds_read_b64_tr_b16 v[88:89], v25 offset:17920
    ds_read_b64_tr_b16 v[90:91], v29 offset:2048
    ds_read_b64_tr_b16 v[92:93], v29 offset:12288
    s_mul_i32 s40, s39, 13108
    s_lshr_b32 s40, s40, 16
    s_mul_i32 s41, s40, 5
    s_sub_u32 s41, s39, s41
    s_mul_i32 s40, s40, 102400
    s_add_u32 s40, s40, 1048576
    s_lshr_b32 s42, s41, 1
    s_min_u32 s42, s42, 2
    s_mul_i32 s43, s42, 38
    s_add_u32 s43, s43, s41
    s_lshl_b32 s43, s43, 10
    s_add_u32 s40, s40, s43
    s_cmp_eq_u32 s42, 2
    s_cselect_b32 s44, 1024, 0
    s_cselect_b32 s43, 0, 2048
    s_add_u32 s43, s43, s44
    s_waitcnt lgkmcnt(0)
    s_lshl_b32 s41, s70, 2
    s_add_u32 s41, s41, 0
    s_mul_i32 s41, s41, s43
    s_add_u32 s41, s41, s40
    buffer_store_dwordx4 v[74:77], v3, s[24:27], s41 offen sc1
    s_lshl_b32 s41, s70, 2
    s_add_u32 s41, s41, 1
    s_mul_i32 s41, s41, s43
    s_add_u32 s41, s41, s40
    buffer_store_dwordx4 v[78:81], v3, s[24:27], s41 offen sc1
    s_lshl_b32 s41, s70, 2
    s_add_u32 s41, s41, 2
    s_mul_i32 s41, s41, s43
    s_add_u32 s41, s41, s40
    buffer_store_dwordx4 v[82:85], v3, s[24:27], s41 offen sc1
    s_lshl_b32 s41, s70, 2
    s_add_u32 s41, s41, 3
    s_mul_i32 s41, s41, s43
    s_add_u32 s41, s41, s40
    buffer_store_dwordx4 v[86:89], v3, s[24:27], s41 offen sc1
    s_add_u32 s41, s70, 16
    s_mul_i32 s41, s41, s43
    s_add_u32 s41, s41, s40
    buffer_store_dwordx4 v[90:93], v3, s[24:27], s41 offen sc1
L_p_done:
    s_nop 1
L_cd_18:
    s_nop 1
    v_mfma_f32_16x16x32_bf16 v[30:33], a[4:7], a[44:47], v[30:33]
    v_mfma_f32_16x16x32_bf16 v[54:57], a[4:7], a[48:51], v[54:57]
    ds_read_b64_tr_b16 a[24:25], v23 offset:25600
    ds_read_b64_tr_b16 a[26:27], v23 offset:26880
    v_mfma_f32_16x16x32_bf16 v[34:37], a[8:11], a[44:47], v[34:37]
    v_mfma_f32_16x16x32_bf16 v[58:61], a[8:11], a[48:51], v[58:61]
    ds_read_b64_tr_b16 a[28:29], v23 offset:25640
    ds_read_b64_tr_b16 a[30:31], v23 offset:26920
    v_mfma_f32_16x16x32_bf16 v[42:45], a[12:15], a[44:47], v[42:45]
    v_mfma_f32_16x16x32_bf16 v[62:65], a[12:15], a[48:51], v[62:65]
    ds_read_b64_tr_b16 a[32:33], v24 offset:25600
    ds_read_b64_tr_b16 a[34:35], v24 offset:26880
    s_waitcnt lgkmcnt(13)
    v_mfma_f32_16x16x32_bf16 v[46:49], a[16:19], a[44:47], v[46:49]
    v_mfma_f32_16x16x32_bf16 v[66:69], a[16:19], a[48:51], v[66:69]
    ds_read_b64_tr_b16 a[36:37], v23 offset:25680
    ds_read_b64_tr_b16 a[38:39], v23 offset:26960
    s_waitcnt lgkmcnt(13)
    v_mfma_f32_16x16x32_bf16 v[50:53], a[20:23], a[44:47], v[50:53]
    v_mfma_f32_16x16x32_bf16 v[70:73], a[20:23], a[48:51], v[70:73]
    ds_read_b64_tr_b16 a[40:41], v23 offset:25720
    ds_read_b64_tr_b16 a[42:43], v23 offset:27000
    s_waitcnt lgkmcnt(8)
    v_mfma_f32_16x16x32_bf16 v[30:33], a[24:27], a[52:55], v[30:33]
    v_mfma_f32_16x16x32_bf16 v[54:57], a[24:27], a[56:59], v[54:57]
    ds_read_b64_tr_b16 a[4:5], v23 offset:30720
    ds_read_b64_tr_b16 a[6:7], v23 offset:32000
    s_waitcnt lgkmcnt(8)
    v_mfma_f32_16x16x32_bf16 v[34:37], a[28:31], a[52:55], v[34:37]
    v_mfma_f32_16x16x32_bf16 v[58:61], a[28:31], a[56:59], v[58:61]
    ds_read_b64_tr_b16 a[8:9], v23 offset:30760
    ds_read_b64_tr_b16 a[10:11], v23 offset:32040
    s_waitcnt lgkmcnt(8)
    v_mfma_f32_16x16x32_bf16 v[42:45], a[32:35], a[52:55], v[42:45]
    v_mfma_f32_16x16x32_bf16 v[62:65], a[32:35], a[56:59], v[62:65]
    ds_read_b64_tr_b16 a[12:13], v24 offset:30720
    ds_read_b64_tr_b16 a[14:15], v24 offset:32000
    ds_read_b32 v12, v27 offset:80
    s_waitcnt lgkmcnt(9)
    v_mfma_f32_16x16x32_bf16 v[46:49], a[36:39], a[52:55], v[46:49]
    v_mfma_f32_16x16x32_bf16 v[66:69], a[36:39], a[56:59], v[66:69]
    ds_read_b64_tr_b16 a[16:17], v23 offset:30800
    ds_read_b64_tr_b16 a[18:19], v23 offset:32080
    s_waitcnt lgkmcnt(9)
    v_mfma_f32_16x16x32_bf16 v[50:53], a[40:43], a[52:55], v[50:53]
    v_mfma_f32_16x16x32_bf16 v[70:73], a[40:43], a[56:59], v[70:73]
    ds_read_b64_tr_b16 a[20:21], v23 offset:30840
    ds_read_b64_tr_b16 a[22:23], v23 offset:32120
    v_mov_b32 v10, 4
    ds_write_b32 v26, v10 offset:96
    s_waitcnt lgkmcnt(5)
    v_cmp_gt_u32 vcc, 8, v12
    s_cbranch_vccnz L_cw_22
L_cn_23:
    ds_read_b128 a[44:47], v21
    ds_read_b128 a[48:51], v21 offset:2048
    ds_read_b128 a[52:55], v22
    ds_read_b128 a[56:59], v22 offset:2048
    global_load_dword v28, v0, s[96:97]
    v_mfma_f32_16x16x32_bf16 v[30:33], a[4:7], a[60:63], v[30:33]
    v_mfma_f32_16x16x32_bf16 v[54:57], a[4:7], a[64:67], v[54:57]
    ds_read_b64_tr_b16 a[24:25], v23 offset:35840
    ds_read_b64_tr_b16 a[26:27], v23 offset:37120
    v_mfma_f32_16x16x32_bf16 v[34:37], a[8:11], a[60:63], v[34:37]
    v_mfma_f32_16x16x32_bf16 v[58:61], a[8:11], a[64:67], v[58:61]
    ds_read_b64_tr_b16 a[28:29], v23 offset:35880
    ds_read_b64_tr_b16 a[30:31], v23 offset:37160
    v_mfma_f32_16x16x32_bf16 v[42:45], a[12:15], a[60:63], v[42:45]
    v_mfma_f32_16x16x32_bf16 v[62:65], a[12:15], a[64:67], v[62:65]
    ds_read_b64_tr_b16 a[32:33], v24 offset:35840
    ds_read_b64_tr_b16 a[34:35], v24 offset:37120
    s_waitcnt lgkmcnt(13)
    v_mfma_f32_16x16x32_bf16 v[46:49], a[16:19], a[60:63], v[46:49]
    v_mfma_f32_16x16x32_bf16 v[66:69], a[16:19], a[64:67], v[66:69]
    ds_read_b64_tr_b16 a[36:37], v23 offset:35920
    ds_read_b64_tr_b16 a[38:39], v23 offset:37200
    s_waitcnt lgkmcnt(13)
    v_mfma_f32_16x16x32_bf16 v[50:53], a[20:23], a[60:63], v[50:53]
    v_mfma_f32_16x16x32_bf16 v[70:73], a[20:23], a[64:67], v[70:73]
    ds_read_b64_tr_b16 a[40:41], v23 offset:35960
    ds_read_b64_tr_b16 a[42:43], v23 offset:37240
    s_waitcnt lgkmcnt(8)
    v_mfma_f32_16x16x32_bf16 v[30:33], a[24:27], a[68:71], v[30:33]
    v_mfma_f32_16x16x32_bf16 v[54:57], a[24:27], a[72:75], v[54:57]
    ds_read_b64_tr_b16 a[4:5], v23 offset:40960
    ds_read_b64_tr_b16 a[6:7], v23 offset:42240
    s_waitcnt lgkmcnt(8)
    v_mfma_f32_16x16x32_bf16 v[34:37], a[28:31], a[68:71], v[34:37]
    v_mfma_f32_16x16x32_bf16 v[58:61], a[28:31], a[72:75], v[58:61]
    ds_read_b64_tr_b16 a[8:9], v23 offset:41000
    ds_read_b64_tr_b16 a[10:11], v23 offset:42280
    s_waitcnt lgkmcnt(8)
    v_mfma_f32_16x16x32_bf16 v[42:45], a[32:35], a[68:71], v[42:45]
    v_mfma_f32_16x16x32_bf16 v[62:65], a[32:35], a[72:75], v[62:65]
    ds_read_b64_tr_b16 a[12:13], v24 offset:40960
    ds_read_b64_tr_b16 a[14:15], v24 offset:42240
    ds_read_b32 v12, v27 offset:80
    s_waitcnt lgkmcnt(9)
    v_mfma_f32_16x16x32_bf16 v[46:49], a[36:39], a[68:71], v[46:49]
    v_mfma_f32_16x16x32_bf16 v[66:69], a[36:39], a[72:75], v[66:69]
    ds_read_b64_tr_b16 a[16:17], v23 offset:41040
    ds_read_b64_tr_b16 a[18:19], v23 offset:42320
    s_waitcnt lgkmcnt(9)
    v_mfma_f32_16x16x32_bf16 v[50:53], a[40:43], a[68:71], v[50:53]
    v_mfma_f32_16x16x32_bf16 v[70:73], a[40:43], a[72:75], v[70:73]
    ds_read_b64_tr_b16 a[20:21], v23 offset:41080
    ds_read_b64_tr_b16 a[22:23], v23 offset:42360
    v_mov_b32 v10, 5
    ds_write_b32 v26, v10 offset:96
    s_waitcnt lgkmcnt(5)
    v_cmp_gt_u32 vcc, 9, v12
    s_cbranch_vccnz L_cw_25
L_cn_26:
    ds_read_b128 a[60:63], v21 offset:16384
    ds_read_b128 a[64:67], v21 offset:18432
    ds_read_b128 a[68:71], v22 offset:16384
    ds_read_b128 a[72:75], v22 offset:18432
    s_waitcnt vmcnt(0)
    v_mov_b32 v10, 1
    ds_write_b32 v26, v10 offset:144
    v_mfma_f32_16x16x32_bf16 v[30:33], a[4:7], a[44:47], v[30:33]
    v_mfma_f32_16x16x32_bf16 v[54:57], a[4:7], a[48:51], v[54:57]
    ds_read_b64_tr_b16 a[24:25], v23 offset:46080
    ds_read_b64_tr_b16 a[26:27], v23 offset:47360
    v_mfma_f32_16x16x32_bf16 v[34:37], a[8:11], a[44:47], v[34:37]
    v_mfma_f32_16x16x32_bf16 v[58:61], a[8:11], a[48:51], v[58:61]
    ds_read_b64_tr_b16 a[28:29], v23 offset:46120
    ds_read_b64_tr_b16 a[30:31], v23 offset:47400
    v_mfma_f32_16x16x32_bf16 v[42:45], a[12:15], a[44:47], v[42:45]
    v_mfma_f32_16x16x32_bf16 v[62:65], a[12:15], a[48:51], v[62:65]
    ds_read_b64_tr_b16 a[32:33], v24 offset:46080
    ds_read_b64_tr_b16 a[34:35], v24 offset:47360
    s_waitcnt lgkmcnt(14)
    v_mfma_f32_16x16x32_bf16 v[46:49], a[16:19], a[44:47], v[46:49]
    v_mfma_f32_16x16x32_bf16 v[66:69], a[16:19], a[48:51], v[66:69]
    ds_read_b64_tr_b16 a[36:37], v23 offset:46160
    ds_read_b64_tr_b16 a[38:39], v23 offset:47440
    s_waitcnt lgkmcnt(14)
    v_mfma_f32_16x16x32_bf16 v[50:53], a[20:23], a[44:47], v[50:53]
    v_mfma_f32_16x16x32_bf16 v[70:73], a[20:23], a[48:51], v[70:73]
    ds_read_b64_tr_b16 a[40:41], v23 offset:46200
    ds_read_b64_tr_b16 a[42:43], v23 offset:47480
    s_waitcnt lgkmcnt(8)
    v_mfma_f32_16x16x32_bf16 v[30:33], a[24:27], a[52:55], v[30:33]
    v_mfma_f32_16x16x32_bf16 v[54:57], a[24:27], a[56:59], v[54:57]
    ds_read_b64_tr_b16 a[4:5], v23 offset:51200
    ds_read_b64_tr_b16 a[6:7], v23 offset:52480
    s_waitcnt lgkmcnt(8)
    v_mfma_f32_16x16x32_bf16 v[34:37], a[28:31], a[52:55], v[34:37]
    v_mfma_f32_16x16x32_bf16 v[58:61], a[28:31], a[56:59], v[58:61]
    ds_read_b64_tr_b16 a[8:9], v23 offset:51240
    ds_read_b64_tr_b16 a[10:11], v23 offset:52520
    s_waitcnt lgkmcnt(8)
    v_mfma_f32_16x16x32_bf16 v[42:45], a[32:35], a[52:55], v[42:45]
    v_mfma_f32_16x16x32_bf16 v[62:65], a[32:35], a[56:59], v[62:65]
    ds_read_b64_tr_b16 a[12:13], v24 offset:51200
    ds_read_b64_tr_b16 a[14:15], v24 offset:52480
    ds_read_b32 v12, v27 offset:80
    s_waitcnt lgkmcnt(9)
    v_mfma_f32_16x16x32_bf16 v[46:49], a[36:39], a[52:55], v[46:49]
    v_mfma_f32_16x16x32_bf16 v[66:69], a[36:39], a[56:59], v[66:69]
    ds_read_b64_tr_b16 a[16:17], v23 offset:51280
    ds_read_b64_tr_b16 a[18:19], v23 offset:52560
    s_waitcnt lgkmcnt(9)
    v_mfma_f32_16x16x32_bf16 v[50:53], a[40:43], a[52:55], v[50:53]
    v_mfma_f32_16x16x32_bf16 v[70:73], a[40:43], a[56:59], v[70:73]
    ds_read_b64_tr_b16 a[20:21], v23 offset:51320
    ds_read_b64_tr_b16 a[22:23], v23 offset:52600
    v_mov_b32 v10, 6
    ds_write_b32 v26, v10 offset:96
    s_waitcnt lgkmcnt(5)
    v_cmp_gt_u32 vcc, 11, v12
    s_cbranch_vccnz L_cw_28
L_cn_29:
    ds_read_b128 a[44:47], v21 offset:32768
    ds_read_b128 a[48:51], v21 offset:34816
    ds_read_b128 a[52:55], v22 offset:32768
    ds_read_b128 a[56:59], v22 offset:34816
    s_cmp_lg_u32 s36, 0
    s_cbranch_scc1 L_pub_31
    ds_read_b32 v12, v27 offset:144
    s_waitcnt lgkmcnt(0)
    v_cmp_gt_u32 vcc, 1, v12
    s_cbranch_vccnz L_cw_32
L_cn_33:
    s_lshl_b32 s45, s2, 3
    s_add_u32 s45, s45, 65536
    s_mov_b64 exec, 1
    buffer_store_dwordx2 v[16:17], v11, s[24:27], s45 offen sc1
    s_mov_b64 exec, -1
L_pub_31:
    s_lshl_b32 s38, s34, 11
    v_lshl_add_u32 v8, v7, 7, s38
    s_lshl_b32 s38, s35, 7
    v_lshl_add_u32 v9, v7, 11, s38
    v_cmp_eq_u32 vcc, 0, v6
    s_nop 1
    v_cndmask_b32 v20, v8, v9, vcc
    s_mov_b32 s45, 229376
    buffer_load_dwordx4 v[74:77], v20, s[24:27], s45 offen sc1
    v_mfma_f32_16x16x32_bf16 v[30:33], a[4:7], a[60:63], v[30:33]
    v_mfma_f32_16x16x32_bf16 v[54:57], a[4:7], a[64:67], v[54:57]
    ds_read_b64_tr_b16 a[24:25], v23 offset:56320
    ds_read_b64_tr_b16 a[26:27], v23 offset:57600
    v_mfma_f32_16x16x32_bf16 v[34:37], a[8:11], a[60:63], v[34:37]
    v_mfma_f32_16x16x32_bf16 v[58:61], a[8:11], a[64:67], v[58:61]
    ds_read_b64_tr_b16 a[28:29], v23 offset:56360
    ds_read_b64_tr_b16 a[30:31], v23 offset:57640
    v_mfma_f32_16x16x32_bf16 v[42:45], a[12:15], a[60:63], v[42:45]
    v_mfma_f32_16x16x32_bf16 v[62:65], a[12:15], a[64:67], v[62:65]
    ds_read_b64_tr_b16 a[32:33], v24 offset:56320
    ds_read_b64_tr_b16 a[34:35], v24 offset:57600
    s_waitcnt lgkmcnt(13)
    v_mfma_f32_16x16x32_bf16 v[46:49], a[16:19], a[60:63], v[46:49]
    v_mfma_f32_16x16x32_bf16 v[66:69], a[16:19], a[64:67], v[66:69]
    ds_read_b64_tr_b16 a[36:37], v23 offset:56400
    ds_read_b64_tr_b16 a[38:39], v23 offset:57680
    s_waitcnt lgkmcnt(13)
    v_mfma_f32_16x16x32_bf16 v[50:53], a[20:23], a[60:63], v[50:53]
    v_mfma_f32_16x16x32_bf16 v[70:73], a[20:23], a[64:67], v[70:73]
    ds_read_b64_tr_b16 a[40:41], v23 offset:56440
    ds_read_b64_tr_b16 a[42:43], v23 offset:57720
    s_waitcnt lgkmcnt(8)
    v_mfma_f32_16x16x32_bf16 v[30:33], a[24:27], a[68:71], v[30:33]
    v_mfma_f32_16x16x32_bf16 v[54:57], a[24:27], a[72:75], v[54:57]
    ds_read_b64_tr_b16 a[4:5], v23
    ds_read_b64_tr_b16 a[6:7], v23 offset:1280
    s_waitcnt lgkmcnt(8)
    v_mfma_f32_16x16x32_bf16 v[34:37], a[28:31], a[68:71], v[34:37]
    v_mfma_f32_16x16x32_bf16 v[58:61], a[28:31], a[72:75], v[58:61]
    ds_read_b64_tr_b16 a[8:9], v23 offset:40
    ds_read_b64_tr_b16 a[10:11], v23 offset:1320
    s_waitcnt lgkmcnt(8)
    v_mfma_f32_16x16x32_bf16 v[42:45], a[32:35], a[68:71], v[42:45]
    v_mfma_f32_16x16x32_bf16 v[62:65], a[32:35], a[72:75], v[62:65]
    ds_read_b64_tr_b16 a[12:13], v24
    ds_read_b64_tr_b16 a[14:15], v24 offset:1280
    ds_read_b32 v12, v27 offset:80
    s_waitcnt lgkmcnt(9)
    v_mfma_f32_16x16x32_bf16 v[46:49], a[36:39], a[68:71], v[46:49]
    v_mfma_f32_16x16x32_bf16 v[66:69], a[36:39], a[72:75], v[66:69]
    ds_read_b64_tr_b16 a[16:17], v23 offset:80
    ds_read_b64_tr_b16 a[18:19], v23 offset:1360
    s_waitcnt lgkmcnt(9)
    v_mfma_f32_16x16x32_bf16 v[50:53], a[40:43], a[68:71], v[50:53]
    v_mfma_f32_16x16x32_bf16 v[70:73], a[40:43], a[72:75], v[70:73]
    ds_read_b64_tr_b16 a[20:21], v23 offset:120
    ds_read_b64_tr_b16 a[22:23], v23 offset:1400
    v_mov_b32 v10, 7
    ds_write_b32 v26, v10 offset:96
    s_waitcnt lgkmcnt(5)
    v_cmp_gt_u32 vcc, 12, v12
    s_cbranch_vccnz L_cw_35
L_cn_36:
    ds_read_b128 a[60:63], v21 offset:49152
    ds_read_b128 a[64:67], v21 offset:51200
    ds_read_b128 a[68:71], v22 offset:49152
    ds_read_b128 a[72:75], v22 offset:51200
    v_mfma_f32_16x16x32_bf16 v[30:33], a[4:7], a[44:47], v[30:33]
    v_mfma_f32_16x16x32_bf16 v[54:57], a[4:7], a[48:51], v[54:57]
    ds_read_b64_tr_b16 a[24:25], v23 offset:5120
    ds_read_b64_tr_b16 a[26:27], v23 offset:6400
    v_mfma_f32_16x16x32_bf16 v[34:37], a[8:11], a[44:47], v[34:37]
    v_mfma_f32_16x16x32_bf16 v[58:61], a[8:11], a[48:51], v[58:61]
    ds_read_b64_tr_b16 a[28:29], v23 offset:5160
    ds_read_b64_tr_b16 a[30:31], v23 offset:6440
    v_mfma_f32_16x16x32_bf16 v[42:45], a[12:15], a[44:47], v[42:45]
    v_mfma_f32_16x16x32_bf16 v[62:65], a[12:15], a[48:51], v[62:65]
    ds_read_b64_tr_b16 a[32:33], v24 offset:5120
    ds_read_b64_tr_b16 a[34:35], v24 offset:6400
    s_waitcnt lgkmcnt(13)
    v_mfma_f32_16x16x32_bf16 v[46:49], a[16:19], a[44:47], v[46:49]
    v_mfma_f32_16x16x32_bf16 v[66:69], a[16:19], a[48:51], v[66:69]
    ds_read_b64_tr_b16 a[36:37], v23 offset:5200
    ds_read_b64_tr_b16 a[38:39], v23 offset:6480
    s_waitcnt lgkmcnt(13)
    v_mfma_f32_16x16x32_bf16 v[50:53], a[20:23], a[44:47], v[50:53]
    v_mfma_f32_16x16x32_bf16 v[70:73], a[20:23], a[48:51], v[70:73]
    ds_read_b64_tr_b16 a[40:41], v23 offset:5240
    ds_read_b64_tr_b16 a[42:43], v23 offset:6520
    s_waitcnt lgkmcnt(8)
    v_mfma_f32_16x16x32_bf16 v[30:33], a[24:27], a[52:55], v[30:33]
    v_mfma_f32_16x16x32_bf16 v[54:57], a[24:27], a[56:59], v[54:57]
    ds_read_b64_tr_b16 a[4:5], v23 offset:10240
    ds_read_b64_tr_b16 a[6:7], v23 offset:11520
    s_waitcnt lgkmcnt(8)
    v_mfma_f32_16x16x32_bf16 v[34:37], a[28:31], a[52:55], v[34:37]
    v_mfma_f32_16x16x32_bf16 v[58:61], a[28:31], a[56:59], v[58:61]
    ds_read_b64_tr_b16 a[8:9], v23 offset:10280
    ds_read_b64_tr_b16 a[10:11], v23 offset:11560
    s_waitcnt lgkmcnt(8)
    v_mfma_f32_16x16x32_bf16 v[42:45], a[32:35], a[52:55], v[42:45]
    v_mfma_f32_16x16x32_bf16 v[62:65], a[32:35], a[56:59], v[62:65]
    ds_read_b64_tr_b16 a[12:13], v24 offset:10240
    ds_read_b64_tr_b16 a[14:15], v24 offset:11520
    ds_read_b32 v12, v27 offset:80
    s_waitcnt lgkmcnt(9)
    v_mfma_f32_16x16x32_bf16 v[46:49], a[36:39], a[52:55], v[46:49]
    v_mfma_f32_16x16x32_bf16 v[66:69], a[36:39], a[56:59], v[66:69]
    ds_read_b64_tr_b16 a[16:17], v23 offset:10320
    ds_read_b64_tr_b16 a[18:19], v23 offset:11600
    s_waitcnt lgkmcnt(9)
    v_mfma_f32_16x16x32_bf16 v[50:53], a[40:43], a[52:55], v[50:53]
    v_mfma_f32_16x16x32_bf16 v[70:73], a[40:43], a[56:59], v[70:73]
    ds_read_b64_tr_b16 a[20:21], v23 offset:10360
    ds_read_b64_tr_b16 a[22:23], v23 offset:11640
    v_mov_b32 v10, 8
    ds_write_b32 v26, v10 offset:96
    s_waitcnt lgkmcnt(5)
    v_cmp_gt_u32 vcc, 14, v12
    s_cbranch_vccnz L_cw_38
L_cn_39:
    ds_read_b128 a[44:47], v21
    ds_read_b128 a[48:51], v21 offset:2048
    ds_read_b128 a[52:55], v22
    ds_read_b128 a[56:59], v22 offset:2048
    v_lshlrev_b32 v8, 7, v2
    s_mov_b64 exec, 0xff
    buffer_load_dword v28, v8, s[24:27], s67 offen sc1
    s_add_u32 s38, s67, 20480
    buffer_load_dword v28, v8, s[24:27], s38 offen sc1
    s_mov_b64 exec, -1
    v_lshlrev_b32 v8, 7, v2
    s_mov_b64 exec, 0x3
    buffer_load_dword v28, v8, s[24:27], s68 offen sc1
    s_add_u32 s38, s68, 20480
    buffer_load_dword v28, v8, s[24:27], s38 offen sc1
    s_mov_b64 exec, -1
    global_load_dword v28, v0, s[96:97]
    v_mfma_f32_16x16x32_bf16 v[30:33], a[4:7], a[60:63], v[30:33]
    v_mfma_f32_16x16x32_bf16 v[54:57], a[4:7], a[64:67], v[54:57]
    ds_read_b64_tr_b16 a[24:25], v23 offset:15360
    ds_read_b64_tr_b16 a[26:27], v23 offset:16640
    v_mfma_f32_16x16x32_bf16 v[34:37], a[8:11], a[60:63], v[34:37]
    v_mfma_f32_16x16x32_bf16 v[58:61], a[8:11], a[64:67], v[58:61]
    ds_read_b64_tr_b16 a[28:29], v23 offset:15400
    ds_read_b64_tr_b16 a[30:31], v23 offset:16680
    v_mfma_f32_16x16x32_bf16 v[42:45], a[12:15], a[60:63], v[42:45]
    v_mfma_f32_16x16x32_bf16 v[62:65], a[12:15], a[64:67], v[62:65]
    ds_read_b64_tr_b16 a[32:33], v24 offset:15360
    ds_read_b64_tr_b16 a[34:35], v24 offset:16640
    s_waitcnt lgkmcnt(13)
    v_mfma_f32_16x16x32_bf16 v[46:49], a[16:19], a[60:63], v[46:49]
    v_mfma_f32_16x16x32_bf16 v[66:69], a[16:19], a[64:67], v[66:69]
    ds_read_b64_tr_b16 a[36:37], v23 offset:15440
    ds_read_b64_tr_b16 a[38:39], v23 offset:16720
    s_waitcnt lgkmcnt(13)
    v_mfma_f32_16x16x32_bf16 v[50:53], a[20:23], a[60:63], v[50:53]
    v_mfma_f32_16x16x32_bf16 v[70:73], a[20:23], a[64:67], v[70:73]
    ds_read_b64_tr_b16 a[40:41], v23 offset:15480
    ds_read_b64_tr_b16 a[42:43], v23 offset:16760
    s_waitcnt lgkmcnt(8)
    v_mfma_f32_16x16x32_bf16 v[30:33], a[24:27], a[68:71], v[30:33]
    v_mfma_f32_16x16x32_bf16 v[54:57], a[24:27], a[72:75], v[54:57]
    ds_read_b64_tr_b16 a[4:5], v23 offset:20480
    ds_read_b64_tr_b16 a[6:7], v23 offset:21760
    s_waitcnt lgkmcnt(8)
    v_mfma_f32_16x16x32_bf16 v[34:37], a[28:31], a[68:71], v[34:37]
    v_mfma_f32_16x16x32_bf16 v[58:61], a[28:31], a[72:75], v[58:61]
    ds_read_b64_tr_b16 a[8:9], v23 offset:20520
    ds_read_b64_tr_b16 a[10:11], v23 offset:21800
    s_waitcnt lgkmcnt(8)
    v_mfma_f32_16x16x32_bf16 v[42:45], a[32:35], a[68:71], v[42:45]
    v_mfma_f32_16x16x32_bf16 v[62:65], a[32:35], a[72:75], v[62:65]
    ds_read_b64_tr_b16 a[12:13], v24 offset:20480
    ds_read_b64_tr_b16 a[14:15], v24 offset:21760
    ds_read_b32 v12, v27 offset:80
    s_waitcnt lgkmcnt(9)
    v_mfma_f32_16x16x32_bf16 v[46:49], a[36:39], a[68:71], v[46:49]
    v_mfma_f32_16x16x32_bf16 v[66:69], a[36:39], a[72:75], v[66:69]
    ds_read_b64_tr_b16 a[16:17], v23 offset:20560
    ds_read_b64_tr_b16 a[18:19], v23 offset:21840
    s_waitcnt lgkmcnt(9)
    v_mfma_f32_16x16x32_bf16 v[50:53], a[40:43], a[68:71], v[50:53]
    v_mfma_f32_16x16x32_bf16 v[70:73], a[40:43], a[72:75], v[70:73]
    ds_read_b64_tr_b16 a[20:21], v23 offset:20600
    ds_read_b64_tr_b16 a[22:23], v23 offset:21880
    v_mov_b32 v10, 9
    ds_write_b32 v26, v10 offset:96
    v_mul_u32_u24 v78, 296, v7
    s_mul_i32 s38, s36, 9472
    s_add_u32 s38, s38, 0
    v_add_u32 v78, s38, v78
    v_lshl_add_u32 v79, v6, 2, v78
    v_lshl_add_u32 v78, v6, 3, v78
    v_lshrrev_b32 v8, 2, v2
    v_mul_u32_u24 v8, 296, v8
    v_and_b32 v9, 3, v2
    v_lshl_add_u32 v8, v9, 3, v8
    s_lshr_b32 s38, s36, 1
    s_mul_i32 s39, s38, 96
    s_add_u32 s39, s39, 0
    v_add_u32 v25, s39, v8
    s_mul_i32 s39, s38, 32
    s_add_u32 s39, s39, 192
    s_and_b32 s40, s36, 1
    s_cmp_eq_u32 s40, 1
    s_cselect_b32 s39, 256, s39
    s_add_u32 s39, s39, 0
    v_add_u32 v29, s39, v8
    s_mul_i32 s39, s38, 2560
    s_cmp_eq_u32 s40, 1
    s_cselect_b32 s39, 5120, s39
    s_add_u32 s39, s39, s61
    s_and_b32 s41, s34, 3
    s_lshl_b32 s41, s41, 13
    s_add_u32 s70, s39, s41
    s_mov_b64 exec, -1
    s_mov_b32 s48, 200000
    s_mov_b32 s45, 229376
    s_waitcnt vmcnt(5)
    s_branch L_pc_43
L_pt_41:
    buffer_load_dwordx4 v[74:77], v20, s[24:27], s45 offen sc1
    s_waitcnt vmcnt(0)
L_pc_43:
    v_cmp_ne_u64_e64 vcc, s[32:33], v[74:75]
    s_cbranch_vccz L_pn_42
    s_mov_b64 exec, vcc
    s_sleep 8
    s_sub_u32 s48, s48, 1
    s_cmp_lg_u32 s48, 0
    s_cbranch_scc1 L_pt_41
L_pn_42:
    s_mov_b64 exec, -1
    s_mov_b32 exec_lo, 0xffff0000
    s_mov_b32 exec_hi, 0xffffffff
    v_cmp_ne_u32 vcc, s50, v76
    s_mov_b64 exec, -1
    s_cmp_eq_u64 vcc, 0
    s_cselect_b32 s49, 1, 0
    s_add_u32 s42, s49, 1
    v_mov_b32 v10, s42
    ds_write_b32 v26, v10 offset:192
    s_cmp_eq_u32 s36, 1
    s_cselect_b32 s76, 0x33333333, -1
    s_cmp_eq_u32 s36, 3
    s_cselect_b32 s76, 0xcccccccc, s76
    s_mov_b32 s77, s76
    s_waitcnt lgkmcnt(6)
    v_cmp_gt_u32 vcc, 15, v12
    s_cbranch_vccnz L_cw_44
L_cn_45:
    ds_read_b128 a[60:63], v21 offset:16384
    ds_read_b128 a[64:67], v21 offset:18432
    ds_read_b128 a[68:71], v22 offset:16384
    ds_read_b128 a[72:75], v22 offset:18432
    v_mfma_f32_16x16x32_bf16 v[30:33], a[4:7], a[44:47], v[30:33]
    v_mfma_f32_16x16x32_bf16 v[54:57], a[4:7], a[48:51], v[54:57]
    ds_read_b64_tr_b16 a[24:25], v23 offset:25600
    ds_read_b64_tr_b16 a[26:27], v23 offset:26880
    v_mfma_f32_16x16x32_bf16 v[34:37], a[8:11], a[44:47], v[34:37]
    v_mfma_f32_16x16x32_bf16 v[58:61], a[8:11], a[48:51], v[58:61]
    ds_read_b64_tr_b16 a[28:29], v23 offset:25640
    ds_read_b64_tr_b16 a[30:31], v23 offset:26920
    v_mfma_f32_16x16x32_bf16 v[42:45], a[12:15], a[44:47], v[42:45]
    v_mfma_f32_16x16x32_bf16 v[62:65], a[12:15], a[48:51], v[62:65]
    ds_read_b64_tr_b16 a[32:33], v24 offset:25600
    ds_read_b64_tr_b16 a[34:35], v24 offset:26880
    s_waitcnt lgkmcnt(14)
    v_mfma_f32_16x16x32_bf16 v[46:49], a[16:19], a[44:47], v[46:49]
    v_mfma_f32_16x16x32_bf16 v[66:69], a[16:19], a[48:51], v[66:69]
    ds_read_b64_tr_b16 a[36:37], v23 offset:25680
    ds_read_b64_tr_b16 a[38:39], v23 offset:26960
    s_waitcnt lgkmcnt(14)
    v_mfma_f32_16x16x32_bf16 v[50:53], a[20:23], a[44:47], v[50:53]
    v_mfma_f32_16x16x32_bf16 v[70:73], a[20:23], a[48:51], v[70:73]
    ds_read_b64_tr_b16 a[40:41], v23 offset:25720
    ds_read_b64_tr_b16 a[42:43], v23 offset:27000
    s_waitcnt lgkmcnt(8)
    v_mfma_f32_16x16x32_bf16 v[30:33], a[24:27], a[52:55], v[30:33]
    v_mfma_f32_16x16x32_bf16 v[54:57], a[24:27], a[56:59], v[54:57]
    ds_read_b64_tr_b16 a[4:5], v23 offset:30720
    ds_read_b64_tr_b16 a[6:7], v23 offset:32000
    s_waitcnt lgkmcnt(8)
    v_mfma_f32_16x16x32_bf16 v[34:37], a[28:31], a[52:55], v[34:37]
    v_mfma_f32_16x16x32_bf16 v[58:61], a[28:31], a[56:59], v[58:61]
    ds_read_b64_tr_b16 a[8:9], v23 offset:30760
    ds_read_b64_tr_b16 a[10:11], v23 offset:32040
    s_waitcnt lgkmcnt(8)
    v_mfma_f32_16x16x32_bf16 v[42:45], a[32:35], a[52:55], v[42:45]
    v_mfma_f32_16x16x32_bf16 v[62:65], a[32:35], a[56:59], v[62:65]
    ds_read_b64_tr_b16 a[12:13], v24 offset:30720
    ds_read_b64_tr_b16 a[14:15], v24 offset:32000
    s_waitcnt lgkmcnt(8)
    v_mfma_f32_16x16x32_bf16 v[46:49], a[36:39], a[52:55], v[46:49]
    v_mfma_f32_16x16x32_bf16 v[66:69], a[36:39], a[56:59], v[66:69]
    ds_read_b64_tr_b16 a[16:17], v23 offset:30800
    ds_read_b64_tr_b16 a[18:19], v23 offset:32080
    s_waitcnt lgkmcnt(8)
    v_mfma_f32_16x16x32_bf16 v[50:53], a[40:43], a[52:55], v[50:53]
    v_mfma_f32_16x16x32_bf16 v[70:73], a[40:43], a[56:59], v[70:73]
    ds_read_b64_tr_b16 a[20:21], v23 offset:30840
    ds_read_b64_tr_b16 a[22:23], v23 offset:32120
    v_mov_b32 v10, 10
    ds_write_b32 v26, v10 offset:96
    s_waitcnt lgkmcnt(9)
    v_mfma_f32_16x16x32_bf16 v[30:33], a[4:7], a[60:63], v[30:33]
    v_mfma_f32_16x16x32_bf16 v[54:57], a[4:7], a[64:67], v[54:57]
    ds_read_b64_tr_b16 a[24:25], v23 offset:35840
    ds_read_b64_tr_b16 a[26:27], v23 offset:37120
    s_waitcnt lgkmcnt(9)
    v_mfma_f32_16x16x32_bf16 v[34:37], a[8:11], a[60:63], v[34:37]
    v_mfma_f32_16x16x32_bf16 v[58:61], a[8:11], a[64:67], v[58:61]
    ds_read_b64_tr_b16 a[28:29], v23 offset:35880
    ds_read_b64_tr_b16 a[30:31], v23 offset:37160
    s_waitcnt lgkmcnt(9)
    v_mfma_f32_16x16x32_bf16 v[42:45], a[12:15], a[60:63], v[42:45]
    v_mfma_f32_16x16x32_bf16 v[62:65], a[12:15], a[64:67], v[62:65]
    ds_read_b64_tr_b16 a[32:33], v24 offset:35840
    ds_read_b64_tr_b16 a[34:35], v24 offset:37120
    s_waitcnt lgkmcnt(9)
    v_mfma_f32_16x16x32_bf16 v[46:49], a[16:19], a[60:63], v[46:49]
    v_mfma_f32_16x16x32_bf16 v[66:69], a[16:19], a[64:67], v[66:69]
    ds_read_b64_tr_b16 a[36:37], v23 offset:35920
    ds_read_b64_tr_b16 a[38:39], v23 offset:37200
    s_waitcnt lgkmcnt(9)
    v_mfma_f32_16x16x32_bf16 v[50:53], a[20:23], a[60:63], v[50:53]
    v_mfma_f32_16x16x32_bf16 v[70:73], a[20:23], a[64:67], v[70:73]
    ds_read_b64_tr_b16 a[40:41], v23 offset:35960
    ds_read_b64_tr_b16 a[42:43], v23 offset:37240
    s_waitcnt lgkmcnt(8)
    v_mfma_f32_16x16x32_bf16 v[30:33], a[24:27], a[68:71], v[30:33]
    v_mfma_f32_16x16x32_bf16 v[54:57], a[24:27], a[72:75], v[54:57]
    s_waitcnt lgkmcnt(6)
    v_mfma_f32_16x16x32_bf16 v[34:37], a[28:31], a[68:71], v[34:37]
    v_mfma_f32_16x16x32_bf16 v[58:61], a[28:31], a[72:75], v[58:61]
    s_waitcnt lgkmcnt(4)
    v_mfma_f32_16x16x32_bf16 v[42:45], a[32:35], a[68:71], v[42:45]
    v_mfma_f32_16x16x32_bf16 v[62:65], a[32:35], a[72:75], v[62:65]
    s_waitcnt lgkmcnt(2)
    v_mfma_f32_16x16x32_bf16 v[46:49], a[36:39], a[68:71], v[46:49]
    v_mfma_f32_16x16x32_bf16 v[66:69], a[36:39], a[72:75], v[66:69]
    s_waitcnt lgkmcnt(0)
    v_mfma_f32_16x16x32_bf16 v[50:53], a[40:43], a[68:71], v[50:53]
    v_mfma_f32_16x16x32_bf16 v[70:73], a[40:43], a[72:75], v[70:73]
    v_mov_b32 v10, 11
    ds_write_b32 v26, v10 offset:96
    s_setprio 3
    v_add_u32 v8, 155648, v3
    ds_read_b128 a[4:7], v8
    ds_read_b128 a[8:11], v8 offset:1024
    ds_read_b128 a[12:15], v8 offset:2048
    ds_read_b128 a[16:19], v8 offset:3072
    s_add_u32 s40, s53, 151552
    v_add_u32 v8, s40, v3
    ds_write_b128 v8, v[38:41]
    v_mov_b32 v10, 3
    ds_write_b32 v26, v10 offset:176
    ds_read_b32 v12, v27
    s_waitcnt lgkmcnt(0)
    v_cmp_gt_u32 vcc, 1, v12
    s_cbranch_vccnz L_cw_47
L_cn_48:
    s_lshl_b32 s38, s36, 8
    s_add_u32 s38, s38, 160768
    v_lshl_add_u32 v8, v7, 3, s38
    v_lshlrev_b32 v9, 4, v6
    v_add_u32 v9, 160000, v9
    ds_read_b64 v[38:39], v8
    ds_read_b64 v[74:75], v8 offset:128
    ds_read_b128 v[88:91], v9 offset:128
    ds_read_b128 v[80:83], v9
    ds_read_b128 v[84:87], v9 offset:64
    ds_read_b128 v[92:95], v9 offset:192
    ds_read_b128 v[96:99], v9 offset:256
    s_waitcnt lgkmcnt(0)
    v_pk_fma_f32 v[42:43], v[38:39], v[88:89], v[42:43] op_sel_hi:[0,1,1] neg_lo:[1,0,0] neg_hi:[1,0,0]
    v_pk_fma_f32 v[44:45], v[38:39], v[90:91], v[44:45] op_sel_hi:[0,1,1] neg_lo:[1,0,0] neg_hi:[1,0,0]
    v_pk_fma_f32 v[30:31], v[38:39], v[80:81], v[30:31] op_sel_hi:[0,1,1] neg_lo:[1,0,0] neg_hi:[1,0,0]
    v_pk_fma_f32 v[32:33], v[38:39], v[82:83], v[32:33] op_sel_hi:[0,1,1] neg_lo:[1,0,0] neg_hi:[1,0,0]
    v_pk_fma_f32 v[34:35], v[38:39], v[84:85], v[34:35] op_sel_hi:[0,1,1] neg_lo:[1,0,0] neg_hi:[1,0,0]
    v_pk_fma_f32 v[36:37], v[38:39], v[86:87], v[36:37] op_sel_hi:[0,1,1] neg_lo:[1,0,0] neg_hi:[1,0,0]
    v_cvt_pk_bf16_f32 v100, v30, v31
    v_cvt_pk_bf16_f32 v101, v32, v33
    v_cvt_pk_bf16_f32 v102, v42, v43
    v_cvt_pk_bf16_f32 v103, v44, v45
    v_cvt_pk_bf16_f32 v104, v34, v35
    v_cvt_pk_bf16_f32 v105, v36, v37
    v_cvt_pk_bf16_f32 v106, v42, v43
    v_cvt_pk_bf16_f32 v107, v44, v45
    v_pk_fma_f32 v[62:63], v[74:75], v[88:89], v[62:63] op_sel_hi:[0,1,1] neg_lo:[1,0,0] neg_hi:[1,0,0]
    v_pk_fma_f32 v[64:65], v[74:75], v[90:91], v[64:65] op_sel_hi:[0,1,1] neg_lo:[1,0,0] neg_hi:[1,0,0]
    v_pk_fma_f32 v[54:55], v[74:75], v[80:81], v[54:55] op_sel_hi:[0,1,1] neg_lo:[1,0,0] neg_hi:[1,0,0]
    v_pk_fma_f32 v[56:57], v[74:75], v[82:83], v[56:57] op_sel_hi:[0,1,1] neg_lo:[1,0,0] neg_hi:[1,0,0]
    v_pk_fma_f32 v[58:59], v[74:75], v[84:85], v[58:59] op_sel_hi:[0,1,1] neg_lo:[1,0,0] neg_hi:[1,0,0]
    v_pk_fma_f32 v[60:61], v[74:75], v[86:87], v[60:61] op_sel_hi:[0,1,1] neg_lo:[1,0,0] neg_hi:[1,0,0]
    v_cvt_pk_bf16_f32 v108, v54, v55
    v_cvt_pk_bf16_f32 v109, v56, v57
    v_cvt_pk_bf16_f32 v110, v62, v63
    v_cvt_pk_bf16_f32 v111, v64, v65
    v_cvt_pk_bf16_f32 v112, v58, v59
    v_cvt_pk_bf16_f32 v113, v60, v61
    v_cvt_pk_bf16_f32 v114, v62, v63
    v_cvt_pk_bf16_f32 v115, v64, v65
    v_mfma_f32_16x16x32_bf16 v[30:33], a[4:7], v[100:103], 0
    v_mfma_f32_16x16x32_bf16 v[34:37], a[12:15], v[104:107], 0
    v_mfma_f32_16x16x32_bf16 v[54:57], a[4:7], v[108:111], 0
    v_mfma_f32_16x16x32_bf16 v[58:61], a[12:15], v[112:115], 0
    v_mfma_f32_16x16x32_bf16 v[122:125], a[8:11], v[100:103], 0
    v_mfma_f32_16x16x32_bf16 v[126:129], a[8:11], v[108:111], 0
    v_mfma_f32_16x16x32_bf16 v[122:125], a[16:19], v[104:107], v[122:125]
    v_mfma_f32_16x16x32_bf16 v[126:129], a[16:19], v[112:115], v[126:129]
    v_mul_f32 v40, 0x3f317218, v39
    v_mul_f32 v76, 0x3f317218, v75
    v_pk_fma_f32 v[46:47], v[38:39], v[92:93], v[46:47] op_sel_hi:[0,1,1] neg_lo:[1,0,0] neg_hi:[1,0,0]
    v_pk_fma_f32 v[48:49], v[38:39], v[94:95], v[48:49] op_sel_hi:[0,1,1] neg_lo:[1,0,0] neg_hi:[1,0,0]
    v_pk_fma_f32 v[50:51], v[38:39], v[96:97], v[50:51] op_sel_hi:[0,1,1] neg_lo:[1,0,0] neg_hi:[1,0,0]
    v_pk_fma_f32 v[52:53], v[38:39], v[98:99], v[52:53] op_sel_hi:[0,1,1] neg_lo:[1,0,0] neg_hi:[1,0,0]
    v_pk_mul_f32 v[42:43], v[42:43], v[40:41] op_sel_hi:[1,0]
    v_pk_mul_f32 v[44:45], v[44:45], v[40:41] op_sel_hi:[1,0]
    v_pk_mul_f32 v[46:47], v[46:47], v[40:41] op_sel_hi:[1,0]
    v_pk_mul_f32 v[48:49], v[48:49], v[40:41] op_sel_hi:[1,0]
    v_pk_mul_f32 v[50:51], v[50:51], v[40:41] op_sel_hi:[1,0]
    v_pk_mul_f32 v[52:53], v[52:53], v[40:41] op_sel_hi:[1,0]
    v_pk_fma_f32 v[66:67], v[74:75], v[92:93], v[66:67] op_sel_hi:[0,1,1] neg_lo:[1,0,0] neg_hi:[1,0,0]
    v_pk_fma_f32 v[68:69], v[74:75], v[94:95], v[68:69] op_sel_hi:[0,1,1] neg_lo:[1,0,0] neg_hi:[1,0,0]
    v_pk_fma_f32 v[70:71], v[74:75], v[96:97], v[70:71] op_sel_hi:[0,1,1] neg_lo:[1,0,0] neg_hi:[1,0,0]
    v_pk_fma_f32 v[72:73], v[74:75], v[98:99], v[72:73] op_sel_hi:[0,1,1] neg_lo:[1,0,0] neg_hi:[1,0,0]
    v_pk_mul_f32 v[62:63], v[62:63], v[76:77] op_sel_hi:[1,0]
    v_pk_mul_f32 v[64:65], v[64:65], v[76:77] op_sel_hi:[1,0]
    v_pk_mul_f32 v[66:67], v[66:67], v[76:77] op_sel_hi:[1,0]
    v_pk_mul_f32 v[68:69], v[68:69], v[76:77] op_sel_hi:[1,0]
    v_pk_mul_f32 v[70:71], v[70:71], v[76:77] op_sel_hi:[1,0]
    v_pk_mul_f32 v[72:73], v[72:73], v[76:77] op_sel_hi:[1,0]
    v_cvt_pk_bf16_f32 v22, v46, v47
    v_cvt_pk_bf16_f32 v23, v48, v49
    v_cvt_pk_bf16_f32 v116, v50, v51
    v_cvt_pk_bf16_f32 v117, v52, v53
    v_cvt_pk_bf16_f32 v42, v42, 1.0
    v_cvt_pk_bf16_f32 v43, v43, 1.0
    v_cvt_pk_bf16_f32 v44, v44, 1.0
    v_cvt_pk_bf16_f32 v45, v45, 1.0
    v_cvt_pk_bf16_f32 v118, v66, v67
    v_cvt_pk_bf16_f32 v119, v68, v69
    v_cvt_pk_bf16_f32 v120, v70, v71
    v_cvt_pk_bf16_f32 v121, v72, v73
    v_cvt_pk_bf16_f32 v62, v62, 1.0
    v_cvt_pk_bf16_f32 v63, v63, 1.0
    v_cvt_pk_bf16_f32 v64, v64, 1.0
    v_cvt_pk_bf16_f32 v65, v65, 1.0
    v_max3_f32 v46, v30, v31, v32
    v_max3_f32 v47, -v30, -v31, -v32
    v_max3_f32 v48, v34, v35, v36
    v_max3_f32 v49, -v34, -v35, -v36
    v_max3_f32 v50, v54, v55, v56
    v_max3_f32 v51, -v54, -v55, -v56
    v_max3_f32 v52, v58, v59, v60
    v_max3_f32 v53, -v58, -v59, -v60
    v_max3_f32 v46, v46, v33, v122
    v_max3_f32 v47, v47, -v33, -v122
    v_max3_f32 v48, v48, v37, v123
    v_max3_f32 v49, v49, -v37, -v123
    v_max3_f32 v50, v50, v57, v126
    v_max3_f32 v51, v51, -v57, -v126
    v_max3_f32 v52, v52, v61, v127
    v_max3_f32 v53, v53, -v61, -v127
    v_permlane16_swap_b32 v46, v47
    v_permlane16_swap_b32 v48, v49
    v_permlane16_swap_b32 v50, v51
    v_permlane16_swap_b32 v52, v53
    v_max_f32 v46, v46, v47
    v_max_f32 v48, v48, v49
    v_max_f32 v50, v50, v51
    v_max_f32 v52, v52, v53
    v_permlane32_swap_b32 v46, v48
    s_nop 0
    v_permlane32_swap_b32 v50, v52
    v_max_f32 v46, v46, v48
    v_max_f32 v50, v50, v52
    v_mul_f32 v46, v39, v46
    v_mul_f32 v50, v75, v50
    v_mov_b32 v48, v46
    v_mov_b32 v52, v50
    s_nop 0
    v_permlane32_swap_b32 v46, v48
    v_permlane32_swap_b32 v50, v52
    v_mov_b32 v47, v46
    v_mov_b32 v49, v48
    v_mov_b32 v51, v50
    v_mov_b32 v53, v52
    v_permlane16_swap_b32 v46, v47
    v_permlane16_swap_b32 v48, v49
    v_permlane16_swap_b32 v50, v51
    v_permlane16_swap_b32 v52, v53
    v_pk_fma_f32 v[66:67], v[30:31], v[38:39], v[46:47] op_sel:[0,1,1] neg_lo:[1,0,1] neg_hi:[1,0,1]
    v_pk_fma_f32 v[68:69], v[32:33], v[38:39], v[46:47] op_sel:[0,1,1] neg_lo:[1,0,1] neg_hi:[1,0,1]
    v_fma_f32 v114, v122, v39, -v46
    v_fma_f32 v115, -v122, v39, -v47
    v_pk_fma_f32 v[30:31], v[30:31], v[38:39], v[46:47] op_sel:[0,1,0] op_sel_hi:[1,1,0] neg_lo:[0,0,1] neg_hi:[0,0,1]
    v_pk_fma_f32 v[32:33], v[32:33], v[38:39], v[46:47] op_sel:[0,1,0] op_sel_hi:[1,1,0] neg_lo:[0,0,1] neg_hi:[0,0,1]
    v_exp_f32 v66, v66
    v_exp_f32 v67, v67
    v_exp_f32 v68, v68
    v_exp_f32 v69, v69
    v_exp_f32 v114, v114
    v_exp_f32 v115, v115
    v_exp_f32 v30, v30
    v_exp_f32 v31, v31
    v_exp_f32 v32, v32
    v_exp_f32 v33, v33
    v_pk_fma_f32 v[70:71], v[34:35], v[38:39], v[48:49] op_sel:[0,1,1] neg_lo:[1,0,1] neg_hi:[1,0,1]
    v_pk_fma_f32 v[72:73], v[36:37], v[38:39], v[48:49] op_sel:[0,1,1] neg_lo:[1,0,1] neg_hi:[1,0,1]
    v_fma_f32 v130, v123, v39, -v48
    v_fma_f32 v131, -v123, v39, -v49
    v_pk_fma_f32 v[34:35], v[34:35], v[38:39], v[48:49] op_sel:[0,1,0] op_sel_hi:[1,1,0] neg_lo:[0,0,1] neg_hi:[0,0,1]
    v_pk_fma_f32 v[36:37], v[36:37], v[38:39], v[48:49] op_sel:[0,1,0] op_sel_hi:[1,1,0] neg_lo:[0,0,1] neg_hi:[0,0,1]
    v_exp_f32 v70, v70
    v_exp_f32 v71, v71
    v_exp_f32 v72, v72
    v_exp_f32 v73, v73
    v_exp_f32 v130, v130
    v_exp_f32 v131, v131
    v_exp_f32 v34, v34
    v_exp_f32 v35, v35
    v_exp_f32 v36, v36
    v_exp_f32 v37, v37
    v_pk_fma_f32 v[106:107], v[54:55], v[74:75], v[50:51] op_sel:[0,1,1] neg_lo:[1,0,1] neg_hi:[1,0,1]
    v_pk_fma_f32 v[108:109], v[56:57], v[74:75], v[50:51] op_sel:[0,1,1] neg_lo:[1,0,1] neg_hi:[1,0,1]
    v_fma_f32 v132, v126, v75, -v50
    v_fma_f32 v133, -v126, v75, -v51
    v_pk_fma_f32 v[54:55], v[54:55], v[74:75], v[50:51] op_sel:[0,1,0] op_sel_hi:[1,1,0] neg_lo:[0,0,1] neg_hi:[0,0,1]
    v_pk_fma_f32 v[56:57], v[56:57], v[74:75], v[50:51] op_sel:[0,1,0] op_sel_hi:[1,1,0] neg_lo:[0,0,1] neg_hi:[0,0,1]
    v_exp_f32 v106, v106
    v_exp_f32 v107, v107
    v_exp_f32 v108, v108
    v_exp_f32 v109, v109
    v_exp_f32 v132, v132
    v_exp_f32 v133, v133
    v_exp_f32 v54, v54
    v_exp_f32 v55, v55
    v_exp_f32 v56, v56
    v_exp_f32 v57, v57
    v_pk_fma_f32 v[110:111], v[58:59], v[74:75], v[52:53] op_sel:[0,1,1] neg_lo:[1,0,1] neg_hi:[1,0,1]
    v_pk_fma_f32 v[112:113], v[60:61], v[74:75], v[52:53] op_sel:[0,1,1] neg_lo:[1,0,1] neg_hi:[1,0,1]
    v_fma_f32 v134, v127, v75, -v52
    v_fma_f32 v135, -v127, v75, -v53
    v_pk_fma_f32 v[58:59], v[58:59], v[74:75], v[52:53] op_sel:[0,1,0] op_sel_hi:[1,1,0] neg_lo:[0,0,1] neg_hi:[0,0,1]
    v_pk_fma_f32 v[60:61], v[60:61], v[74:75], v[52:53] op_sel:[0,1,0] op_sel_hi:[1,1,0] neg_lo:[0,0,1] neg_hi:[0,0,1]
    v_exp_f32 v110, v110
    v_exp_f32 v111, v111
    v_exp_f32 v112, v112
    v_exp_f32 v113, v113
    v_exp_f32 v134, v134
    v_exp_f32 v135, v135
    v_exp_f32 v58, v58
    v_exp_f32 v59, v59
    v_exp_f32 v60, v60
    v_exp_f32 v61, v61
    v_pk_add_f32 v[122:123], v[30:31], v[32:33]
    v_pk_add_f32 v[80:81], v[66:67], v[68:69]
    v_pk_add_f32 v[124:125], v[34:35], v[36:37]
    v_pk_add_f32 v[86:87], v[70:71], v[72:73]
    v_pk_add_f32 v[126:127], v[54:55], v[56:57]
    v_pk_add_f32 v[92:93], v[106:107], v[108:109]
    v_pk_add_f32 v[128:129], v[58:59], v[60:61]
    v_pk_add_f32 v[98:99], v[110:111], v[112:113]
    v_add_f32 v46, v122, v123
    v_add_f32 v47, v80, v81
    v_add_f32 v48, v124, v125
    v_add_f32 v49, v86, v87
    v_add_f32 v50, v126, v127
    v_add_f32 v51, v92, v93
    v_add_f32 v52, v128, v129
    v_add_f32 v53, v98, v99
    v_pk_add_f32 v[46:47], v[46:47], v[114:115]
    v_pk_add_f32 v[48:49], v[48:49], v[130:131]
    v_pk_add_f32 v[50:51], v[50:51], v[132:133]
    v_pk_add_f32 v[52:53], v[52:53], v[134:135]
    v_permlane16_swap_b32 v46, v47
    v_permlane16_swap_b32 v48, v49
    v_permlane16_swap_b32 v50, v51
    v_permlane16_swap_b32 v52, v53
    v_add_f32 v46, v46, v47
    v_add_f32 v48, v48, v49
    v_add_f32 v50, v50, v51
    v_add_f32 v52, v52, v53
    v_permlane32_swap_b32 v46, v48
    s_nop 0
    v_permlane32_swap_b32 v50, v52
    v_add_f32 v46, v46, v48
    v_add_f32 v50, v50, v52
    v_rcp_f32 v46, v46
    v_rcp_f32 v50, v50
    v_mov_b32 v48, v46
    v_mov_b32 v52, v50
    s_nop 0
    v_permlane32_swap_b32 v46, v48
    v_permlane32_swap_b32 v50, v52
    v_mov_b32 v47, v46
    v_mov_b32 v49, v48
    v_mov_b32 v51, v50
    v_mov_b32 v53, v52
    v_permlane16_swap_b32 v46, v47
    v_permlane16_swap_b32 v48, v49
    v_permlane16_swap_b32 v50, v51
    v_permlane16_swap_b32 v52, v53
    v_pk_mul_f32 v[30:31], v[30:31], v[46:47] op_sel_hi:[1,0]
    v_pk_mul_f32 v[66:67], v[66:67], v[46:47] op_sel:[0,1]
    v_pk_mul_f32 v[32:33], v[32:33], v[46:47] op_sel_hi:[1,0]
    v_pk_mul_f32 v[68:69], v[68:69], v[46:47] op_sel:[0,1]
    v_pk_mul_f32 v[114:115], v[114:115], v[46:47]
    v_pk_mul_f32 v[34:35], v[34:35], v[48:49] op_sel_hi:[1,0]
    v_pk_mul_f32 v[70:71], v[70:71], v[48:49] op_sel:[0,1]
    v_pk_mul_f32 v[36:37], v[36:37], v[48:49] op_sel_hi:[1,0]
    v_pk_mul_f32 v[72:73], v[72:73], v[48:49] op_sel:[0,1]
    v_pk_mul_f32 v[130:131], v[130:131], v[48:49]
    v_pk_mul_f32 v[54:55], v[54:55], v[50:51] op_sel_hi:[1,0]
    v_pk_mul_f32 v[106:107], v[106:107], v[50:51] op_sel:[0,1]
    v_pk_mul_f32 v[56:57], v[56:57], v[50:51] op_sel_hi:[1,0]
    v_pk_mul_f32 v[108:109], v[108:109], v[50:51] op_sel:[0,1]
    v_pk_mul_f32 v[132:133], v[132:133], v[50:51]
    v_pk_mul_f32 v[58:59], v[58:59], v[52:53] op_sel_hi:[1,0]
    v_pk_mul_f32 v[110:111], v[110:111], v[52:53] op_sel:[0,1]
    v_pk_mul_f32 v[60:61], v[60:61], v[52:53] op_sel_hi:[1,0]
    v_pk_mul_f32 v[112:113], v[112:113], v[52:53] op_sel:[0,1]
    v_pk_mul_f32 v[134:135], v[134:135], v[52:53]
    v_cvt_pk_bf16_f32 v80, v30, v31
    v_cvt_pk_bf16_f32 v81, v32, v33
    v_cvt_pk_bf16_f32 v82, v66, v67
    v_cvt_pk_bf16_f32 v83, v68, v69
    v_cvt_pk_bf16_f32 v84, v114, v115
    v_cvt_pk_bf16_f32 v86, v34, v35
    v_cvt_pk_bf16_f32 v87, v36, v37
    v_cvt_pk_bf16_f32 v88, v70, v71
    v_cvt_pk_bf16_f32 v89, v72, v73
    v_cvt_pk_bf16_f32 v90, v130, v131
    v_cvt_pk_bf16_f32 v92, v54, v55
    v_cvt_pk_bf16_f32 v93, v56, v57
    v_cvt_pk_bf16_f32 v94, v106, v107
    v_cvt_pk_bf16_f32 v95, v108, v109
    v_cvt_pk_bf16_f32 v96, v132, v133
    v_cvt_pk_bf16_f32 v98, v58, v59
    v_cvt_pk_bf16_f32 v99, v60, v61
    v_cvt_pk_bf16_f32 v100, v110, v111
    v_cvt_pk_bf16_f32 v101, v112, v113
    v_cvt_pk_bf16_f32 v102, v134, v135
    ds_read_b32 v12, v27 offset:96
    s_waitcnt lgkmcnt(0)
    v_cmp_gt_u32 vcc, 11, v12
    s_cbranch_vccnz L_cw_50
L_cn_51:
    ds_write_b64 v78, v[80:81]
    ds_write_b64 v78, v[82:83] offset:32
    ds_write_b32 v78, v84 offset:64
    ds_write_b64 v78, v[22:23] offset:192
    ds_write_b64 v78, v[86:87] offset:96
    ds_write_b64 v78, v[88:89] offset:128
    ds_write_b32 v78, v90 offset:160
    ds_write_b64 v78, v[116:117] offset:224
    ds_write_b64 v78, v[92:93] offset:4736
    ds_write_b64 v78, v[94:95] offset:4768
    ds_write_b32 v78, v96 offset:4800
    ds_write_b64 v78, v[118:119] offset:4928
    ds_write_b64 v78, v[98:99] offset:4832
    ds_write_b64 v78, v[100:101] offset:4864
    ds_write_b32 v78, v102 offset:4896
    ds_write_b64 v78, v[120:121] offset:4960
    s_mov_b32 exec_lo, 0x0
    s_mov_b32 exec_hi, 0xffffffff
    ds_write_b32 v79, v42 offset:248
    ds_write_b32 v79, v43 offset:256
    ds_write_b32 v79, v44 offset:264
    ds_write_b32 v79, v45 offset:272
    ds_write_b32 v79, v62 offset:4984
    ds_write_b32 v79, v63 offset:4992
    ds_write_b32 v79, v64 offset:5000
    ds_write_b32 v79, v65 offset:5008
    s_mov_b64 exec, -1
    v_mov_b32 v10, 1
    ds_write_b32 v26, v10 offset:16
    ds_read_b32 v12, v27 offset:16
    s_waitcnt lgkmcnt(0)
    v_cmp_gt_u32 vcc, 1, v12
    s_cbranch_vccnz L_cw_53
L_cn_54:
    ds_read_b64_tr_b16 a[52:53], v29
    ds_read_b64_tr_b16 a[54:55], v29 offset:4736
    ds_read_b64_tr_b16 a[4:5], v25
    ds_read_b64_tr_b16 a[6:7], v25 offset:4736
    ds_read_b64_tr_b16 a[8:9], v25 offset:32
    ds_read_b64_tr_b16 a[10:11], v25 offset:4768
    ds_read_b64_tr_b16 a[12:13], v25 offset:64
    ds_read_b64_tr_b16 a[14:15], v25 offset:4800
    ds_read_b64_tr_b16 a[56:57], v29 offset:9472
    ds_read_b64_tr_b16 a[58:59], v29 offset:14208
    ds_read_b64_tr_b16 a[16:17], v25 offset:9472
    ds_read_b64_tr_b16 a[18:19], v25 offset:14208
    ds_read_b64_tr_b16 a[20:21], v25 offset:9504
    ds_read_b64_tr_b16 a[22:23], v25 offset:14240
    ds_read_b64_tr_b16 a[24:25], v25 offset:9536
    ds_read_b64_tr_b16 a[26:27], v25 offset:14272
    s_waitcnt lgkmcnt(8)
    ds_read_b64_tr_b16 a[60:61], v29 offset:18944
    ds_read_b64_tr_b16 a[62:63], v29 offset:23680
    ds_read_b64_tr_b16 a[28:29], v25 offset:18944
    ds_read_b64_tr_b16 a[30:31], v25 offset:23680
    ds_read_b64_tr_b16 a[32:33], v25 offset:18976
    ds_read_b64_tr_b16 a[34:35], v25 offset:23712
    ds_read_b64_tr_b16 a[36:37], v25 offset:19008
    ds_read_b64_tr_b16 a[38:39], v25 offset:23744
    v_mfma_f32_16x16x32_bf16 v[30:33], a[4:7], a[52:55], 0
    v_mfma_f32_16x16x32_bf16 v[34:37], a[8:11], a[52:55], 0
    v_mfma_f32_16x16x32_bf16 v[38:41], a[12:15], a[52:55], 0
    s_waitcnt lgkmcnt(8)
    ds_read_b64_tr_b16 a[64:65], v29 offset:28416
    ds_read_b64_tr_b16 a[66:67], v29 offset:33152
    ds_read_b64_tr_b16 a[40:41], v25 offset:28416
    ds_read_b64_tr_b16 a[42:43], v25 offset:33152
    ds_read_b64_tr_b16 a[44:45], v25 offset:28448
    ds_read_b64_tr_b16 a[46:47], v25 offset:33184
    ds_read_b64_tr_b16 a[48:49], v25 offset:28480
    ds_read_b64_tr_b16 a[50:51], v25 offset:33216
    v_mfma_f32_16x16x32_bf16 v[30:33], a[16:19], a[56:59], v[30:33]
    v_mfma_f32_16x16x32_bf16 v[34:37], a[20:23], a[56:59], v[34:37]
    v_mfma_f32_16x16x32_bf16 v[38:41], a[24:27], a[56:59], v[38:41]
    s_waitcnt lgkmcnt(8)
    v_mfma_f32_16x16x32_bf16 v[30:33], a[28:31], a[60:63], v[30:33]
    v_mfma_f32_16x16x32_bf16 v[34:37], a[32:35], a[60:63], v[34:37]
    v_mfma_f32_16x16x32_bf16 v[38:41], a[36:39], a[60:63], v[38:41]
    s_waitcnt lgkmcnt(0)
    v_mov_b32 v10, 1
    ds_write_b32 v26, v10 offset:32
    v_mfma_f32_16x16x32_bf16 v[30:33], a[40:43], a[64:67], v[30:33]
    v_mfma_f32_16x16x32_bf16 v[34:37], a[44:47], a[64:67], v[34:37]
    v_mfma_f32_16x16x32_bf16 v[38:41], a[48:51], a[64:67], v[38:41]
    s_mov_b64 exec, s[76:77]
    s_nop 4
    buffer_atomic_add_f32 v30, v4, s[24:27], s70 offen
    buffer_atomic_add_f32 v31, v4, s[24:27], s70 offen offset:256
    buffer_atomic_add_f32 v32, v4, s[24:27], s70 offen offset:512
    buffer_atomic_add_f32 v33, v4, s[24:27], s70 offen offset:768
    buffer_atomic_add_f32 v34, v4, s[24:27], s70 offen offset:1024
    buffer_atomic_add_f32 v35, v4, s[24:27], s70 offen offset:1280
    buffer_atomic_add_f32 v36, v4, s[24:27], s70 offen offset:1536
    buffer_atomic_add_f32 v37, v4, s[24:27], s70 offen offset:1792
    buffer_atomic_add_f32 v38, v4, s[24:27], s70 offen offset:2048
    buffer_atomic_add_f32 v39, v4, s[24:27], s70 offen offset:2304
    s_mov_b64 exec, -1
    s_waitcnt vmcnt(0)
    v_mov_b32 v10, 1
    ds_write_b32 v26, v10 offset:976
    s_cmp_lg_u32 s36, 0
    s_cbranch_scc1 L_pub_56
    ds_read_b32 v12, v27 offset:976
    s_waitcnt lgkmcnt(0)
    v_cmp_gt_u32 vcc, 1, v12
    s_cbranch_vccnz L_cw_57
L_cn_58:
    s_add_u32 s45, s56, 32768
    s_mov_b64 exec, 1
    buffer_store_dwordx4 v[16:19], v11, s[24:27], s45 offen sc1
    s_mov_b64 exec, -1
L_pub_56:
    s_setprio 0
    ds_read_b32 v12, v27 offset:1008
    s_waitcnt lgkmcnt(0)
    v_cmp_gt_u32 vcc, 1, v12
    s_cbranch_vccnz L_cw_60
L_cn_61:
    global_load_dword v28, v0, s[96:97]
    ds_read_b32 v12, v27 offset:32
    s_waitcnt lgkmcnt(0)
    v_cmp_gt_u32 vcc, 1, v12
    s_cbranch_vccnz L_cw_63
L_cn_64:
    s_add_u32 s51, s64, 49152
    s_add_u32 m0, s53, 0
    s_nop 0
    buffer_load_dwordx4 v3, s[24:27], s51 offen sc1 lds
    s_add_u32 s51, s64, 53248
    s_add_u32 m0, s53, 4096
    s_nop 0
    buffer_load_dwordx4 v3, s[24:27], s51 offen sc1 lds
    s_add_u32 s51, s64, 57344
    s_add_u32 m0, s53, 8192
    s_nop 0
    buffer_load_dwordx4 v3, s[24:27], s51 offen sc1 lds
    s_add_u32 s51, s64, 61440
    s_add_u32 m0, s53, 12288
    s_nop 0
    buffer_load_dwordx4 v3, s[24:27], s51 offen sc1 lds
    s_add_u32 s51, s64, 65536
    s_add_u32 m0, s53, 16384
    s_nop 0
    buffer_load_dwordx4 v3, s[24:27], s51 offen sc1 lds
    s_add_u32 s51, s64, 69632
    s_add_u32 m0, s53, 20480
    s_nop 0
    buffer_load_dwordx4 v3, s[24:27], s51 offen sc1 lds
    s_add_u32 s51, s64, 73728
    s_add_u32 m0, s53, 24576
    s_nop 0
    buffer_load_dwordx4 v3, s[24:27], s51 offen sc1 lds
    s_waitcnt vmcnt(7)
    s_add_u32 s51, s64, 77824
    s_add_u32 m0, s53, 28672
    s_nop 0
    buffer_load_dwordx4 v3, s[24:27], s51 offen sc1 lds
    s_waitcnt vmcnt(7)
    s_add_u32 s51, s64, 81920
    s_add_u32 m0, s53, 32768
    s_nop 0
    buffer_load_dwordx4 v3, s[24:27], s51 offen sc1 lds
    s_waitcnt vmcnt(7)
    s_add_u32 s51, s64, 86016
    s_add_u32 m0, s53, 36864
    s_nop 0
    buffer_load_dwordx4 v3, s[24:27], s51 offen sc1 lds
    v_mul_u32_u24 v21, 1280, v7
    v_lshl_add_u32 v21, v6, 3, v21
    s_mul_i32 s38, s60, 20480
    s_mul_i32 s70, s58, 160
    s_add_u32 s70, s70, s38
    buffer_load_dwordx2 v[22:23], v21, s[28:31], s70 offen
    buffer_load_dwordx2 v[24:25], v21, s[28:31], s70 offen offset:32
    buffer_load_dwordx2 v[30:31], v21, s[28:31], s70 offen offset:64
    buffer_load_dwordx2 v[32:33], v21, s[28:31], s70 offen offset:96
    buffer_load_dwordx2 v[34:35], v21, s[28:31], s70 offen offset:128
    s_mul_i32 s38, s35, 448
    s_mul_i32 s40, s35, 384
    s_add_u32 s40, s40, 768
    s_cmp_ge_u32 s35, 12
    s_cselect_b32 s38, s40, s38
    s_add_u32 s38, s38, 393216
    s_lshl_b32 s39, s36, 7
    s_add_u32 s38, s38, s39
    v_and_b32 v8, 3, v2
    v_lshlrev_b32 v8, 13, v8
    v_lshl_add_u32 v8, v6, 4, v8
    buffer_load_dwordx4 v[36:39], v8, s[24:27], s38 offen sc1
    buffer_load_dwordx4 v[40:43], v8, s[24:27], s38 offen offset:64 sc1
    ds_read_b32 v12, v27 offset:48
    s_waitcnt lgkmcnt(0)
    v_cmp_gt_u32 vcc, 1, v12
    s_cbranch_vccnz L_cw_66
L_cn_67:
    s_waitcnt vmcnt(7)
    s_add_u32 s51, s64, 90112
    s_add_u32 m0, s53, 126976
    s_nop 0
    buffer_load_dwordx4 v3, s[24:27], s51 offen sc1 lds
    s_waitcnt vmcnt(7)
    s_add_u32 s51, s64, 94208
    s_add_u32 m0, s53, 131072
    s_nop 0
    buffer_load_dwordx4 v3, s[24:27], s51 offen sc1 lds
    s_waitcnt vmcnt(7)
    s_add_u32 s51, s64, 98304
    s_add_u32 m0, s53, 135168
    s_nop 0
    buffer_load_dwordx4 v3, s[24:27], s51 offen sc1 lds
    s_waitcnt vmcnt(7)
    s_add_u32 s51, s65, 0
    s_add_u32 m0, s53, 139264
    s_nop 0
    buffer_load_dwordx4 v3, s[24:27], s51 offen sc1 lds
    s_waitcnt vmcnt(7)
    s_add_u32 s51, s65, 4096
    s_add_u32 m0, s53, 143360
    s_nop 0
    buffer_load_dwordx4 v3, s[24:27], s51 offen sc1 lds
    s_waitcnt vmcnt(7)
    s_add_u32 s51, s65, 8192
    s_add_u32 m0, s53, 147456
    s_nop 0
    buffer_load_dwordx4 v3, s[24:27], s51 offen sc1 lds
    s_waitcnt vmcnt(7)
    s_add_u32 s51, s65, 12288
    s_add_u32 m0, s53, 40960
    s_nop 0
    buffer_load_dwordx4 v3, s[24:27], s51 offen sc1 lds
    s_waitcnt vmcnt(7)
    s_add_u32 s51, s65, 16384
    s_add_u32 m0, s53, 45056
    s_nop 0
    buffer_load_dwordx4 v3, s[24:27], s51 offen sc1 lds
    s_waitcnt vmcnt(7)
    s_add_u32 s51, s65, 20480
    s_add_u32 m0, s53, 49152
    s_nop 0
    buffer_load_dwordx4 v3, s[24:27], s51 offen sc1 lds
    s_waitcnt vmcnt(7)
    s_add_u32 s51, s65, 24576
    s_add_u32 m0, s53, 94208
    s_nop 0
    buffer_load_dwordx4 v3, s[24:27], s51 offen sc1 lds
    s_waitcnt vmcnt(7)
    s_add_u32 s51, s65, 28672
    s_add_u32 m0, s53, 98304
    s_nop 0
    buffer_load_dwordx4 v3, s[24:27], s51 offen sc1 lds
    s_waitcnt vmcnt(7)
    s_add_u32 s51, s65, 32768
    s_add_u32 m0, s53, 102400
    s_nop 0
    buffer_load_dwordx4 v3, s[24:27], s51 offen sc1 lds
    s_waitcnt vmcnt(7)
    s_add_u32 s51, s65, 36864
    s_add_u32 m0, s53, 110592
    s_nop 0
    buffer_load_dwordx4 v3, s[24:27], s51 offen sc1 lds
    s_waitcnt vmcnt(7)
    s_add_u32 s51, s65, 40960
    s_add_u32 m0, s53, 114688
    s_nop 0
    buffer_load_dwordx4 v3, s[24:27], s51 offen sc1 lds
    s_waitcnt vmcnt(7)
    s_add_u32 s51, s65, 45056
    s_add_u32 m0, s53, 118784
    s_nop 0
    buffer_load_dwordx4 v3, s[24:27], s51 offen sc1 lds
    v_add_f32 v36, v36, v36 quad_perm:[1,0,3,2] row_mask:0xf bank_mask:0xf
    v_add_f32 v37, v37, v37 quad_perm:[1,0,3,2] row_mask:0xf bank_mask:0xf
    v_add_f32 v38, v38, v38 quad_perm:[1,0,3,2] row_mask:0xf bank_mask:0xf
    v_add_f32 v39, v39, v39 quad_perm:[1,0,3,2] row_mask:0xf bank_mask:0xf
    v_add_f32 v40, v40, v40 quad_perm:[1,0,3,2] row_mask:0xf bank_mask:0xf
    v_add_f32 v41, v41, v41 quad_perm:[1,0,3,2] row_mask:0xf bank_mask:0xf
    v_add_f32 v42, v42, v42 quad_perm:[1,0,3,2] row_mask:0xf bank_mask:0xf
    v_add_f32 v43, v43, v43 quad_perm:[1,0,3,2] row_mask:0xf bank_mask:0xf
    v_add_f32 v36, v36, v36 quad_perm:[2,3,0,1] row_mask:0xf bank_mask:0xf
    v_add_f32 v37, v37, v37 quad_perm:[2,3,0,1] row_mask:0xf bank_mask:0xf
    v_add_f32 v38, v38, v38 quad_perm:[2,3,0,1] row_mask:0xf bank_mask:0xf
    v_add_f32 v39, v39, v39 quad_perm:[2,3,0,1] row_mask:0xf bank_mask:0xf
    v_add_f32 v40, v40, v40 quad_perm:[2,3,0,1] row_mask:0xf bank_mask:0xf
    v_add_f32 v41, v41, v41 quad_perm:[2,3,0,1] row_mask:0xf bank_mask:0xf
    v_add_f32 v42, v42, v42 quad_perm:[2,3,0,1] row_mask:0xf bank_mask:0xf
    v_add_f32 v43, v43, v43 quad_perm:[2,3,0,1] row_mask:0xf bank_mask:0xf
    s_add_u32 s39, s39, 160000
    v_lshl_add_u32 v8, v6, 4, s39
    ds_write_b128 v8, v[36:39]
    ds_write_b128 v8, v[40:43] offset:64
    s_waitcnt vmcnt(0) lgkmcnt(0)
    v_mov_b32 v10, 1
    ds_write_b32 v26, v10 offset:64
    v_add_u32 v18, 0x10000, v3
    v_add_u32 v19, 0x20000, v3
    s_lshl_b32 s42, s34, 11
    s_lshl_b32 s43, s59, 6
    s_add_u32 s42, s42, s43
    s_lshr_b32 s43, s36, 1
    s_lshl_b32 s43, s43, 5
    s_add_u32 s42, s42, s43
    v_lshl_add_u32 v20, v7, 7, s42
    s_mul_i32 s71, s60, 20480
    s_add_u32 s71, s71, 6422528
    v_mov_b32 v28, 0
    v_mov_b32 v29, 0
    v_mov_b32 v38, 0x3f803f80
    ds_read_b32 v12, v27 offset:64
    s_waitcnt lgkmcnt(0)
    v_cmp_gt_u32 vcc, 1, v12
    s_cbranch_vccnz L_cw_69
L_cn_70:
    s_mov_b64 exec, 0xffff
    s_mov_b32 s48, 200000
    s_mov_b32 s45, 131072
L_pt_72:
    buffer_load_dwordx2 v[12:13], v20, s[24:27], s45 offen sc1
    s_waitcnt vmcnt(0)
L_pc_74:
    v_cmp_ne_u64_e64 vcc, s[32:33], v[12:13]
    s_cbranch_vccz L_pn_73
    s_mov_b64 exec, vcc
    s_sub_u32 s48, s48, 1
    s_cmp_lg_u32 s48, 0
    s_cbranch_scc1 L_pt_72
L_pn_73:
    s_mov_b64 exec, -1
    buffer_load_dwordx4 a[4:7], v3, s[24:27], s71 offen sc1
    buffer_load_dwordx4 a[8:11], v3, s[24:27], s71 offen offset:1024 sc1
    buffer_load_dwordx4 a[12:15], v3, s[24:27], s71 offen offset:2048 sc1
    buffer_load_dwordx4 a[16:19], v3, s[24:27], s71 offen offset:3072 sc1
    s_add_u32 s76, s71, 4096
    buffer_load_dwordx4 a[20:23], v3, s[24:27], s76 offen sc1
    buffer_load_dwordx4 a[24:27], v3, s[24:27], s76 offen offset:1024 sc1
    ds_read_b32 v12, v27 offset:80
    s_waitcnt lgkmcnt(0)
    v_cmp_gt_u32 vcc, 21, v12
    s_cbranch_vccnz L_cw_75
L_cn_76:
    ds_read_b128 a[84:87], v3 offset:53248
    ds_read_b128 a[88:91], v3 offset:54272
    ds_read_b128 a[92:95], v3 offset:55296
    ds_read_b128 a[96:99], v3 offset:56320
    ds_read_b128 a[100:103], v3 offset:57344
    ds_read_b128 a[104:107], v3 offset:58368
    ds_read_b128 v[48:51], v3 offset:59392
    ds_read_b128 v[52:55], v3 offset:60416
    ds_read_b128 v[56:59], v3 offset:61440
    ds_read_b128 v[60:63], v3 offset:62464
    s_waitcnt vmcnt(5) lgkmcnt(8)
    buffer_load_dwordx4 a[28:31], v3, s[24:27], s76 offen offset:2048 sc1
    v_mfma_f32_16x16x32_bf16 v[40:43], a[84:87], a[4:7], 0
    ds_read_b128 v[64:67], v3 offset:63488
    v_mfma_f32_16x16x32_bf16 v[44:47], a[88:91], a[4:7], 0
    buffer_load_dwordx4 a[32:35], v3, s[24:27], s76 offen offset:3072 sc1
    ds_read_b128 v[68:71], v3 offset:64512
    s_waitcnt vmcnt(6) lgkmcnt(8)
    v_mfma_f32_16x16x32_bf16 v[40:43], a[92:95], a[8:11], v[40:43]
    s_add_u32 s76, s71, 8192
    buffer_load_dwordx4 a[36:39], v3, s[24:27], s76 offen sc1
    ds_read_b128 a[84:87], v18
    v_mfma_f32_16x16x32_bf16 v[44:47], a[96:99], a[8:11], v[44:47]
    ds_read_b128 a[88:91], v18 offset:1024
    buffer_load_dwordx4 a[40:43], v3, s[24:27], s76 offen offset:1024 sc1
    s_waitcnt vmcnt(7) lgkmcnt(8)
    v_mfma_f32_16x16x32_bf16 v[40:43], a[100:103], a[12:15], v[40:43]
    ds_read_b128 a[92:95], v18 offset:2048
    buffer_load_dwordx4 a[44:47], v3, s[24:27], s76 offen offset:2048 sc1
    v_mfma_f32_16x16x32_bf16 v[44:47], a[104:107], a[12:15], v[44:47]
    ds_read_b128 a[96:99], v18 offset:3072
    s_waitcnt vmcnt(7) lgkmcnt(8)
    buffer_load_dwordx4 a[48:51], v3, s[24:27], s76 offen offset:3072 sc1
    v_mfma_f32_16x16x32_bf16 v[40:43], v[48:51], a[16:19], v[40:43]
    ds_read_b128 a[100:103], v18 offset:4096
    v_mfma_f32_16x16x32_bf16 v[44:47], v[52:55], a[16:19], v[44:47]
    s_add_u32 s76, s71, 12288
    buffer_load_dwordx4 a[52:55], v3, s[24:27], s76 offen sc1
    ds_read_b128 a[104:107], v18 offset:5120
    s_waitcnt vmcnt(8) lgkmcnt(8)
    v_mfma_f32_16x16x32_bf16 v[40:43], v[56:59], a[20:23], v[40:43]
    buffer_load_dwordx4 a[56:59], v3, s[24:27], s76 offen offset:1024 sc1
    ds_read_b128 v[48:51], v18 offset:6144
    v_mfma_f32_16x16x32_bf16 v[44:47], v[60:63], a[20:23], v[44:47]
    ds_read_b128 v[52:55], v18 offset:7168
    buffer_load_dwordx4 a[60:63], v3, s[24:27], s76 offen offset:2048 sc1
    v_mov_b32 v10, 13
    ds_write_b32 v26, v10 offset:96
    s_waitcnt vmcnt(9) lgkmcnt(9)
    v_mfma_f32_16x16x32_bf16 v[40:43], v[64:67], a[24:27], v[40:43]
    buffer_load_dwordx4 a[64:67], v3, s[24:27], s76 offen offset:3072 sc1
    ds_read_b128 v[56:59], v18 offset:8192
    v_mfma_f32_16x16x32_bf16 v[44:47], v[68:71], a[24:27], v[44:47]
    ds_read_b128 v[60:63], v18 offset:9216
    s_add_u32 s76, s71, 16384
    buffer_load_dword a68, v4, s[24:27], s76 offen sc1
    s_waitcnt vmcnt(10) lgkmcnt(9)
    v_mfma_f32_16x16x32_bf16 v[40:43], a[84:87], a[28:31], v[40:43]
    buffer_load_dword a69, v4, s[24:27], s76 offen offset:256 sc1
    ds_read_b128 v[64:67], v18 offset:10240
    v_mfma_f32_16x16x32_bf16 v[44:47], a[88:91], a[28:31], v[44:47]
    buffer_load_dword a70, v4, s[24:27], s76 offen offset:512 sc1
    ds_read_b128 v[68:71], v18 offset:11264
    s_waitcnt vmcnt(11) lgkmcnt(9)
    buffer_load_dword a71, v4, s[24:27], s76 offen offset:768 sc1
    v_mfma_f32_16x16x32_bf16 v[40:43], a[92:95], a[32:35], v[40:43]
    buffer_load_dword a72, v4, s[24:27], s76 offen offset:1024 sc1
    ds_read_b128 a[84:87], v18 offset:12288
    v_mfma_f32_16x16x32_bf16 v[44:47], a[96:99], a[32:35], v[44:47]
    buffer_load_dword a73, v4, s[24:27], s76 offen offset:1280 sc1
    ds_read_b128 a[88:91], v18 offset:13312
    s_waitcnt vmcnt(13) lgkmcnt(9)
    buffer_load_dword a74, v4, s[24:27], s76 offen offset:1536 sc1
    v_mfma_f32_16x16x32_bf16 v[40:43], a[100:103], a[36:39], v[40:43]
    buffer_load_dword a75, v4, s[24:27], s76 offen offset:1792 sc1
    ds_read_b128 a[92:95], v18 offset:14336
    v_mfma_f32_16x16x32_bf16 v[44:47], a[104:107], a[36:39], v[44:47]
    buffer_load_dword a76, v4, s[24:27], s76 offen offset:2048 sc1
    ds_read_b128 a[96:99], v18 offset:15360
    s_waitcnt vmcnt(15) lgkmcnt(9)
    buffer_load_dword a77, v4, s[24:27], s76 offen offset:2304 sc1
    v_mfma_f32_16x16x32_bf16 v[40:43], v[48:51], a[40:43], v[40:43]
    buffer_load_dword a78, v4, s[24:27], s76 offen offset:2560 sc1
    ds_read_b128 a[100:103], v18 offset:16384
    v_mfma_f32_16x16x32_bf16 v[44:47], v[52:55], a[40:43], v[44:47]
    buffer_load_dword a79, v4, s[24:27], s76 offen offset:2816 sc1
    ds_read_b128 a[104:107], v18 offset:17408
    v_mov_b32 v10, 16
    buffer_load_dword a80, v4, s[24:27], s76 offen offset:3072 sc1
    ds_write_b32 v26, v10 offset:96
    s_waitcnt vmcnt(18) lgkmcnt(9)
    buffer_load_dword a81, v4, s[24:27], s76 offen offset:3328 sc1
    v_mfma_f32_16x16x32_bf16 v[40:43], v[56:59], a[44:47], v[40:43]
    buffer_load_dword a82, v4, s[24:27], s76 offen offset:3584 sc1
    ds_read_b128 v[48:51], v18 offset:18432
    v_mfma_f32_16x16x32_bf16 v[44:47], v[60:63], a[44:47], v[44:47]
    buffer_load_dword a83, v4, s[24:27], s76 offen offset:3840 sc1
    ds_read_b128 v[52:55], v18 offset:19456
    s_waitcnt vmcnt(20) lgkmcnt(9)
    v_mfma_f32_16x16x32_bf16 v[40:43], v[64:67], a[48:51], v[40:43]
    ds_read_b128 v[56:59], v18 offset:20480
    v_mfma_f32_16x16x32_bf16 v[44:47], v[68:71], a[48:51], v[44:47]
    ds_read_b128 v[60:63], v18 offset:21504
    s_waitcnt vmcnt(19) lgkmcnt(9)
    v_mfma_f32_16x16x32_bf16 v[40:43], a[84:87], a[52:55], v[40:43]
    ds_read_b128 v[64:67], v18 offset:22528
    v_mfma_f32_16x16x32_bf16 v[44:47], a[88:91], a[52:55], v[44:47]
    ds_read_b128 v[68:71], v18 offset:23552
    s_waitcnt vmcnt(18) lgkmcnt(9)
    v_mfma_f32_16x16x32_bf16 v[40:43], a[92:95], a[56:59], v[40:43]
    ds_read_b128 a[84:87], v18 offset:24576
    v_mfma_f32_16x16x32_bf16 v[44:47], a[96:99], a[56:59], v[44:47]
    ds_read_b128 a[88:91], v18 offset:25600
    s_waitcnt vmcnt(17) lgkmcnt(9)
    v_mfma_f32_16x16x32_bf16 v[40:43], a[100:103], a[60:63], v[40:43]
    ds_read_b128 a[92:95], v18 offset:26624
    v_mfma_f32_16x16x32_bf16 v[44:47], a[104:107], a[60:63], v[44:47]
    ds_read_b128 a[96:99], v18 offset:27648
    v_mov_b32 v10, 18
    ds_write_b32 v26, v10 offset:96
    s_waitcnt vmcnt(16) lgkmcnt(9)
    v_mfma_f32_16x16x32_bf16 v[40:43], v[48:51], a[64:67], v[40:43]
    v_mfma_f32_16x16x32_bf16 v[44:47], v[52:55], a[64:67], v[44:47]
    s_waitcnt vmcnt(12) lgkmcnt(7)
    v_mfma_f32_16x16x32_bf16 v[40:43], v[56:59], a[68:71], v[40:43]
    v_mfma_f32_16x16x32_bf16 v[44:47], v[60:63], a[68:71], v[44:47]
    s_waitcnt vmcnt(8) lgkmcnt(5)
    v_mfma_f32_16x16x32_bf16 v[40:43], v[64:67], a[72:75], v[40:43]
    v_mfma_f32_16x16x32_bf16 v[44:47], v[68:71], a[72:75], v[44:47]
    s_waitcnt vmcnt(4) lgkmcnt(3)
    v_mfma_f32_16x16x32_bf16 v[40:43], a[84:87], a[76:79], v[40:43]
    v_mfma_f32_16x16x32_bf16 v[44:47], a[88:91], a[76:79], v[44:47]
    s_waitcnt vmcnt(0) lgkmcnt(1)
    v_mfma_f32_16x16x32_bf16 v[40:43], a[92:95], a[80:83], v[40:43]
    v_mfma_f32_16x16x32_bf16 v[44:47], a[96:99], a[80:83], v[44:47]
    v_mov_b32 v10, 21
    ds_write_b32 v26, v10 offset:96
    v_lshlrev_b32 v36, 16, v22
    v_and_b32 v37, 0xffff0000, v22
    s_nop 2
    v_add_f32 v36, v36, v40
    v_add_f32 v37, v37, v41
    v_cvt_pk_bf16_f32 v48, v36, v37
    v_lshlrev_b32 v36, 16, v23
    v_and_b32 v37, 0xffff0000, v23
    v_add_f32 v36, v36, v42
    v_add_f32 v37, v37, v43
    v_cvt_pk_bf16_f32 v49, v36, v37
    v_lshlrev_b32 v36, 16, v24
    v_and_b32 v37, 0xffff0000, v24
    v_add_f32 v36, v36, v44
    v_add_f32 v37, v37, v45
    v_cvt_pk_bf16_f32 v50, v36, v37
    v_lshlrev_b32 v36, 16, v25
    v_and_b32 v37, 0xffff0000, v25
    v_add_f32 v36, v36, v46
    v_add_f32 v37, v37, v47
    v_cvt_pk_bf16_f32 v51, v36, v37
    buffer_store_dwordx4 v[48:51], v3, s[24:27], s84 offen sc1
    v_dot2_f32_bf16 v28, v48, v38, v28
    v_dot2_f32_bf16 v28, v49, v38, v28
    v_dot2_f32_bf16 v28, v50, v38, v28
    v_dot2_f32_bf16 v28, v51, v38, v28
    v_dot2_f32_bf16 v29, v48, v48, v29
    v_dot2_f32_bf16 v29, v49, v49, v29
    v_dot2_f32_bf16 v29, v50, v50, v29
    v_dot2_f32_bf16 v29, v51, v51, v29
    ds_read_b128 a[84:87], v18 offset:40960
    ds_read_b128 a[88:91], v18 offset:41984
    ds_read_b128 a[92:95], v18 offset:43008
    ds_read_b128 a[96:99], v18 offset:44032
    ds_read_b128 a[100:103], v18 offset:57344
    ds_read_b128 a[104:107], v18 offset:58368
    ds_read_b128 v[60:63], v18 offset:59392
    ds_read_b128 v[64:67], v18 offset:60416
    ds_read_b128 v[68:71], v3
    ds_read_b128 v[72:75], v3 offset:1024
    s_waitcnt lgkmcnt(8)
    v_mfma_f32_16x16x32_bf16 v[52:55], a[84:87], a[4:7], 0
    ds_read_b128 v[76:79], v3 offset:2048
    v_mfma_f32_16x16x32_bf16 v[56:59], a[88:91], a[4:7], 0
    ds_read_b128 v[80:83], v3 offset:3072
    s_waitcnt lgkmcnt(8)
    v_mfma_f32_16x16x32_bf16 v[52:55], a[92:95], a[8:11], v[52:55]
    ds_read_b128 a[84:87], v3 offset:4096
    v_mfma_f32_16x16x32_bf16 v[56:59], a[96:99], a[8:11], v[56:59]
    ds_read_b128 a[88:91], v3 offset:5120
    s_waitcnt lgkmcnt(8)
    v_mfma_f32_16x16x32_bf16 v[52:55], a[100:103], a[12:15], v[52:55]
    ds_read_b128 a[92:95], v3 offset:6144
    v_mfma_f32_16x16x32_bf16 v[56:59], a[104:107], a[12:15], v[56:59]
    ds_read_b128 a[96:99], v3 offset:7168
    s_waitcnt lgkmcnt(8)
    v_mfma_f32_16x16x32_bf16 v[52:55], v[60:63], a[16:19], v[52:55]
    ds_read_b128 a[100:103], v3 offset:8192
    v_mfma_f32_16x16x32_bf16 v[56:59], v[64:67], a[16:19], v[56:59]
    ds_read_b128 a[104:107], v3 offset:9216
    s_waitcnt lgkmcnt(8)
    v_mfma_f32_16x16x32_bf16 v[52:55], v[68:71], a[20:23], v[52:55]
    ds_read_b128 v[60:63], v3 offset:10240
    v_mfma_f32_16x16x32_bf16 v[56:59], v[72:75], a[20:23], v[56:59]
    ds_read_b128 v[64:67], v3 offset:11264
    v_mov_b32 v10, 23
    ds_write_b32 v26, v10 offset:96
    s_waitcnt lgkmcnt(9)
    v_mfma_f32_16x16x32_bf16 v[52:55], v[76:79], a[24:27], v[52:55]
    ds_read_b128 v[68:71], v3 offset:12288
    v_mfma_f32_16x16x32_bf16 v[56:59], v[80:83], a[24:27], v[56:59]
    ds_read_b128 v[72:75], v3 offset:13312
    s_waitcnt lgkmcnt(9)
    v_mfma_f32_16x16x32_bf16 v[52:55], a[84:87], a[28:31], v[52:55]
    ds_read_b128 v[76:79], v3 offset:14336
    v_mfma_f32_16x16x32_bf16 v[56:59], a[88:91], a[28:31], v[56:59]
    ds_read_b128 v[80:83], v3 offset:15360
    s_waitcnt lgkmcnt(9)
    v_mfma_f32_16x16x32_bf16 v[52:55], a[92:95], a[32:35], v[52:55]
    ds_read_b128 a[84:87], v3 offset:16384
    v_mfma_f32_16x16x32_bf16 v[56:59], a[96:99], a[32:35], v[56:59]
    ds_read_b128 a[88:91], v3 offset:17408
    s_waitcnt lgkmcnt(9)
    v_mfma_f32_16x16x32_bf16 v[52:55], a[100:103], a[36:39], v[52:55]
    ds_read_b128 a[92:95], v3 offset:18432
    v_mfma_f32_16x16x32_bf16 v[56:59], a[104:107], a[36:39], v[56:59]
    ds_read_b128 a[96:99], v3 offset:19456
    s_waitcnt lgkmcnt(9)
    v_mfma_f32_16x16x32_bf16 v[52:55], v[60:63], a[40:43], v[52:55]
    ds_read_b128 a[100:103], v3 offset:20480
    v_mfma_f32_16x16x32_bf16 v[56:59], v[64:67], a[40:43], v[56:59]
    ds_read_b128 a[104:107], v3 offset:21504
    v_mov_b32 v10, 26
    ds_write_b32 v26, v10 offset:96
    s_waitcnt lgkmcnt(9)
    v_mfma_f32_16x16x32_bf16 v[52:55], v[68:71], a[44:47], v[52:55]
    ds_read_b128 v[60:63], v3 offset:22528
    v_mfma_f32_16x16x32_bf16 v[56:59], v[72:75], a[44:47], v[56:59]
    ds_read_b128 v[64:67], v3 offset:23552
    s_waitcnt lgkmcnt(9)
    v_mfma_f32_16x16x32_bf16 v[52:55], v[76:79], a[48:51], v[52:55]
    ds_read_b128 v[68:71], v3 offset:24576
    v_mfma_f32_16x16x32_bf16 v[56:59], v[80:83], a[48:51], v[56:59]
    ds_read_b128 v[72:75], v3 offset:25600
    s_waitcnt lgkmcnt(9)
    v_mfma_f32_16x16x32_bf16 v[52:55], a[84:87], a[52:55], v[52:55]
    ds_read_b128 v[76:79], v3 offset:26624
    v_mfma_f32_16x16x32_bf16 v[56:59], a[88:91], a[52:55], v[56:59]
    ds_read_b128 v[80:83], v3 offset:27648
    s_waitcnt lgkmcnt(9)
    v_mfma_f32_16x16x32_bf16 v[52:55], a[92:95], a[56:59], v[52:55]
    ds_read_b128 a[84:87], v3 offset:28672
    v_mfma_f32_16x16x32_bf16 v[56:59], a[96:99], a[56:59], v[56:59]
    ds_read_b128 a[88:91], v3 offset:29696
    s_waitcnt lgkmcnt(9)
    v_mfma_f32_16x16x32_bf16 v[52:55], a[100:103], a[60:63], v[52:55]
    ds_read_b128 a[92:95], v3 offset:30720
    v_mfma_f32_16x16x32_bf16 v[56:59], a[104:107], a[60:63], v[56:59]
    ds_read_b128 a[96:99], v3 offset:31744
    v_mov_b32 v10, 28
    ds_write_b32 v26, v10 offset:96
    s_waitcnt lgkmcnt(9)
    v_mfma_f32_16x16x32_bf16 v[52:55], v[60:63], a[64:67], v[52:55]
    v_mfma_f32_16x16x32_bf16 v[56:59], v[64:67], a[64:67], v[56:59]
    s_waitcnt lgkmcnt(7)
    v_mfma_f32_16x16x32_bf16 v[52:55], v[68:71], a[68:71], v[52:55]
    v_mfma_f32_16x16x32_bf16 v[56:59], v[72:75], a[68:71], v[56:59]
    s_waitcnt lgkmcnt(5)
    v_mfma_f32_16x16x32_bf16 v[52:55], v[76:79], a[72:75], v[52:55]
    v_mfma_f32_16x16x32_bf16 v[56:59], v[80:83], a[72:75], v[56:59]
    s_waitcnt lgkmcnt(3)
    v_mfma_f32_16x16x32_bf16 v[52:55], a[84:87], a[76:79], v[52:55]
    v_mfma_f32_16x16x32_bf16 v[56:59], a[88:91], a[76:79], v[56:59]
    s_waitcnt lgkmcnt(1)
    v_mfma_f32_16x16x32_bf16 v[52:55], a[92:95], a[80:83], v[52:55]
    v_mfma_f32_16x16x32_bf16 v[56:59], a[96:99], a[80:83], v[56:59]
    v_mov_b32 v10, 31
    ds_write_b32 v26, v10 offset:96
    v_lshlrev_b32 v36, 16, v30
    v_and_b32 v37, 0xffff0000, v30
    s_nop 2
    v_add_f32 v36, v36, v52
    v_add_f32 v37, v37, v53
    v_cvt_pk_bf16_f32 v40, v36, v37
    v_lshlrev_b32 v36, 16, v31
    v_and_b32 v37, 0xffff0000, v31
    v_add_f32 v36, v36, v54
    v_add_f32 v37, v37, v55
    v_cvt_pk_bf16_f32 v41, v36, v37
    v_lshlrev_b32 v36, 16, v32
    v_and_b32 v37, 0xffff0000, v32
    v_add_f32 v36, v36, v56
    v_add_f32 v37, v37, v57
    v_cvt_pk_bf16_f32 v42, v36, v37
    v_lshlrev_b32 v36, 16, v33
    v_and_b32 v37, 0xffff0000, v33
    v_add_f32 v36, v36, v58
    v_add_f32 v37, v37, v59
    v_cvt_pk_bf16_f32 v43, v36, v37
    s_add_u32 s38, s84, 8192
    buffer_store_dwordx4 v[40:43], v3, s[24:27], s38 offen sc1
    v_dot2_f32_bf16 v28, v40, v38, v28
    v_dot2_f32_bf16 v28, v41, v38, v28
    v_dot2_f32_bf16 v28, v42, v38, v28
    v_dot2_f32_bf16 v28, v43, v38, v28
    v_dot2_f32_bf16 v29, v40, v40, v29
    v_dot2_f32_bf16 v29, v41, v41, v29
    v_dot2_f32_bf16 v29, v42, v42, v29
    v_dot2_f32_bf16 v29, v43, v43, v29
    ds_read_b128 a[84:87], v3 offset:32768
    ds_read_b128 a[88:91], v3 offset:33792
    ds_read_b128 a[92:95], v3 offset:34816
    ds_read_b128 a[96:99], v3 offset:35840
    ds_read_b128 a[100:103], v3 offset:36864
    s_waitcnt lgkmcnt(4)
    v_mfma_f32_16x16x32_bf16 v[44:47], a[84:87], a[4:7], 0
    ds_read_b128 a[104:107], v3 offset:37888
    s_waitcnt lgkmcnt(4)
    v_mfma_f32_16x16x32_bf16 v[44:47], a[88:91], a[8:11], v[44:47]
    ds_read_b128 a[84:87], v3 offset:38912
    s_waitcnt lgkmcnt(4)
    v_mfma_f32_16x16x32_bf16 v[44:47], a[92:95], a[12:15], v[44:47]
    ds_read_b128 a[88:91], v3 offset:39936
    s_waitcnt lgkmcnt(4)
    v_mfma_f32_16x16x32_bf16 v[44:47], a[96:99], a[16:19], v[44:47]
    ds_read_b128 a[92:95], v18 offset:61440
    s_waitcnt vmcnt(1)
    s_cmp_eq_u32 s49, 0
    s_cbranch_scc1 L_sl_78
    s_lshl_b32 s45, s36, 5
    s_add_u32 s45, s45, s56
    s_add_u32 s45, s45, 98304
    s_mov_b64 exec, 1
    buffer_store_dwordx2 v[16:17], v11, s[24:27], s45 offen
    s_mov_b64 exec, -1
    s_branch L_dn_79
L_sl_78:
    s_lshl_b32 s45, s36, 5
    s_add_u32 s45, s45, s56
    s_add_u32 s45, s45, 98304
    s_mov_b64 exec, 1
    buffer_store_dwordx2 v[16:17], v11, s[24:27], s45 offen sc1
    s_mov_b64 exec, -1
L_dn_79:
    s_waitcnt lgkmcnt(4)
    v_mfma_f32_16x16x32_bf16 v[44:47], a[100:103], a[20:23], v[44:47]
    ds_read_b128 a[96:99], v18 offset:62464
    v_mov_b32 v10, 32
    ds_write_b32 v26, v10 offset:96
    s_waitcnt lgkmcnt(5)
    v_mfma_f32_16x16x32_bf16 v[44:47], a[104:107], a[24:27], v[44:47]
    ds_read_b128 a[100:103], v18 offset:63488
    s_waitcnt lgkmcnt(5)
    v_mfma_f32_16x16x32_bf16 v[44:47], a[84:87], a[28:31], v[44:47]
    ds_read_b128 a[104:107], v18 offset:64512
    s_waitcnt lgkmcnt(5)
    v_mfma_f32_16x16x32_bf16 v[44:47], a[88:91], a[32:35], v[44:47]
    ds_read_b128 a[84:87], v19
    s_waitcnt lgkmcnt(5)
    v_mfma_f32_16x16x32_bf16 v[44:47], a[92:95], a[36:39], v[44:47]
    ds_read_b128 a[88:91], v19 offset:1024
    s_waitcnt lgkmcnt(5)
    v_mfma_f32_16x16x32_bf16 v[44:47], a[96:99], a[40:43], v[44:47]
    ds_read_b128 a[92:95], v19 offset:2048
    v_mov_b32 v10, 33
    ds_write_b32 v26, v10 offset:96
    s_waitcnt lgkmcnt(5)
    v_mfma_f32_16x16x32_bf16 v[44:47], a[100:103], a[44:47], v[44:47]
    ds_read_b128 a[96:99], v19 offset:3072
    s_waitcnt lgkmcnt(5)
    v_mfma_f32_16x16x32_bf16 v[44:47], a[104:107], a[48:51], v[44:47]
    ds_read_b128 a[100:103], v19 offset:4096
    s_waitcnt lgkmcnt(5)
    v_mfma_f32_16x16x32_bf16 v[44:47], a[84:87], a[52:55], v[44:47]
    ds_read_b128 a[104:107], v19 offset:5120
    s_waitcnt lgkmcnt(5)
    v_mfma_f32_16x16x32_bf16 v[44:47], a[88:91], a[56:59], v[44:47]
    ds_read_b128 a[84:87], v19 offset:6144
    s_waitcnt lgkmcnt(5)
    v_mfma_f32_16x16x32_bf16 v[44:47], a[92:95], a[60:63], v[44:47]
    ds_read_b128 a[88:91], v19 offset:7168
    v_mov_b32 v10, 34
    ds_write_b32 v26, v10 offset:96
    s_waitcnt lgkmcnt(5)
    v_mfma_f32_16x16x32_bf16 v[44:47], a[96:99], a[64:67], v[44:47]
    s_waitcnt lgkmcnt(4)
    v_mfma_f32_16x16x32_bf16 v[44:47], a[100:103], a[68:71], v[44:47]
    s_waitcnt lgkmcnt(3)
    v_mfma_f32_16x16x32_bf16 v[44:47], a[104:107], a[72:75], v[44:47]
    s_waitcnt lgkmcnt(2)
    v_mfma_f32_16x16x32_bf16 v[44:47], a[84:87], a[76:79], v[44:47]
    s_waitcnt vmcnt(1)
    s_cmp_eq_u32 s49, 0
    s_cbranch_scc1 L_sl_80
    s_lshl_b32 s45, s36, 5
    s_add_u32 s45, s45, s56
    s_add_u32 s45, s45, 98304
    s_mov_b64 exec, 1
    buffer_store_dwordx2 v[16:17], v11, s[24:27], s45 offen offset:8
    s_mov_b64 exec, -1
    s_branch L_dn_81
L_sl_80:
    s_lshl_b32 s45, s36, 5
    s_add_u32 s45, s45, s56
    s_add_u32 s45, s45, 98304
    s_mov_b64 exec, 1
    buffer_store_dwordx2 v[16:17], v11, s[24:27], s45 offen offset:8 sc1
    s_mov_b64 exec, -1
L_dn_81:
    s_waitcnt lgkmcnt(1)
    v_mfma_f32_16x16x32_bf16 v[44:47], a[88:91], a[80:83], v[44:47]
    v_mov_b32 v10, 36
    ds_write_b32 v26, v10 offset:96
    v_lshlrev_b32 v36, 16, v34
    v_and_b32 v37, 0xffff0000, v34
    s_nop 3
    v_add_f32 v36, v36, v44
    v_add_f32 v37, v37, v45
    v_cvt_pk_bf16_f32 v40, v36, v37
    v_lshlrev_b32 v36, 16, v35
    v_and_b32 v37, 0xffff0000, v35
    v_add_f32 v36, v36, v46
    v_add_f32 v37, v37, v47
    v_cvt_pk_bf16_f32 v41, v36, v37
    buffer_store_dwordx2 v[40:41], v5, s[24:27], s85 offen sc1
    v_dot2_f32_bf16 v28, v40, v38, v28
    v_dot2_f32_bf16 v28, v41, v38, v28
    v_dot2_f32_bf16 v29, v40, v40, v29
    v_dot2_f32_bf16 v29, v41, v41, v29
    s_nop 2
    v_permlane16_swap_b32 v28, v29
    v_add_f32 v28, v28, v29
    v_mov_b32 v29, v28
    s_nop 1
    v_permlane32_swap_b32 v28, v29
    v_add_f32 v28, v28, v29
    s_mov_b32 exec_lo, 0xffffffff
    s_mov_b32 exec_hi, 0x0
    buffer_store_dword v28, v4, s[24:27], s86 offen sc1
    s_mov_b64 exec, -1
    s_lshr_b32 s38, s36, 1
    s_lshl_b32 s38, s38, 10
    s_and_b32 s39, s36, 1
    s_lshl_b32 s39, s39, 6
    s_add_u32 s38, s38, s39
    s_lshl_b32 s39, s59, 10
    s_lshl_b32 s40, s36, 5
    s_add_u32 s39, s39, s40
    v_and_b32 v8, 8, v2
    v_lshlrev_b32 v8, 2, v8
    v_add_u32 v8, s38, v8
    v_mov_b32 v9, s39
    v_cmp_gt_u32 vcc, 16, v2
    s_nop 1
    v_cndmask_b32 v8, v9, v8, vcc
    v_and_b32 v9, 7, v2
    v_lshl_add_u32 v8, v9, 7, v8
    s_lshl_b32 s38, s34, 11
    v_add_u32 v24, s38, v8
    v_lshlrev_b32 v36, 8, v6
    v_lshl_add_u32 v36, v7, 2, v36
    s_mul_i32 s77, s57, 1024
    s_add_u32 s77, s77, 458752
    s_mul_i32 s78, s60, 1024
    s_add_u32 s78, s78, 458752
    s_mul_i32 s71, s57, 20480
    s_add_u32 s71, s71, 9043968
    v_add_u32 v2, 20480, v3
    v_add_u32 v4, 20480, v5
    s_mov_b64 exec, 0xffff
    s_mov_b32 s48, 200000
    s_mov_b32 s45, 163840
L_pt_82:
    buffer_load_dwordx2 v[14:15], v24, s[24:27], s45 offen sc1
    s_waitcnt vmcnt(0)
L_pc_84:
    v_cmp_ne_u64_e64 vcc, s[32:33], v[14:15]
    s_cbranch_vccz L_pn_83
    s_mov_b64 exec, vcc
    s_sub_u32 s48, s48, 1
    s_cmp_lg_u32 s48, 0
    s_cbranch_scc1 L_pt_82
L_pn_83:
    s_mov_b64 exec, -1
    s_cmp_eq_u32 s49, 0
    s_cbranch_scc1 L_sl_85
    s_lshl_b32 s45, s36, 5
    s_add_u32 s45, s45, s56
    s_add_u32 s45, s45, 98304
    s_mov_b64 exec, 1
    buffer_store_dwordx2 v[16:17], v11, s[24:27], s45 offen offset:16
    s_mov_b64 exec, -1
    s_branch L_dn_86
L_sl_85:
    s_lshl_b32 s45, s36, 5
    s_add_u32 s45, s45, s56
    s_add_u32 s45, s45, 98304
    s_mov_b64 exec, 1
    buffer_store_dwordx2 v[16:17], v11, s[24:27], s45 offen offset:16 sc1
    s_mov_b64 exec, -1
L_dn_86:
    buffer_load_dwordx4 a[0:3], v3, s[24:27], s71 offen sc1
    buffer_load_dwordx4 a[80:83], v2, s[24:27], s71 offen sc1
    buffer_load_dwordx4 a[4:7], v3, s[24:27], s71 offen offset:1024 sc1
    buffer_load_dwordx4 a[84:87], v2, s[24:27], s71 offen offset:1024 sc1
    buffer_load_dwordx4 a[8:11], v3, s[24:27], s71 offen offset:2048 sc1
    buffer_load_dwordx4 a[88:91], v2, s[24:27], s71 offen offset:2048 sc1
    buffer_load_dwordx4 a[12:15], v3, s[24:27], s71 offen offset:3072 sc1
    buffer_load_dwordx4 a[92:95], v2, s[24:27], s71 offen offset:3072 sc1
    ds_read_b128 v[110:113], v19 offset:8192
    ds_read_b128 v[114:117], v19 offset:9216
    ds_read_b128 v[118:121], v19 offset:10240
    ds_read_b128 v[122:125], v19 offset:11264
    s_waitcnt vmcnt(6) lgkmcnt(2)
    s_add_u32 s76, s71, 4096
    buffer_load_dwordx4 a[16:19], v3, s[24:27], s76 offen sc1
    v_mfma_f32_16x16x32_bf16 v[78:81], v[110:113], a[0:3], 0
    v_mfma_f32_16x16x32_bf16 v[94:97], v[110:113], a[80:83], 0
    buffer_load_dwordx4 a[96:99], v2, s[24:27], s76 offen sc1
    ds_read_b128 v[126:129], v19 offset:12288
    v_mfma_f32_16x16x32_bf16 v[82:85], v[114:117], a[0:3], 0
    v_mfma_f32_16x16x32_bf16 v[98:101], v[114:117], a[80:83], 0
    buffer_load_dwordx4 a[20:23], v3, s[24:27], s76 offen offset:1024 sc1
    ds_read_b128 v[130:133], v19 offset:13312
    s_waitcnt lgkmcnt(2)
    v_mfma_f32_16x16x32_bf16 v[86:89], v[118:121], a[0:3], 0
    buffer_load_dwordx4 a[100:103], v2, s[24:27], s76 offen offset:1024 sc1
    v_mfma_f32_16x16x32_bf16 v[102:105], v[118:121], a[80:83], 0
    ds_read_b128 v[134:137], v19 offset:14336
    s_mov_b32 s45, 163840
    s_mov_b64 exec, 0xffff
    buffer_load_dwordx2 v[14:15], v24, s[24:27], s45 offen offset:8 sc1
    s_mov_b64 exec, -1
    v_mfma_f32_16x16x32_bf16 v[90:93], v[122:125], a[0:3], 0
    buffer_load_dwordx4 a[24:27], v3, s[24:27], s76 offen offset:2048 sc1
    v_mfma_f32_16x16x32_bf16 v[106:109], v[122:125], a[80:83], 0
    ds_read_b128 v[138:141], v19 offset:15360
    buffer_load_dwordx4 a[104:107], v2, s[24:27], s76 offen offset:2048 sc1
    s_waitcnt vmcnt(11) lgkmcnt(2)
    v_mfma_f32_16x16x32_bf16 v[78:81], v[126:129], a[4:7], v[78:81]
    v_mfma_f32_16x16x32_bf16 v[94:97], v[126:129], a[84:87], v[94:97]
    buffer_load_dwordx4 a[28:31], v3, s[24:27], s76 offen offset:3072 sc1
    ds_read_b128 v[110:113], v19 offset:16384
    v_mfma_f32_16x16x32_bf16 v[82:85], v[130:133], a[4:7], v[82:85]
    v_mfma_f32_16x16x32_bf16 v[98:101], v[130:133], a[84:87], v[98:101]
    buffer_load_dwordx4 v[20:23], v2, s[24:27], s76 offen offset:3072 sc1
    ds_read_b128 v[114:117], v19 offset:17408
    s_waitcnt lgkmcnt(2)
    v_mfma_f32_16x16x32_bf16 v[86:89], v[134:137], a[4:7], v[86:89]
    v_mfma_f32_16x16x32_bf16 v[102:105], v[134:137], a[84:87], v[102:105]
    ds_read_b128 v[118:121], v19 offset:18432
    v_mfma_f32_16x16x32_bf16 v[90:93], v[138:141], a[4:7], v[90:93]
    v_mfma_f32_16x16x32_bf16 v[106:109], v[138:141], a[84:87], v[106:109]
    ds_read_b128 v[122:125], v19 offset:19456
    s_waitcnt vmcnt(11) lgkmcnt(2)
    v_mfma_f32_16x16x32_bf16 v[78:81], v[110:113], a[8:11], v[78:81]
    v_mfma_f32_16x16x32_bf16 v[94:97], v[110:113], a[88:91], v[94:97]
    ds_read_b128 v[126:129], v3 offset:40960
    v_mfma_f32_16x16x32_bf16 v[82:85], v[114:117], a[8:11], v[82:85]
    v_mfma_f32_16x16x32_bf16 v[98:101], v[114:117], a[88:91], v[98:101]
    ds_read_b128 v[130:133], v3 offset:41984
    s_waitcnt lgkmcnt(2)
    v_mfma_f32_16x16x32_bf16 v[86:89], v[118:121], a[8:11], v[86:89]
    v_mfma_f32_16x16x32_bf16 v[102:105], v[118:121], a[88:91], v[102:105]
    ds_read_b128 v[134:137], v3 offset:43008
    v_mfma_f32_16x16x32_bf16 v[90:93], v[122:125], a[8:11], v[90:93]
    v_mfma_f32_16x16x32_bf16 v[106:109], v[122:125], a[88:91], v[106:109]
    ds_read_b128 v[138:141], v3 offset:44032
    s_waitcnt vmcnt(9) lgkmcnt(2)
    v_mfma_f32_16x16x32_bf16 v[78:81], v[126:129], a[12:15], v[78:81]
    v_mfma_f32_16x16x32_bf16 v[94:97], v[126:129], a[92:95], v[94:97]
    ds_read_b128 v[110:113], v3 offset:45056
    v_mfma_f32_16x16x32_bf16 v[82:85], v[130:133], a[12:15], v[82:85]
    v_mfma_f32_16x16x32_bf16 v[98:101], v[130:133], a[92:95], v[98:101]
    ds_read_b128 v[114:117], v3 offset:46080
    s_waitcnt lgkmcnt(2)
    v_mfma_f32_16x16x32_bf16 v[86:89], v[134:137], a[12:15], v[86:89]
    v_mfma_f32_16x16x32_bf16 v[102:105], v[134:137], a[92:95], v[102:105]
    ds_read_b128 v[118:121], v3 offset:47104
    v_mfma_f32_16x16x32_bf16 v[90:93], v[138:141], a[12:15], v[90:93]
    v_mfma_f32_16x16x32_bf16 v[106:109], v[138:141], a[92:95], v[106:109]
    ds_read_b128 v[122:125], v3 offset:48128
    v_mov_b32 v10, 40
    ds_write_b32 v26, v10 offset:96
    s_waitcnt vmcnt(7) lgkmcnt(3)
    v_mfma_f32_16x16x32_bf16 v[78:81], v[110:113], a[16:19], v[78:81]
    v_mfma_f32_16x16x32_bf16 v[94:97], v[110:113], a[96:99], v[94:97]
    ds_read_b128 v[126:129], v3 offset:49152
    v_mfma_f32_16x16x32_bf16 v[82:85], v[114:117], a[16:19], v[82:85]
    v_mfma_f32_16x16x32_bf16 v[98:101], v[114:117], a[96:99], v[98:101]
    ds_read_b128 v[130:133], v3 offset:50176
    s_waitcnt lgkmcnt(3)
    v_mfma_f32_16x16x32_bf16 v[86:89], v[118:121], a[16:19], v[86:89]
    v_mfma_f32_16x16x32_bf16 v[102:105], v[118:121], a[96:99], v[102:105]
    ds_read_b128 v[134:137], v3 offset:51200
    v_mfma_f32_16x16x32_bf16 v[90:93], v[122:125], a[16:19], v[90:93]
    v_mfma_f32_16x16x32_bf16 v[106:109], v[122:125], a[96:99], v[106:109]
    ds_read_b128 v[138:141], v3 offset:52224
    s_waitcnt vmcnt(5) lgkmcnt(2)
    v_mfma_f32_16x16x32_bf16 v[78:81], v[126:129], a[20:23], v[78:81]
    v_mfma_f32_16x16x32_bf16 v[94:97], v[126:129], a[100:103], v[94:97]
    ds_read_b128 v[110:113], v18 offset:28672
    v_mfma_f32_16x16x32_bf16 v[82:85], v[130:133], a[20:23], v[82:85]
    v_mfma_f32_16x16x32_bf16 v[98:101], v[130:133], a[100:103], v[98:101]
    ds_read_b128 v[114:117], v18 offset:29696
    s_waitcnt lgkmcnt(2)
    v_mfma_f32_16x16x32_bf16 v[86:89], v[134:137], a[20:23], v[86:89]
    v_mfma_f32_16x16x32_bf16 v[102:105], v[134:137], a[100:103], v[102:105]
    ds_read_b128 v[118:121], v18 offset:30720
    v_mfma_f32_16x16x32_bf16 v[90:93], v[138:141], a[20:23], v[90:93]
    v_mfma_f32_16x16x32_bf16 v[106:109], v[138:141], a[100:103], v[106:109]
    ds_read_b128 v[122:125], v18 offset:31744
    s_mov_b64 exec, 0xffff
    s_mov_b32 s48, 200000
    s_mov_b32 s45, 163840
    s_waitcnt vmcnt(4)
    s_branch L_pc_89
L_pt_87:
    buffer_load_dwordx2 v[14:15], v24, s[24:27], s45 offen offset:8 sc1
    s_waitcnt vmcnt(0)
L_pc_89:
    v_cmp_ne_u64_e64 vcc, s[32:33], v[14:15]
    s_cbranch_vccz L_pn_88
    s_mov_b64 exec, vcc
    s_sub_u32 s48, s48, 1
    s_cmp_lg_u32 s48, 0
    s_cbranch_scc1 L_pt_87
L_pn_88:
    s_mov_b64 exec, -1
    s_add_u32 s76, s71, 8192
    buffer_load_dwordx4 a[32:35], v3, s[24:27], s76 offen sc1
    buffer_load_dwordx4 v[28:31], v2, s[24:27], s76 offen sc1
    buffer_load_dwordx4 a[36:39], v3, s[24:27], s76 offen offset:1024 sc1
    buffer_load_dwordx4 v[32:35], v2, s[24:27], s76 offen offset:1024 sc1
    s_waitcnt vmcnt(6) lgkmcnt(2)
    v_mfma_f32_16x16x32_bf16 v[78:81], v[110:113], a[24:27], v[78:81]
    v_mfma_f32_16x16x32_bf16 v[94:97], v[110:113], a[104:107], v[94:97]
    buffer_load_dwordx4 a[40:43], v3, s[24:27], s76 offen offset:2048 sc1
    ds_read_b128 v[126:129], v18 offset:32768
    v_mfma_f32_16x16x32_bf16 v[82:85], v[114:117], a[24:27], v[82:85]
    v_mfma_f32_16x16x32_bf16 v[98:101], v[114:117], a[104:107], v[98:101]
    buffer_load_dwordx4 v[38:41], v2, s[24:27], s76 offen offset:2048 sc1
    ds_read_b128 v[130:133], v18 offset:33792
    s_waitcnt lgkmcnt(2)
    v_mfma_f32_16x16x32_bf16 v[86:89], v[118:121], a[24:27], v[86:89]
    buffer_load_dwordx4 a[44:47], v3, s[24:27], s76 offen offset:3072 sc1
    v_mfma_f32_16x16x32_bf16 v[102:105], v[118:121], a[104:107], v[102:105]
    ds_read_b128 v[134:137], v18 offset:34816
    buffer_load_dwordx4 v[42:45], v2, s[24:27], s76 offen offset:3072 sc1
    v_mfma_f32_16x16x32_bf16 v[90:93], v[122:125], a[24:27], v[90:93]
    v_mfma_f32_16x16x32_bf16 v[106:109], v[122:125], a[104:107], v[106:109]
    s_add_u32 s76, s71, 12288
    buffer_load_dwordx4 a[48:51], v3, s[24:27], s76 offen sc1
    ds_read_b128 v[138:141], v18 offset:35840
    s_waitcnt vmcnt(9) lgkmcnt(2)
    v_mfma_f32_16x16x32_bf16 v[78:81], v[126:129], a[28:31], v[78:81]
    buffer_load_dwordx4 v[46:49], v2, s[24:27], s76 offen sc1
    v_mfma_f32_16x16x32_bf16 v[94:97], v[126:129], v[20:23], v[94:97]
    ds_read_b128 v[110:113], v18 offset:36864
    buffer_load_dwordx4 a[52:55], v3, s[24:27], s76 offen offset:1024 sc1
    v_mfma_f32_16x16x32_bf16 v[82:85], v[130:133], a[28:31], v[82:85]
    v_mfma_f32_16x16x32_bf16 v[98:101], v[130:133], v[20:23], v[98:101]
    buffer_load_dwordx4 v[50:53], v2, s[24:27], s76 offen offset:1024 sc1
    ds_read_b128 v[114:117], v18 offset:37888
    s_waitcnt lgkmcnt(2)
    v_mfma_f32_16x16x32_bf16 v[86:89], v[134:137], a[28:31], v[86:89]
    s_mov_b32 s45, 163840
    s_mov_b64 exec, 0xffffff
    buffer_load_dwordx2 v[14:15], v24, s[24:27], s45 offen offset:16 sc1
    s_mov_b64 exec, -1
    v_mfma_f32_16x16x32_bf16 v[102:105], v[134:137], v[20:23], v[102:105]
    buffer_load_dwordx4 a[56:59], v3, s[24:27], s76 offen offset:2048 sc1
    ds_read_b128 v[118:121], v18 offset:38912
    v_mfma_f32_16x16x32_bf16 v[90:93], v[138:141], a[28:31], v[90:93]
    v_mfma_f32_16x16x32_bf16 v[106:109], v[138:141], v[20:23], v[106:109]
    buffer_load_dwordx4 v[54:57], v2, s[24:27], s76 offen offset:2048 sc1
    ds_read_b128 v[122:125], v18 offset:39936
    v_mov_b32 v10, 44
    ds_write_b32 v26, v10 offset:96
    s_waitcnt vmcnt(13) lgkmcnt(3)
    buffer_load_dwordx4 a[60:63], v3, s[24:27], s76 offen offset:3072 sc1
    v_mfma_f32_16x16x32_bf16 v[78:81], v[110:113], a[32:35], v[78:81]
    v_mfma_f32_16x16x32_bf16 v[94:97], v[110:113], v[28:31], v[94:97]
    buffer_load_dwordx4 v[58:61], v2, s[24:27], s76 offen offset:3072 sc1
    ds_read_b128 v[126:129], v18 offset:45056
    v_mfma_f32_16x16x32_bf16 v[82:85], v[114:117], a[32:35], v[82:85]
    v_mfma_f32_16x16x32_bf16 v[98:101], v[114:117], v[28:31], v[98:101]
    ds_read_b128 v[130:133], v18 offset:46080
    s_waitcnt lgkmcnt(3)
    v_mfma_f32_16x16x32_bf16 v[86:89], v[118:121], a[32:35], v[86:89]
    v_mfma_f32_16x16x32_bf16 v[102:105], v[118:121], v[28:31], v[102:105]
    ds_read_b128 v[134:137], v18 offset:47104
    v_mfma_f32_16x16x32_bf16 v[90:93], v[122:125], a[32:35], v[90:93]
    v_mfma_f32_16x16x32_bf16 v[106:109], v[122:125], v[28:31], v[106:109]
    ds_read_b128 v[138:141], v18 offset:48128
    s_waitcnt vmcnt(13) lgkmcnt(2)
    v_mfma_f32_16x16x32_bf16 v[78:81], v[126:129], a[36:39], v[78:81]
    v_mfma_f32_16x16x32_bf16 v[94:97], v[126:129], v[32:35], v[94:97]
    ds_read_b128 v[110:113], v18 offset:49152
    v_mfma_f32_16x16x32_bf16 v[82:85], v[130:133], a[36:39], v[82:85]
    v_mfma_f32_16x16x32_bf16 v[98:101], v[130:133], v[32:35], v[98:101]
    ds_read_b128 v[114:117], v18 offset:50176
    s_waitcnt lgkmcnt(2)
    v_mfma_f32_16x16x32_bf16 v[86:89], v[134:137], a[36:39], v[86:89]
    v_mfma_f32_16x16x32_bf16 v[102:105], v[134:137], v[32:35], v[102:105]
    ds_read_b128 v[118:121], v18 offset:51200
    v_mfma_f32_16x16x32_bf16 v[90:93], v[138:141], a[36:39], v[90:93]
    v_mfma_f32_16x16x32_bf16 v[106:109], v[138:141], v[32:35], v[106:109]
    ds_read_b128 v[122:125], v18 offset:52224
    s_waitcnt vmcnt(11) lgkmcnt(2)
    v_mfma_f32_16x16x32_bf16 v[78:81], v[110:113], a[40:43], v[78:81]
    v_mfma_f32_16x16x32_bf16 v[94:97], v[110:113], v[38:41], v[94:97]
    ds_read_b32 v12, v27 offset:80
    ds_read_b128 v[126:129], v18 offset:53248
    v_mfma_f32_16x16x32_bf16 v[82:85], v[114:117], a[40:43], v[82:85]
    v_mfma_f32_16x16x32_bf16 v[98:101], v[114:117], v[38:41], v[98:101]
    ds_read_b128 v[130:133], v18 offset:54272
    s_waitcnt lgkmcnt(3)
    v_mfma_f32_16x16x32_bf16 v[86:89], v[118:121], a[40:43], v[86:89]
    v_mfma_f32_16x16x32_bf16 v[102:105], v[118:121], v[38:41], v[102:105]
    ds_read_b128 v[134:137], v18 offset:55296
    v_mfma_f32_16x16x32_bf16 v[90:93], v[122:125], a[40:43], v[90:93]
    v_mfma_f32_16x16x32_bf16 v[106:109], v[122:125], v[38:41], v[106:109]
    s_waitcnt lgkmcnt(3)
    v_cmp_gt_u32 vcc, 25, v12
    ds_read_b128 v[138:141], v18 offset:56320
    s_cbranch_vccnz L_cw_90
L_cn_91:
    s_waitcnt vmcnt(9) lgkmcnt(2)
    v_mfma_f32_16x16x32_bf16 v[78:81], v[126:129], a[44:47], v[78:81]
    v_mfma_f32_16x16x32_bf16 v[94:97], v[126:129], v[42:45], v[94:97]
    ds_read_b128 v[110:113], v19 offset:20480
    v_mfma_f32_16x16x32_bf16 v[82:85], v[130:133], a[44:47], v[82:85]
    v_mfma_f32_16x16x32_bf16 v[98:101], v[130:133], v[42:45], v[98:101]
    ds_read_b128 v[114:117], v19 offset:21504
    s_waitcnt lgkmcnt(2)
    v_mfma_f32_16x16x32_bf16 v[86:89], v[134:137], a[44:47], v[86:89]
    v_mfma_f32_16x16x32_bf16 v[102:105], v[134:137], v[42:45], v[102:105]
    ds_read_b128 v[118:121], v19 offset:22528
    v_mfma_f32_16x16x32_bf16 v[90:93], v[138:141], a[44:47], v[90:93]
    v_mfma_f32_16x16x32_bf16 v[106:109], v[138:141], v[42:45], v[106:109]
    ds_read_b128 v[122:125], v19 offset:23552
    v_mov_b32 v10, 48
    ds_write_b32 v26, v10 offset:96
    s_waitcnt vmcnt(7) lgkmcnt(3)
    v_mfma_f32_16x16x32_bf16 v[78:81], v[110:113], a[48:51], v[78:81]
    v_mfma_f32_16x16x32_bf16 v[94:97], v[110:113], v[46:49], v[94:97]
    ds_read_b128 v[126:129], v19 offset:24576
    v_mfma_f32_16x16x32_bf16 v[82:85], v[114:117], a[48:51], v[82:85]
    v_mfma_f32_16x16x32_bf16 v[98:101], v[114:117], v[46:49], v[98:101]
    ds_read_b128 v[130:133], v19 offset:25600
    s_waitcnt lgkmcnt(3)
    v_mfma_f32_16x16x32_bf16 v[86:89], v[118:121], a[48:51], v[86:89]
    v_mfma_f32_16x16x32_bf16 v[102:105], v[118:121], v[46:49], v[102:105]
    ds_read_b128 v[134:137], v19 offset:26624
    v_mfma_f32_16x16x32_bf16 v[90:93], v[122:125], a[48:51], v[90:93]
    v_mfma_f32_16x16x32_bf16 v[106:109], v[122:125], v[46:49], v[106:109]
    ds_read_b128 v[138:141], v19 offset:27648
    s_waitcnt vmcnt(5) lgkmcnt(2)
    v_mfma_f32_16x16x32_bf16 v[78:81], v[126:129], a[52:55], v[78:81]
    v_mfma_f32_16x16x32_bf16 v[94:97], v[126:129], v[50:53], v[94:97]
    ds_read_b128 v[110:113], v3 offset:53248
    v_mfma_f32_16x16x32_bf16 v[82:85], v[130:133], a[52:55], v[82:85]
    v_mfma_f32_16x16x32_bf16 v[98:101], v[130:133], v[50:53], v[98:101]
    ds_read_b128 v[114:117], v3 offset:54272
    s_waitcnt lgkmcnt(2)
    v_mfma_f32_16x16x32_bf16 v[86:89], v[134:137], a[52:55], v[86:89]
    v_mfma_f32_16x16x32_bf16 v[102:105], v[134:137], v[50:53], v[102:105]
    ds_read_b128 v[118:121], v3 offset:55296
    v_mfma_f32_16x16x32_bf16 v[90:93], v[138:141], a[52:55], v[90:93]
    v_mfma_f32_16x16x32_bf16 v[106:109], v[138:141], v[50:53], v[106:109]
    ds_read_b128 v[122:125], v3 offset:56320
    s_mov_b64 exec, 0xffffff
    s_mov_b32 s48, 200000
    s_mov_b32 s45, 163840
    s_waitcnt vmcnt(4)
    s_branch L_pc_95
L_pt_93:
    buffer_load_dwordx2 v[14:15], v24, s[24:27], s45 offen offset:16 sc1
    s_waitcnt vmcnt(0)
L_pc_95:
    v_cmp_ne_u64_e64 vcc, s[32:33], v[14:15]
    s_cbranch_vccz L_pn_94
    s_mov_b64 exec, vcc
    s_sub_u32 s48, s48, 1
    s_cmp_lg_u32 s48, 0
    s_cbranch_scc1 L_pt_93
L_pn_94:
    s_mov_b64 exec, -1
    s_add_u32 s76, s71, 16384
    buffer_load_dwordx2 a[64:65], v5, s[24:27], s76 offen sc1
    buffer_load_dwordx2 a[66:67], v5, s[24:27], s76 offen offset:512 sc1
    buffer_load_dwordx2 v[62:63], v4, s[24:27], s76 offen sc1
    buffer_load_dwordx2 v[64:65], v4, s[24:27], s76 offen offset:512 sc1
    buffer_load_dwordx2 a[68:69], v5, s[24:27], s76 offen offset:1024 sc1
    buffer_load_dwordx2 a[70:71], v5, s[24:27], s76 offen offset:1536 sc1
    buffer_load_dwordx2 v[66:67], v4, s[24:27], s76 offen offset:1024 sc1
    buffer_load_dwordx2 v[68:69], v4, s[24:27], s76 offen offset:1536 sc1
    s_waitcnt vmcnt(10) lgkmcnt(2)
    v_mfma_f32_16x16x32_bf16 v[78:81], v[110:113], a[56:59], v[78:81]
    buffer_load_dwordx2 a[72:73], v5, s[24:27], s76 offen offset:2048 sc1
    v_mfma_f32_16x16x32_bf16 v[94:97], v[110:113], v[54:57], v[94:97]
    buffer_load_dwordx2 a[74:75], v5, s[24:27], s76 offen offset:2560 sc1
    ds_read_b32 v12, v27 offset:80
    ds_read_b128 v[126:129], v3 offset:57344
    buffer_load_dwordx2 v[70:71], v4, s[24:27], s76 offen offset:2048 sc1
    v_mfma_f32_16x16x32_bf16 v[82:85], v[114:117], a[56:59], v[82:85]
    buffer_load_dwordx2 v[72:73], v4, s[24:27], s76 offen offset:2560 sc1
    v_mfma_f32_16x16x32_bf16 v[98:101], v[114:117], v[54:57], v[98:101]
    buffer_load_dwordx2 a[76:77], v5, s[24:27], s76 offen offset:3072 sc1
    ds_read_b128 v[130:133], v3 offset:58368
    s_waitcnt lgkmcnt(3)
    buffer_load_dwordx2 a[78:79], v5, s[24:27], s76 offen offset:3584 sc1
    v_mfma_f32_16x16x32_bf16 v[86:89], v[118:121], a[56:59], v[86:89]
    buffer_load_dwordx2 v[74:75], v4, s[24:27], s76 offen offset:3072 sc1
    v_mfma_f32_16x16x32_bf16 v[102:105], v[118:121], v[54:57], v[102:105]
    buffer_load_dwordx2 v[76:77], v4, s[24:27], s76 offen offset:3584 sc1
    ds_read_b128 v[134:137], v3 offset:59392
    v_mfma_f32_16x16x32_bf16 v[90:93], v[122:125], a[56:59], v[90:93]
    buffer_load_dword v25, v36, s[24:27], s77 offen sc1
    v_mfma_f32_16x16x32_bf16 v[106:109], v[122:125], v[54:57], v[106:109]
    buffer_load_dword v0, v36, s[24:27], s77 offen offset:128 sc1
    s_waitcnt lgkmcnt(3)
    v_cmp_gt_u32 vcc, 29, v12
    buffer_load_dword v142, v36, s[24:27], s77 offen offset:1024 sc1
    ds_read_b128 v[138:141], v3 offset:60416
    s_cbranch_vccnz L_cw_96
L_cn_97:
    s_waitcnt vmcnt(19) lgkmcnt(2)
    buffer_load_dword v9, v36, s[24:27], s77 offen offset:1152 sc1
    v_mfma_f32_16x16x32_bf16 v[78:81], v[126:129], a[60:63], v[78:81]
    buffer_load_dword v143, v36, s[24:27], s78 offen sc1
    v_mfma_f32_16x16x32_bf16 v[94:97], v[126:129], v[58:61], v[94:97]
    buffer_load_dword v144, v36, s[24:27], s78 offen offset:64 sc1
    ds_read_b128 v[110:113], v3 offset:61440
    v_mfma_f32_16x16x32_bf16 v[82:85], v[130:133], a[60:63], v[82:85]
    buffer_load_dword v145, v36, s[24:27], s78 offen offset:128 sc1
    v_mfma_f32_16x16x32_bf16 v[98:101], v[130:133], v[58:61], v[98:101]
    buffer_load_dword v146, v36, s[24:27], s78 offen offset:192 sc1
    ds_read_b128 v[114:117], v3 offset:62464
    s_waitcnt lgkmcnt(2)
    v_mfma_f32_16x16x32_bf16 v[86:89], v[134:137], a[60:63], v[86:89]
    v_mfma_f32_16x16x32_bf16 v[102:105], v[134:137], v[58:61], v[102:105]
    ds_read_b128 v[118:121], v3 offset:63488
    v_mfma_f32_16x16x32_bf16 v[90:93], v[138:141], a[60:63], v[90:93]
    v_mfma_f32_16x16x32_bf16 v[106:109], v[138:141], v[58:61], v[106:109]
    ds_read_b128 v[122:125], v3 offset:64512
    v_mov_b32 v10, 52
    ds_write_b32 v26, v10 offset:96
    s_waitcnt vmcnt(20) lgkmcnt(3)
    v_mfma_f32_16x16x32_bf16 v[78:81], v[110:113], a[64:67], v[78:81]
    v_mfma_f32_16x16x32_bf16 v[94:97], v[110:113], v[62:65], v[94:97]
    ds_read_b128 v[126:129], v18
    v_mfma_f32_16x16x32_bf16 v[82:85], v[114:117], a[64:67], v[82:85]
    v_mfma_f32_16x16x32_bf16 v[98:101], v[114:117], v[62:65], v[98:101]
    ds_read_b128 v[130:133], v18 offset:1024
    s_waitcnt lgkmcnt(3)
    v_mfma_f32_16x16x32_bf16 v[86:89], v[118:121], a[64:67], v[86:89]
    v_mfma_f32_16x16x32_bf16 v[102:105], v[118:121], v[62:65], v[102:105]
    ds_read_b128 v[134:137], v18 offset:2048
    v_mfma_f32_16x16x32_bf16 v[90:93], v[122:125], a[64:67], v[90:93]
    v_mfma_f32_16x16x32_bf16 v[106:109], v[122:125], v[62:65], v[106:109]
    ds_read_b128 v[138:141], v18 offset:3072
    s_waitcnt vmcnt(16) lgkmcnt(2)
    v_mfma_f32_16x16x32_bf16 v[78:81], v[126:129], a[68:71], v[78:81]
    v_mfma_f32_16x16x32_bf16 v[94:97], v[126:129], v[66:69], v[94:97]
    ds_read_b128 v[110:113], v18 offset:4096
    v_mfma_f32_16x16x32_bf16 v[82:85], v[130:133], a[68:71], v[82:85]
    v_mfma_f32_16x16x32_bf16 v[98:101], v[130:133], v[66:69], v[98:101]
    ds_read_b128 v[114:117], v18 offset:5120
    s_waitcnt lgkmcnt(2)
    v_mfma_f32_16x16x32_bf16 v[86:89], v[134:137], a[68:71], v[86:89]
    v_mfma_f32_16x16x32_bf16 v[102:105], v[134:137], v[66:69], v[102:105]
    ds_read_b128 v[118:121], v18 offset:6144
    v_mfma_f32_16x16x32_bf16 v[90:93], v[138:141], a[68:71], v[90:93]
    v_mfma_f32_16x16x32_bf16 v[106:109], v[138:141], v[66:69], v[106:109]
    ds_read_b128 v[122:125], v18 offset:7168
    s_waitcnt vmcnt(12) lgkmcnt(2)
    v_mfma_f32_16x16x32_bf16 v[78:81], v[110:113], a[72:75], v[78:81]
    v_mfma_f32_16x16x32_bf16 v[94:97], v[110:113], v[70:73], v[94:97]
    ds_read_b128 v[126:129], v18 offset:8192
    v_mfma_f32_16x16x32_bf16 v[82:85], v[114:117], a[72:75], v[82:85]
    v_mfma_f32_16x16x32_bf16 v[98:101], v[114:117], v[70:73], v[98:101]
    ds_read_b128 v[130:133], v18 offset:9216
    s_waitcnt lgkmcnt(2)
    v_mfma_f32_16x16x32_bf16 v[86:89], v[118:121], a[72:75], v[86:89]
    v_mfma_f32_16x16x32_bf16 v[102:105], v[118:121], v[70:73], v[102:105]
    ds_read_b128 v[134:137], v18 offset:10240
    v_mfma_f32_16x16x32_bf16 v[90:93], v[122:125], a[72:75], v[90:93]
    v_mfma_f32_16x16x32_bf16 v[106:109], v[122:125], v[70:73], v[106:109]
    ds_read_b128 v[138:141], v18 offset:11264
    s_waitcnt vmcnt(8) lgkmcnt(2)
    v_mfma_f32_16x16x32_bf16 v[78:81], v[126:129], a[76:79], v[78:81]
    v_mfma_f32_16x16x32_bf16 v[94:97], v[126:129], v[74:77], v[94:97]
    v_mfma_f32_16x16x32_bf16 v[82:85], v[130:133], a[76:79], v[82:85]
    v_mfma_f32_16x16x32_bf16 v[98:101], v[130:133], v[74:77], v[98:101]
    s_waitcnt lgkmcnt(0)
    v_mfma_f32_16x16x32_bf16 v[86:89], v[134:137], a[76:79], v[86:89]
    v_mfma_f32_16x16x32_bf16 v[102:105], v[134:137], v[74:77], v[102:105]
    v_mfma_f32_16x16x32_bf16 v[90:93], v[138:141], a[76:79], v[90:93]
    v_mfma_f32_16x16x32_bf16 v[106:109], v[138:141], v[74:77], v[106:109]
    v_mov_b32 v10, 56
    ds_write_b32 v26, v10 offset:96
    v_lshlrev_b32 v8, 4, v6
    v_add_u32 v8, 160000, v8
    ds_read_b128 v[110:113], v8
    ds_read_b128 v[114:117], v8 offset:64
    ds_read_b128 v[118:121], v8 offset:128
    ds_read_b128 v[122:125], v8 offset:192
    s_waitcnt vmcnt(0)
    v_add_f32 v25, v25, v0
    v_add_f32 v142, v142, v9
    v_add_f32 v143, v143, v145
    v_add_f32 v144, v144, v146
    v_permlane16_swap_b32 v25, v142
    s_nop 0
    v_permlane16_swap_b32 v143, v144
    v_add_f32 v25, v25, v142
    v_add_f32 v143, v143, v144
    s_nop 1
    v_permlane32_swap_b32 v25, v143
    v_add_f32 v25, v25, v143
    v_mul_f32 v25, 0x3acccccd, v25
    v_mov_b32 v143, v25
    s_nop 1
    v_permlane32_swap_b32 v25, v143
    v_mov_b32 v142, v25
    v_mov_b32 v144, v143
    s_nop 0
    v_permlane16_swap_b32 v25, v142
    v_permlane16_swap_b32 v143, v144
    v_mov_b32 v37, v25
    v_mov_b32 v24, v142
    v_fma_f32 v36, -v143, v143, v144
    v_max_f32 v36, 0, v36
    v_add_f32 v36, 0x3727c5ac, v36
    v_rsq_f32 v36, v36
    s_waitcnt lgkmcnt(0)
    v_pk_fma_f32 v[78:79], v[36:37], v[110:111], v[78:79] op_sel:[1,0,0] neg_lo:[1,0,0] neg_hi:[1,0,0]
    v_pk_fma_f32 v[80:81], v[36:37], v[112:113], v[80:81] op_sel:[1,0,0] neg_lo:[1,0,0] neg_hi:[1,0,0]
    v_pk_fma_f32 v[82:83], v[36:37], v[114:115], v[82:83] op_sel:[1,0,0] neg_lo:[1,0,0] neg_hi:[1,0,0]
    v_pk_fma_f32 v[84:85], v[36:37], v[116:117], v[84:85] op_sel:[1,0,0] neg_lo:[1,0,0] neg_hi:[1,0,0]
    v_pk_fma_f32 v[86:87], v[36:37], v[118:119], v[86:87] op_sel:[1,0,0] neg_lo:[1,0,0] neg_hi:[1,0,0]
    v_pk_fma_f32 v[88:89], v[36:37], v[120:121], v[88:89] op_sel:[1,0,0] neg_lo:[1,0,0] neg_hi:[1,0,0]
    v_pk_fma_f32 v[90:91], v[36:37], v[122:123], v[90:91] op_sel:[1,0,0] neg_lo:[1,0,0] neg_hi:[1,0,0]
    v_pk_fma_f32 v[92:93], v[36:37], v[124:125], v[92:93] op_sel:[1,0,0] neg_lo:[1,0,0] neg_hi:[1,0,0]
    v_pk_fma_f32 v[94:95], v[24:25], v[110:111], v[94:95] op_sel_hi:[0,1,1] neg_lo:[1,0,0] neg_hi:[1,0,0]
    v_pk_fma_f32 v[96:97], v[24:25], v[112:113], v[96:97] op_sel_hi:[0,1,1] neg_lo:[1,0,0] neg_hi:[1,0,0]
    v_pk_fma_f32 v[98:99], v[24:25], v[114:115], v[98:99] op_sel_hi:[0,1,1] neg_lo:[1,0,0] neg_hi:[1,0,0]
    v_pk_fma_f32 v[100:101], v[24:25], v[116:117], v[100:101] op_sel_hi:[0,1,1] neg_lo:[1,0,0] neg_hi:[1,0,0]
    v_pk_fma_f32 v[102:103], v[24:25], v[118:119], v[102:103] op_sel_hi:[0,1,1] neg_lo:[1,0,0] neg_hi:[1,0,0]
    v_pk_fma_f32 v[104:105], v[24:25], v[120:121], v[104:105] op_sel_hi:[0,1,1] neg_lo:[1,0,0] neg_hi:[1,0,0]
    v_pk_fma_f32 v[106:107], v[24:25], v[122:123], v[106:107] op_sel_hi:[0,1,1] neg_lo:[1,0,0] neg_hi:[1,0,0]
    v_pk_fma_f32 v[108:109], v[24:25], v[124:125], v[108:109] op_sel_hi:[0,1,1] neg_lo:[1,0,0] neg_hi:[1,0,0]
    v_cvt_pk_bf16_f32 v110, v78, v79
    v_pk_max_i16 v110, v110, 0
    v_cvt_pk_bf16_f32 v111, v80, v81
    v_pk_max_i16 v111, v111, 0
    v_cvt_pk_bf16_f32 v112, v82, v83
    v_pk_max_i16 v112, v112, 0
    v_cvt_pk_bf16_f32 v113, v84, v85
    v_pk_max_i16 v113, v113, 0
    v_cvt_pk_bf16_f32 v114, v86, v87
    v_pk_max_i16 v114, v114, 0
    v_cvt_pk_bf16_f32 v115, v88, v89
    v_pk_max_i16 v115, v115, 0
    v_cvt_pk_bf16_f32 v116, v90, v91
    v_pk_max_i16 v116, v116, 0
    v_cvt_pk_bf16_f32 v117, v92, v93
    v_pk_max_i16 v117, v117, 0
    s_add_u32 s38, s87, 0
    s_add_u32 s39, s38, 16384
    buffer_store_dwordx4 v[110:113], v3, s[24:27], s38 offen sc1
    buffer_store_dwordx4 v[114:117], v3, s[24:27], s39 offen sc1
    v_cvt_pk_bf16_f32 v118, v94, v95
    v_pk_max_i16 v118, v118, 0
    v_cvt_pk_bf16_f32 v119, v96, v97
    v_pk_max_i16 v119, v119, 0
    v_cvt_pk_bf16_f32 v120, v98, v99
    v_pk_max_i16 v120, v120, 0
    v_cvt_pk_bf16_f32 v121, v100, v101
    v_pk_max_i16 v121, v121, 0
    v_cvt_pk_bf16_f32 v122, v102, v103
    v_pk_max_i16 v122, v122, 0
    v_cvt_pk_bf16_f32 v123, v104, v105
    v_pk_max_i16 v123, v123, 0
    v_cvt_pk_bf16_f32 v124, v106, v107
    v_pk_max_i16 v124, v124, 0
    v_cvt_pk_bf16_f32 v125, v108, v109
    v_pk_max_i16 v125, v125, 0
    s_add_u32 s38, s87, 55296
    s_add_u32 s39, s38, 16384
    buffer_store_dwordx4 v[118:121], v3, s[24:27], s38 offen sc1
    buffer_store_dwordx4 v[122:125], v3, s[24:27], s39 offen sc1
    s_nop 1
    s_and_b32 s38, s60, 0xfffffffe
    s_mul_i32 s71, s38, 55296
    s_add_u32 s71, s71, 11665408
    s_and_b32 s38, s36, 1
    s_lshl_b32 s38, s38, 10
    s_add_u32 s76, s71, s38
    v_add_u32 v2, 55296, v3
    v_add_u32 v4, 55296, v5
    s_lshl_b32 s42, s34, 11
    s_lshl_b32 s43, s59, 6
    s_add_u32 s42, s42, s43
    s_lshr_b32 s43, s36, 1
    s_lshl_b32 s43, s43, 5
    s_add_u32 s42, s42, s43
    v_lshl_add_u32 v25, v7, 7, s42
    ds_read_b32 v12, v27 offset:80
    s_waitcnt lgkmcnt(0)
    v_cmp_gt_u32 vcc, 32, v12
    s_cbranch_vccnz L_cw_99
L_cn_100:
    ds_read_b128 v[102:105], v18 offset:12288
    ds_read_b128 v[106:109], v18 offset:13312
    ds_read_b128 v[110:113], v18 offset:14336
    s_waitcnt lgkmcnt(1)
    v_mfma_f32_16x16x32_bf16 v[78:81], v[102:105], a[0:3], 0
    v_mfma_f32_16x16x32_bf16 v[90:93], v[102:105], a[80:83], 0
    ds_read_b128 v[114:117], v18 offset:15360
    v_mfma_f32_16x16x32_bf16 v[82:85], v[106:109], a[0:3], 0
    v_mfma_f32_16x16x32_bf16 v[94:97], v[106:109], a[80:83], 0
    ds_read_b128 v[118:121], v18 offset:16384
    s_waitcnt lgkmcnt(2)
    v_mfma_f32_16x16x32_bf16 v[86:89], v[110:113], a[0:3], 0
    v_mfma_f32_16x16x32_bf16 v[98:101], v[110:113], a[80:83], 0
    ds_read_b128 v[122:125], v18 offset:17408
    s_waitcnt lgkmcnt(1)
    v_mfma_f32_16x16x32_bf16 v[78:81], v[114:117], a[4:7], v[78:81]
    v_mfma_f32_16x16x32_bf16 v[90:93], v[114:117], a[84:87], v[90:93]
    ds_read_b128 v[102:105], v18 offset:18432
    v_mfma_f32_16x16x32_bf16 v[82:85], v[118:121], a[4:7], v[82:85]
    v_mfma_f32_16x16x32_bf16 v[94:97], v[118:121], a[84:87], v[94:97]
    ds_read_b128 v[106:109], v18 offset:19456
    s_waitcnt lgkmcnt(2)
    v_mfma_f32_16x16x32_bf16 v[86:89], v[122:125], a[4:7], v[86:89]
    v_mfma_f32_16x16x32_bf16 v[98:101], v[122:125], a[84:87], v[98:101]
    ds_read_b128 v[110:113], v18 offset:20480
    s_waitcnt lgkmcnt(1)
    v_mfma_f32_16x16x32_bf16 v[78:81], v[102:105], a[8:11], v[78:81]
    v_mfma_f32_16x16x32_bf16 v[90:93], v[102:105], a[88:91], v[90:93]
    ds_read_b32 v12, v27 offset:80
    ds_read_b128 v[114:117], v18 offset:21504
    v_mfma_f32_16x16x32_bf16 v[82:85], v[106:109], a[8:11], v[82:85]
    v_mfma_f32_16x16x32_bf16 v[94:97], v[106:109], a[88:91], v[94:97]
    ds_read_b128 v[118:121], v18 offset:22528
    s_waitcnt lgkmcnt(3)
    v_mfma_f32_16x16x32_bf16 v[86:89], v[110:113], a[8:11], v[86:89]
    v_mfma_f32_16x16x32_bf16 v[98:101], v[110:113], a[88:91], v[98:101]
    s_waitcnt lgkmcnt(2)
    v_cmp_gt_u32 vcc, 35, v12
    ds_read_b128 v[122:125], v18 offset:23552
    s_cbranch_vccnz L_cw_102
L_cn_103:
    s_waitcnt lgkmcnt(1)
    v_mfma_f32_16x16x32_bf16 v[78:81], v[114:117], a[12:15], v[78:81]
    v_mfma_f32_16x16x32_bf16 v[90:93], v[114:117], a[92:95], v[90:93]
    ds_read_b128 v[102:105], v18 offset:24576
    v_mfma_f32_16x16x32_bf16 v[82:85], v[118:121], a[12:15], v[82:85]
    v_mfma_f32_16x16x32_bf16 v[94:97], v[118:121], a[92:95], v[94:97]
    ds_read_b128 v[106:109], v18 offset:25600
    s_waitcnt lgkmcnt(2)
    v_mfma_f32_16x16x32_bf16 v[86:89], v[122:125], a[12:15], v[86:89]
    v_mfma_f32_16x16x32_bf16 v[98:101], v[122:125], a[92:95], v[98:101]
    ds_read_b128 v[110:113], v18 offset:26624
    v_mov_b32 v10, 59
    ds_write_b32 v26, v10 offset:96
    s_waitcnt lgkmcnt(2)
    v_mfma_f32_16x16x32_bf16 v[78:81], v[102:105], a[16:19], v[78:81]
    v_mfma_f32_16x16x32_bf16 v[90:93], v[102:105], a[96:99], v[90:93]
    ds_read_b128 v[114:117], v18 offset:27648
    v_mfma_f32_16x16x32_bf16 v[82:85], v[106:109], a[16:19], v[82:85]
    v_mfma_f32_16x16x32_bf16 v[94:97], v[106:109], a[96:99], v[94:97]
    ds_read_b128 v[118:121], v18 offset:40960
    s_waitcnt lgkmcnt(3)
    v_mfma_f32_16x16x32_bf16 v[86:89], v[110:113], a[16:19], v[86:89]
    v_mfma_f32_16x16x32_bf16 v[98:101], v[110:113], a[96:99], v[98:101]
    ds_read_b128 v[122:125], v18 offset:41984
    s_waitcnt lgkmcnt(1)
    v_mfma_f32_16x16x32_bf16 v[78:81], v[114:117], a[20:23], v[78:81]
    v_mfma_f32_16x16x32_bf16 v[90:93], v[114:117], a[100:103], v[90:93]
    ds_read_b128 v[102:105], v18 offset:43008
    v_mfma_f32_16x16x32_bf16 v[82:85], v[118:121], a[20:23], v[82:85]
    v_mfma_f32_16x16x32_bf16 v[94:97], v[118:121], a[100:103], v[94:97]
    ds_read_b128 v[106:109], v18 offset:44032
    s_waitcnt lgkmcnt(2)
    v_mfma_f32_16x16x32_bf16 v[86:89], v[122:125], a[20:23], v[86:89]
    v_mfma_f32_16x16x32_bf16 v[98:101], v[122:125], a[100:103], v[98:101]
    ds_read_b128 v[110:113], v18 offset:57344
    s_waitcnt lgkmcnt(1)
    v_mfma_f32_16x16x32_bf16 v[78:81], v[102:105], a[24:27], v[78:81]
    v_mfma_f32_16x16x32_bf16 v[90:93], v[102:105], a[104:107], v[90:93]
    ds_read_b32 v12, v27 offset:80
    ds_read_b128 v[114:117], v18 offset:58368
    v_mfma_f32_16x16x32_bf16 v[82:85], v[106:109], a[24:27], v[82:85]
    v_mfma_f32_16x16x32_bf16 v[94:97], v[106:109], a[104:107], v[94:97]
    ds_read_b128 v[118:121], v18 offset:59392
    s_waitcnt lgkmcnt(3)
    v_mfma_f32_16x16x32_bf16 v[86:89], v[110:113], a[24:27], v[86:89]
    v_mfma_f32_16x16x32_bf16 v[98:101], v[110:113], a[104:107], v[98:101]
    ds_read_b128 v[122:125], v18 offset:60416
    s_waitcnt vmcnt(0)
    s_cmp_eq_u32 s49, 0
    s_cbranch_scc1 L_sl_105
    s_lshl_b32 s45, s36, 5
    s_add_u32 s45, s45, s56
    s_add_u32 s45, s45, 131072
    s_mov_b64 exec, 1
    buffer_store_dwordx2 v[16:17], v11, s[24:27], s45 offen
    s_mov_b64 exec, -1
    s_branch L_dn_106
L_sl_105:
    s_lshl_b32 s45, s36, 5
    s_add_u32 s45, s45, s56
    s_add_u32 s45, s45, 131072
    s_mov_b64 exec, 1
    buffer_store_dwordx2 v[16:17], v11, s[24:27], s45 offen sc1
    s_mov_b64 exec, -1
L_dn_106:
    ds_read_b32 v12, v27 offset:80
    s_waitcnt lgkmcnt(0)
    v_cmp_gt_u32 vcc, 38, v12
    s_cbranch_vccnz L_cw_107
L_cn_108:
    v_mfma_f32_16x16x32_bf16 v[78:81], v[114:117], a[28:31], v[78:81]
    v_mfma_f32_16x16x32_bf16 v[90:93], v[114:117], v[20:23], v[90:93]
    ds_read_b128 v[102:105], v3
    v_mfma_f32_16x16x32_bf16 v[82:85], v[118:121], a[28:31], v[82:85]
    v_mfma_f32_16x16x32_bf16 v[94:97], v[118:121], v[20:23], v[94:97]
    ds_read_b128 v[106:109], v3 offset:1024
    v_mfma_f32_16x16x32_bf16 v[86:89], v[122:125], a[28:31], v[86:89]
    v_mfma_f32_16x16x32_bf16 v[98:101], v[122:125], v[20:23], v[98:101]
    ds_read_b128 v[110:113], v3 offset:2048
    v_mov_b32 v10, 62
    ds_write_b32 v26, v10 offset:96
    s_waitcnt lgkmcnt(2)
    v_mfma_f32_16x16x32_bf16 v[78:81], v[102:105], a[32:35], v[78:81]
    v_mfma_f32_16x16x32_bf16 v[90:93], v[102:105], v[28:31], v[90:93]
    ds_read_b128 v[114:117], v3 offset:3072
    v_mfma_f32_16x16x32_bf16 v[82:85], v[106:109], a[32:35], v[82:85]
    v_mfma_f32_16x16x32_bf16 v[94:97], v[106:109], v[28:31], v[94:97]
    ds_read_b128 v[118:121], v3 offset:4096
    s_waitcnt lgkmcnt(3)
    v_mfma_f32_16x16x32_bf16 v[86:89], v[110:113], a[32:35], v[86:89]
    v_mfma_f32_16x16x32_bf16 v[98:101], v[110:113], v[28:31], v[98:101]
    ds_read_b128 v[122:125], v3 offset:5120
    s_waitcnt lgkmcnt(1)
    v_mfma_f32_16x16x32_bf16 v[78:81], v[114:117], a[36:39], v[78:81]
    v_mfma_f32_16x16x32_bf16 v[90:93], v[114:117], v[32:35], v[90:93]
    ds_read_b128 v[102:105], v3 offset:6144
    v_mfma_f32_16x16x32_bf16 v[82:85], v[118:121], a[36:39], v[82:85]
    v_mfma_f32_16x16x32_bf16 v[94:97], v[118:121], v[32:35], v[94:97]
    ds_read_b128 v[106:109], v3 offset:7168
    s_waitcnt lgkmcnt(2)
    v_mfma_f32_16x16x32_bf16 v[86:89], v[122:125], a[36:39], v[86:89]
    v_mfma_f32_16x16x32_bf16 v[98:101], v[122:125], v[32:35], v[98:101]
    ds_read_b128 v[110:113], v3 offset:8192
    s_waitcnt lgkmcnt(1)
    v_mfma_f32_16x16x32_bf16 v[78:81], v[102:105], a[40:43], v[78:81]
    v_mfma_f32_16x16x32_bf16 v[90:93], v[102:105], v[38:41], v[90:93]
    ds_read_b32 v12, v27 offset:80
    ds_read_b128 v[114:117], v3 offset:9216
    v_mfma_f32_16x16x32_bf16 v[82:85], v[106:109], a[40:43], v[82:85]
    v_mfma_f32_16x16x32_bf16 v[94:97], v[106:109], v[38:41], v[94:97]
    ds_read_b128 v[118:121], v3 offset:10240
    s_waitcnt lgkmcnt(3)
    v_mfma_f32_16x16x32_bf16 v[86:89], v[110:113], a[40:43], v[86:89]
    v_mfma_f32_16x16x32_bf16 v[98:101], v[110:113], v[38:41], v[98:101]
    s_waitcnt lgkmcnt(2)
    v_cmp_gt_u32 vcc, 41, v12
    ds_read_b128 v[122:125], v3 offset:11264
    s_cbranch_vccnz L_cw_110
L_cn_111:
    s_waitcnt lgkmcnt(1)
    v_mfma_f32_16x16x32_bf16 v[78:81], v[114:117], a[44:47], v[78:81]
    v_mfma_f32_16x16x32_bf16 v[90:93], v[114:117], v[42:45], v[90:93]
    ds_read_b128 v[102:105], v3 offset:12288
    v_mfma_f32_16x16x32_bf16 v[82:85], v[118:121], a[44:47], v[82:85]
    v_mfma_f32_16x16x32_bf16 v[94:97], v[118:121], v[42:45], v[94:97]
    ds_read_b128 v[106:109], v3 offset:13312
    s_waitcnt lgkmcnt(2)
    v_mfma_f32_16x16x32_bf16 v[86:89], v[122:125], a[44:47], v[86:89]
    v_mfma_f32_16x16x32_bf16 v[98:101], v[122:125], v[42:45], v[98:101]
    ds_read_b128 v[110:113], v3 offset:14336
    v_mov_b32 v10, 65
    ds_write_b32 v26, v10 offset:96
    s_waitcnt lgkmcnt(2)
    v_mfma_f32_16x16x32_bf16 v[78:81], v[102:105], a[48:51], v[78:81]
    v_mfma_f32_16x16x32_bf16 v[90:93], v[102:105], v[46:49], v[90:93]
    ds_read_b128 v[114:117], v3 offset:15360
    v_mfma_f32_16x16x32_bf16 v[82:85], v[106:109], a[48:51], v[82:85]
    v_mfma_f32_16x16x32_bf16 v[94:97], v[106:109], v[46:49], v[94:97]
    ds_read_b128 v[118:121], v3 offset:16384
    s_waitcnt lgkmcnt(3)
    v_mfma_f32_16x16x32_bf16 v[86:89], v[110:113], a[48:51], v[86:89]
    v_mfma_f32_16x16x32_bf16 v[98:101], v[110:113], v[46:49], v[98:101]
    ds_read_b128 v[122:125], v3 offset:17408
    s_waitcnt lgkmcnt(1)
    v_mfma_f32_16x16x32_bf16 v[78:81], v[114:117], a[52:55], v[78:81]
    v_mfma_f32_16x16x32_bf16 v[90:93], v[114:117], v[50:53], v[90:93]
    ds_read_b128 v[102:105], v3 offset:18432
    v_mfma_f32_16x16x32_bf16 v[82:85], v[118:121], a[52:55], v[82:85]
    v_mfma_f32_16x16x32_bf16 v[94:97], v[118:121], v[50:53], v[94:97]
    ds_read_b128 v[106:109], v3 offset:19456
    s_waitcnt lgkmcnt(2)
    v_mfma_f32_16x16x32_bf16 v[86:89], v[122:125], a[52:55], v[86:89]
    v_mfma_f32_16x16x32_bf16 v[98:101], v[122:125], v[50:53], v[98:101]
    ds_read_b128 v[110:113], v3 offset:20480
    s_waitcnt lgkmcnt(1)
    s_mov_b32 s45, 196608
    s_mov_b64 exec, 0xffff
    buffer_load_dwordx2 v[14:15], v25, s[24:27], s45 offen sc1
    s_mov_b64 exec, -1
    v_mfma_f32_16x16x32_bf16 v[78:81], v[102:105], a[56:59], v[78:81]
    v_mfma_f32_16x16x32_bf16 v[90:93], v[102:105], v[54:57], v[90:93]
    ds_read_b32 v12, v27 offset:80
    ds_read_b128 v[114:117], v3 offset:21504
    v_mfma_f32_16x16x32_bf16 v[82:85], v[106:109], a[56:59], v[82:85]
    v_mfma_f32_16x16x32_bf16 v[94:97], v[106:109], v[54:57], v[94:97]
    ds_read_b128 v[118:121], v3 offset:22528
    s_waitcnt lgkmcnt(3)
    v_mfma_f32_16x16x32_bf16 v[86:89], v[110:113], a[56:59], v[86:89]
    v_mfma_f32_16x16x32_bf16 v[98:101], v[110:113], v[54:57], v[98:101]
    s_waitcnt lgkmcnt(2)
    v_cmp_gt_u32 vcc, 44, v12
    ds_read_b128 v[122:125], v3 offset:23552
    s_cbranch_vccnz L_cw_113
L_cn_114:
    s_waitcnt lgkmcnt(1)
    v_mfma_f32_16x16x32_bf16 v[78:81], v[114:117], a[60:63], v[78:81]
    v_mfma_f32_16x16x32_bf16 v[90:93], v[114:117], v[58:61], v[90:93]
    ds_read_b128 v[102:105], v3 offset:24576
    v_mfma_f32_16x16x32_bf16 v[82:85], v[118:121], a[60:63], v[82:85]
    v_mfma_f32_16x16x32_bf16 v[94:97], v[118:121], v[58:61], v[94:97]
    ds_read_b128 v[106:109], v3 offset:25600
    s_waitcnt lgkmcnt(2)
    v_mfma_f32_16x16x32_bf16 v[86:89], v[122:125], a[60:63], v[86:89]
    v_mfma_f32_16x16x32_bf16 v[98:101], v[122:125], v[58:61], v[98:101]
    ds_read_b128 v[110:113], v3 offset:26624
    v_mov_b32 v10, 68
    ds_write_b32 v26, v10 offset:96
    s_waitcnt lgkmcnt(2)
    s_mov_b64 exec, 0xffff
    s_mov_b32 s48, 200000
    s_mov_b32 s45, 196608
    s_waitcnt vmcnt(0)
    s_branch L_pc_118
L_pt_116:
    buffer_load_dwordx2 v[14:15], v25, s[24:27], s45 offen sc1
    s_waitcnt vmcnt(0)
L_pc_118:
    v_cmp_ne_u64_e64 vcc, s[32:33], v[14:15]
    s_cbranch_vccz L_pn_117
    s_mov_b64 exec, vcc
    s_sub_u32 s48, s48, 1
    s_cmp_lg_u32 s48, 0
    s_cbranch_scc1 L_pt_116
L_pn_117:
    s_mov_b64 exec, -1
    v_mfma_f32_16x16x32_bf16 v[78:81], v[102:105], a[64:67], v[78:81]
    buffer_load_dwordx4 a[0:3], v3, s[24:27], s76 offen sc1
    v_mfma_f32_16x16x32_bf16 v[90:93], v[102:105], v[62:65], v[90:93]
    ds_read_b128 v[114:117], v3 offset:27648
    v_mfma_f32_16x16x32_bf16 v[82:85], v[106:109], a[64:67], v[82:85]
    v_mfma_f32_16x16x32_bf16 v[94:97], v[106:109], v[62:65], v[94:97]
    ds_read_b128 v[118:121], v3 offset:28672
    s_waitcnt lgkmcnt(3)
    v_mfma_f32_16x16x32_bf16 v[86:89], v[110:113], a[64:67], v[86:89]
    v_mfma_f32_16x16x32_bf16 v[98:101], v[110:113], v[62:65], v[98:101]
    buffer_load_dwordx4 a[80:83], v2, s[24:27], s76 offen sc1
    ds_read_b128 v[122:125], v3 offset:29696
    s_waitcnt lgkmcnt(1)
    v_mfma_f32_16x16x32_bf16 v[78:81], v[114:117], a[68:71], v[78:81]
    v_mfma_f32_16x16x32_bf16 v[90:93], v[114:117], v[66:69], v[90:93]
    ds_read_b128 v[102:105], v3 offset:30720
    v_mfma_f32_16x16x32_bf16 v[82:85], v[118:121], a[68:71], v[82:85]
    v_mfma_f32_16x16x32_bf16 v[94:97], v[118:121], v[66:69], v[94:97]
    buffer_load_dwordx4 a[4:7], v3, s[24:27], s76 offen offset:2048 sc1
    ds_read_b128 v[106:109], v3 offset:31744
    s_waitcnt lgkmcnt(2)
    v_mfma_f32_16x16x32_bf16 v[86:89], v[122:125], a[68:71], v[86:89]
    v_mfma_f32_16x16x32_bf16 v[98:101], v[122:125], v[66:69], v[98:101]
    ds_read_b128 v[110:113], v3 offset:32768
    s_waitcnt lgkmcnt(1)
    v_mfma_f32_16x16x32_bf16 v[78:81], v[102:105], a[72:75], v[78:81]
    v_mfma_f32_16x16x32_bf16 v[90:93], v[102:105], v[70:73], v[90:93]
    buffer_load_dwordx4 a[84:87], v2, s[24:27], s76 offen offset:2048 sc1
    ds_read_b128 v[114:117], v3 offset:33792
    v_mfma_f32_16x16x32_bf16 v[82:85], v[106:109], a[72:75], v[82:85]
    v_mfma_f32_16x16x32_bf16 v[94:97], v[106:109], v[70:73], v[94:97]
    ds_read_b128 v[118:121], v3 offset:34816
    s_waitcnt lgkmcnt(2)
    v_mfma_f32_16x16x32_bf16 v[86:89], v[110:113], a[72:75], v[86:89]
    v_mfma_f32_16x16x32_bf16 v[98:101], v[110:113], v[70:73], v[98:101]
    ds_read_b128 v[122:125], v3 offset:35840
    s_addk_i32 s76, 4096
    buffer_load_dwordx4 a[8:11], v3, s[24:27], s76 offen sc1
    s_waitcnt lgkmcnt(1)
    v_mfma_f32_16x16x32_bf16 v[78:81], v[114:117], a[76:79], v[78:81]
    v_mfma_f32_16x16x32_bf16 v[90:93], v[114:117], v[74:77], v[90:93]
    v_mfma_f32_16x16x32_bf16 v[82:85], v[118:121], a[76:79], v[82:85]
    v_mfma_f32_16x16x32_bf16 v[94:97], v[118:121], v[74:77], v[94:97]
    s_waitcnt lgkmcnt(0)
    buffer_load_dwordx4 a[88:91], v2, s[24:27], s76 offen sc1
    v_mfma_f32_16x16x32_bf16 v[86:89], v[122:125], a[76:79], v[86:89]
    v_mfma_f32_16x16x32_bf16 v[98:101], v[122:125], v[74:77], v[98:101]
    v_mov_b32 v10, 71
    ds_write_b32 v26, v10 offset:96
    buffer_load_dwordx4 a[12:15], v3, s[24:27], s76 offen offset:2048 sc1
    buffer_load_dwordx4 a[92:95], v2, s[24:27], s76 offen offset:2048 sc1
    s_addk_i32 s76, 4096
    buffer_load_dwordx4 a[16:19], v3, s[24:27], s76 offen sc1
    buffer_load_dwordx4 a[96:99], v2, s[24:27], s76 offen sc1
    buffer_load_dwordx4 a[20:23], v3, s[24:27], s76 offen offset:2048 sc1
    buffer_load_dwordx4 a[100:103], v2, s[24:27], s76 offen offset:2048 sc1
    v_lshlrev_b32 v8, 4, v6
    v_add_u32 v8, 160000, v8
    ds_read_b128 v[102:105], v8 offset:256
    ds_read_b128 v[106:109], v8 offset:320
    ds_read_b128 v[110:113], v8 offset:384
    s_waitcnt lgkmcnt(0)
    v_pk_fma_f32 v[78:79], v[36:37], v[102:103], v[78:79] op_sel:[1,0,0] neg_lo:[1,0,0] neg_hi:[1,0,0]
    v_pk_fma_f32 v[80:81], v[36:37], v[104:105], v[80:81] op_sel:[1,0,0] neg_lo:[1,0,0] neg_hi:[1,0,0]
    v_pk_fma_f32 v[82:83], v[36:37], v[106:107], v[82:83] op_sel:[1,0,0] neg_lo:[1,0,0] neg_hi:[1,0,0]
    v_pk_fma_f32 v[84:85], v[36:37], v[108:109], v[84:85] op_sel:[1,0,0] neg_lo:[1,0,0] neg_hi:[1,0,0]
    v_pk_fma_f32 v[86:87], v[36:37], v[110:111], v[86:87] op_sel:[1,0,0] neg_lo:[1,0,0] neg_hi:[1,0,0]
    v_pk_fma_f32 v[88:89], v[36:37], v[112:113], v[88:89] op_sel:[1,0,0] neg_lo:[1,0,0] neg_hi:[1,0,0]
    v_pk_fma_f32 v[90:91], v[24:25], v[102:103], v[90:91] op_sel_hi:[0,1,1] neg_lo:[1,0,0] neg_hi:[1,0,0]
    v_pk_fma_f32 v[92:93], v[24:25], v[104:105], v[92:93] op_sel_hi:[0,1,1] neg_lo:[1,0,0] neg_hi:[1,0,0]
    v_pk_fma_f32 v[94:95], v[24:25], v[106:107], v[94:95] op_sel_hi:[0,1,1] neg_lo:[1,0,0] neg_hi:[1,0,0]
    v_pk_fma_f32 v[96:97], v[24:25], v[108:109], v[96:97] op_sel_hi:[0,1,1] neg_lo:[1,0,0] neg_hi:[1,0,0]
    v_pk_fma_f32 v[98:99], v[24:25], v[110:111], v[98:99] op_sel_hi:[0,1,1] neg_lo:[1,0,0] neg_hi:[1,0,0]
    v_pk_fma_f32 v[100:101], v[24:25], v[112:113], v[100:101] op_sel_hi:[0,1,1] neg_lo:[1,0,0] neg_hi:[1,0,0]
    v_cvt_pk_bf16_f32 v102, v78, v79
    v_pk_max_i16 v102, v102, 0
    v_cvt_pk_bf16_f32 v103, v80, v81
    v_pk_max_i16 v103, v103, 0
    v_cvt_pk_bf16_f32 v104, v82, v83
    v_pk_max_i16 v104, v104, 0
    v_cvt_pk_bf16_f32 v105, v84, v85
    v_pk_max_i16 v105, v105, 0
    v_cvt_pk_bf16_f32 v110, v86, v87
    v_pk_max_i16 v110, v110, 0
    v_cvt_pk_bf16_f32 v111, v88, v89
    v_pk_max_i16 v111, v111, 0
    s_add_u32 s38, s87, 32768
    buffer_store_dwordx4 v[102:105], v3, s[24:27], s38 offen sc1
    buffer_store_dwordx2 v[110:111], v5, s[24:27], s88 offen sc1
    v_cvt_pk_bf16_f32 v106, v90, v91
    v_pk_max_i16 v106, v106, 0
    v_cvt_pk_bf16_f32 v107, v92, v93
    v_pk_max_i16 v107, v107, 0
    v_cvt_pk_bf16_f32 v108, v94, v95
    v_pk_max_i16 v108, v108, 0
    v_cvt_pk_bf16_f32 v109, v96, v97
    v_pk_max_i16 v109, v109, 0
    v_cvt_pk_bf16_f32 v112, v98, v99
    v_pk_max_i16 v112, v112, 0
    v_cvt_pk_bf16_f32 v113, v100, v101
    v_pk_max_i16 v113, v113, 0
    s_add_u32 s38, s87, 88064
    s_add_u32 s88, s88, 55296
    buffer_store_dwordx4 v[106:109], v3, s[24:27], s38 offen sc1
    buffer_store_dwordx2 v[112:113], v5, s[24:27], s88 offen sc1
    s_nop 1
    s_and_b32 s38, s36, 1
    s_cmp_eq_u32 s38, 1
    s_cbranch_scc1 L_p4odd
    ds_read_b32 v12, v27 offset:80
    s_waitcnt lgkmcnt(0)
    v_cmp_gt_u32 vcc, 48, v12
    s_cbranch_vccnz L_cw_119
L_cn_120:
    ds_read_b128 a[48:51], v3 offset:36864
    ds_read_b128 a[52:55], v3 offset:37888
    ds_read_b128 a[56:59], v3 offset:38912
    ds_read_b128 a[60:63], v3 offset:39936
    ds_read_b128 a[64:67], v18 offset:61440
    s_waitcnt vmcnt(14) lgkmcnt(3)
    s_add_u32 s76, s71, 12288
    buffer_load_dwordx4 a[24:27], v3, s[24:27], s76 offen sc1
    v_mfma_f32_16x16x32_bf16 v[46:49], a[48:51], a[0:3], 0
    v_mfma_f32_16x16x32_bf16 v[66:69], a[48:51], a[80:83], 0
    ds_read_b32 v12, v27 offset:80
    ds_read_b128 a[68:71], v19 offset:2048
    v_mfma_f32_16x16x32_bf16 v[50:53], a[52:55], a[0:3], 0
    v_mfma_f32_16x16x32_bf16 v[70:73], a[52:55], a[80:83], 0
    ds_read_b128 a[72:75], v19 offset:3072
    s_waitcnt lgkmcnt(3)
    buffer_load_dwordx4 a[104:107], v2, s[24:27], s76 offen sc1
    v_mfma_f32_16x16x32_bf16 v[54:57], a[56:59], a[0:3], 0
    v_mfma_f32_16x16x32_bf16 v[74:77], a[56:59], a[80:83], 0
    ds_read_b128 a[76:79], v19 offset:4096
    v_mfma_f32_16x16x32_bf16 v[58:61], a[60:63], a[0:3], 0
    v_mfma_f32_16x16x32_bf16 v[78:81], a[60:63], a[80:83], 0
    ds_read_b128 v[96:99], v19 offset:5120
    v_mfma_f32_16x16x32_bf16 v[62:65], a[64:67], a[0:3], 0
    buffer_load_dwordx4 a[28:31], v3, s[24:27], s76 offen offset:2048 sc1
    v_mfma_f32_16x16x32_bf16 v[82:85], a[64:67], a[80:83], 0
    s_waitcnt lgkmcnt(4)
    v_cmp_gt_u32 vcc, 53, v12
    ds_read_b128 v[100:103], v19 offset:6144
    s_cbranch_vccnz L_cw_122
L_cn_123:
    s_waitcnt vmcnt(15) lgkmcnt(3)
    v_mfma_f32_16x16x32_bf16 v[46:49], a[68:71], a[4:7], v[46:49]
    v_mfma_f32_16x16x32_bf16 v[66:69], a[68:71], a[84:87], v[66:69]
    ds_read_b128 a[48:51], v19 offset:12288
    v_mfma_f32_16x16x32_bf16 v[50:53], a[72:75], a[4:7], v[50:53]
    buffer_load_dwordx4 v[20:23], v2, s[24:27], s76 offen offset:2048 sc1
    v_mfma_f32_16x16x32_bf16 v[70:73], a[72:75], a[84:87], v[70:73]
    ds_read_b128 a[52:55], v19 offset:13312
    s_waitcnt lgkmcnt(2)
    v_mfma_f32_16x16x32_bf16 v[54:57], a[76:79], a[4:7], v[54:57]
    v_mfma_f32_16x16x32_bf16 v[74:77], a[76:79], a[84:87], v[74:77]
    ds_read_b128 a[56:59], v19 offset:14336
    v_mfma_f32_16x16x32_bf16 v[58:61], v[96:99], a[4:7], v[58:61]
    v_mfma_f32_16x16x32_bf16 v[78:81], v[96:99], a[84:87], v[78:81]
    s_add_u32 s76, s71, 16384
    buffer_load_dwordx4 a[32:35], v3, s[24:27], s76 offen sc1
    ds_read_b128 a[60:63], v19 offset:15360
    v_mfma_f32_16x16x32_bf16 v[62:65], v[100:103], a[4:7], v[62:65]
    v_mfma_f32_16x16x32_bf16 v[82:85], v[100:103], a[84:87], v[82:85]
    ds_read_b128 a[64:67], v19 offset:16384
    v_mov_b32 v10, 76
    ds_write_b32 v26, v10 offset:96
    s_waitcnt vmcnt(15) lgkmcnt(4)
    v_mfma_f32_16x16x32_bf16 v[46:49], a[48:51], a[8:11], v[46:49]
    v_mfma_f32_16x16x32_bf16 v[66:69], a[48:51], a[88:91], v[66:69]
    buffer_load_dwordx4 v[28:31], v2, s[24:27], s76 offen sc1
    ds_read_b32 v12, v27 offset:80
    ds_read_b128 a[68:71], v3 offset:43008
    v_mfma_f32_16x16x32_bf16 v[50:53], a[52:55], a[8:11], v[50:53]
    v_mfma_f32_16x16x32_bf16 v[70:73], a[52:55], a[88:91], v[70:73]
    ds_read_b128 a[72:75], v3 offset:44032
    s_waitcnt lgkmcnt(4)
    v_mfma_f32_16x16x32_bf16 v[54:57], a[56:59], a[8:11], v[54:57]
    v_mfma_f32_16x16x32_bf16 v[74:77], a[56:59], a[88:91], v[74:77]
    buffer_load_dwordx4 a[36:39], v3, s[24:27], s76 offen offset:2048 sc1
    ds_read_b128 a[76:79], v3 offset:45056
    v_mfma_f32_16x16x32_bf16 v[58:61], a[60:63], a[8:11], v[58:61]
    v_mfma_f32_16x16x32_bf16 v[78:81], a[60:63], a[88:91], v[78:81]
    ds_read_b128 v[96:99], v3 offset:46080
    v_mfma_f32_16x16x32_bf16 v[62:65], a[64:67], a[8:11], v[62:65]
    v_mfma_f32_16x16x32_bf16 v[82:85], a[64:67], a[88:91], v[82:85]
    s_waitcnt lgkmcnt(4)
    buffer_load_dwordx4 v[32:35], v2, s[24:27], s76 offen offset:2048 sc1
    v_cmp_gt_u32 vcc, 58, v12
    ds_read_b128 v[100:103], v3 offset:47104
    s_cbranch_vccnz L_cw_125
L_cn_126:
    s_waitcnt vmcnt(16) lgkmcnt(3)
    v_mfma_f32_16x16x32_bf16 v[46:49], a[68:71], a[12:15], v[46:49]
    v_mfma_f32_16x16x32_bf16 v[66:69], a[68:71], a[92:95], v[66:69]
    ds_read_b128 a[48:51], v18 offset:28672
    v_mfma_f32_16x16x32_bf16 v[50:53], a[72:75], a[12:15], v[50:53]
    v_mfma_f32_16x16x32_bf16 v[70:73], a[72:75], a[92:95], v[70:73]
    s_add_u32 s76, s71, 20480
    buffer_load_dwordx4 a[40:43], v3, s[24:27], s76 offen sc1
    ds_read_b128 a[52:55], v18 offset:29696
    s_waitcnt lgkmcnt(2)
    v_mfma_f32_16x16x32_bf16 v[54:57], a[76:79], a[12:15], v[54:57]
    v_mfma_f32_16x16x32_bf16 v[74:77], a[76:79], a[92:95], v[74:77]
    ds_read_b128 a[56:59], v18 offset:30720
    v_mfma_f32_16x16x32_bf16 v[58:61], v[96:99], a[12:15], v[58:61]
    v_mfma_f32_16x16x32_bf16 v[78:81], v[96:99], a[92:95], v[78:81]
    buffer_load_dwordx4 v[38:41], v2, s[24:27], s76 offen sc1
    ds_read_b128 a[60:63], v18 offset:31744
    v_mfma_f32_16x16x32_bf16 v[62:65], v[100:103], a[12:15], v[62:65]
    v_mfma_f32_16x16x32_bf16 v[82:85], v[100:103], a[92:95], v[82:85]
    ds_read_b128 a[64:67], v18 offset:32768
    v_mov_b32 v10, 81
    ds_write_b32 v26, v10 offset:96
    s_waitcnt vmcnt(16) lgkmcnt(4)
    v_mfma_f32_16x16x32_bf16 v[46:49], a[48:51], a[16:19], v[46:49]
    v_mfma_f32_16x16x32_bf16 v[66:69], a[48:51], a[96:99], v[66:69]
    buffer_load_dwordx4 a[44:47], v3, s[24:27], s76 offen offset:2048 sc1
    ds_read_b32 v12, v27 offset:80
    ds_read_b128 a[68:71], v18 offset:38912
    v_mfma_f32_16x16x32_bf16 v[50:53], a[52:55], a[16:19], v[50:53]
    v_mfma_f32_16x16x32_bf16 v[70:73], a[52:55], a[96:99], v[70:73]
    ds_read_b128 a[72:75], v18 offset:39936
    s_waitcnt lgkmcnt(4)
    v_mfma_f32_16x16x32_bf16 v[54:57], a[56:59], a[16:19], v[54:57]
    v_mfma_f32_16x16x32_bf16 v[74:77], a[56:59], a[96:99], v[74:77]
    buffer_load_dwordx4 v[42:45], v2, s[24:27], s76 offen offset:2048 sc1
    ds_read_b128 a[76:79], v18 offset:45056
    v_mfma_f32_16x16x32_bf16 v[58:61], a[60:63], a[16:19], v[58:61]
    v_mfma_f32_16x16x32_bf16 v[78:81], a[60:63], a[96:99], v[78:81]
    ds_read_b128 v[96:99], v18 offset:46080
    v_mfma_f32_16x16x32_bf16 v[62:65], a[64:67], a[16:19], v[62:65]
    v_mfma_f32_16x16x32_bf16 v[82:85], a[64:67], a[96:99], v[82:85]
    ds_read_b128 v[100:103], v18 offset:47104
    s_add_u32 s76, s71, 24576
    buffer_load_dwordx4 a[0:3], v3, s[24:27], s76 offen sc1
    s_waitcnt vmcnt(13)
    s_cmp_eq_u32 s49, 0
    s_cbranch_scc1 L_sl_128
    s_lshl_b32 s45, s36, 5
    s_add_u32 s45, s45, s56
    s_add_u32 s45, s45, 131072
    s_mov_b64 exec, 1
    buffer_store_dwordx2 v[16:17], v11, s[24:27], s45 offen offset:8
    s_mov_b64 exec, -1
    s_branch L_dn_129
L_sl_128:
    s_lshl_b32 s45, s36, 5
    s_add_u32 s45, s45, s56
    s_add_u32 s45, s45, 131072
    s_mov_b64 exec, 1
    buffer_store_dwordx2 v[16:17], v11, s[24:27], s45 offen offset:8 sc1
    s_mov_b64 exec, -1
L_dn_129:
    ds_read_b32 v12, v27 offset:80
    s_waitcnt lgkmcnt(0)
    v_cmp_gt_u32 vcc, 63, v12
    s_cbranch_vccnz L_cw_130
L_cn_131:
    v_mfma_f32_16x16x32_bf16 v[46:49], a[68:71], a[20:23], v[46:49]
    buffer_load_dwordx4 a[80:83], v2, s[24:27], s76 offen sc1
    v_mfma_f32_16x16x32_bf16 v[66:69], a[68:71], a[100:103], v[66:69]
    ds_read_b128 a[48:51], v18 offset:53248
    v_mfma_f32_16x16x32_bf16 v[50:53], a[72:75], a[20:23], v[50:53]
    v_mfma_f32_16x16x32_bf16 v[70:73], a[72:75], a[100:103], v[70:73]
    ds_read_b128 a[52:55], v18 offset:54272
    v_mfma_f32_16x16x32_bf16 v[54:57], a[76:79], a[20:23], v[54:57]
    v_mfma_f32_16x16x32_bf16 v[74:77], a[76:79], a[100:103], v[74:77]
    buffer_load_dwordx4 a[4:7], v3, s[24:27], s76 offen offset:2048 sc1
    ds_read_b128 a[56:59], v18 offset:55296
    v_mfma_f32_16x16x32_bf16 v[58:61], v[96:99], a[20:23], v[58:61]
    v_mfma_f32_16x16x32_bf16 v[78:81], v[96:99], a[100:103], v[78:81]
    ds_read_b128 a[60:63], v18 offset:56320
    v_mfma_f32_16x16x32_bf16 v[62:65], v[100:103], a[20:23], v[62:65]
    v_mfma_f32_16x16x32_bf16 v[82:85], v[100:103], a[100:103], v[82:85]
    ds_read_b128 a[64:67], v19 offset:20480
    buffer_load_dwordx4 a[84:87], v2, s[24:27], s76 offen offset:2048 sc1
    v_mov_b32 v10, 86
    ds_write_b32 v26, v10 offset:96
    s_waitcnt vmcnt(15) lgkmcnt(4)
    v_mfma_f32_16x16x32_bf16 v[46:49], a[48:51], a[24:27], v[46:49]
    v_mfma_f32_16x16x32_bf16 v[66:69], a[48:51], a[104:107], v[66:69]
    ds_read_b32 v12, v27 offset:80
    ds_read_b128 a[68:71], v19 offset:26624
    v_mfma_f32_16x16x32_bf16 v[50:53], a[52:55], a[24:27], v[50:53]
    v_mfma_f32_16x16x32_bf16 v[70:73], a[52:55], a[104:107], v[70:73]
    s_mov_b32 s45, 196608
    s_mov_b64 exec, 0xffff
    buffer_load_dwordx2 v[14:15], v25, s[24:27], s45 offen offset:8 sc1
    s_mov_b64 exec, -1
    ds_read_b128 a[72:75], v19 offset:27648
    s_waitcnt lgkmcnt(4)
    v_mfma_f32_16x16x32_bf16 v[54:57], a[56:59], a[24:27], v[54:57]
    s_add_u32 s76, s71, 28672
    buffer_load_dwordx4 a[8:11], v3, s[24:27], s76 offen sc1
    v_mfma_f32_16x16x32_bf16 v[74:77], a[56:59], a[104:107], v[74:77]
    ds_read_b128 a[76:79], v3 offset:53248
    v_mfma_f32_16x16x32_bf16 v[58:61], a[60:63], a[24:27], v[58:61]
    v_mfma_f32_16x16x32_bf16 v[78:81], a[60:63], a[104:107], v[78:81]
    ds_read_b128 v[96:99], v3 offset:54272
    v_mfma_f32_16x16x32_bf16 v[62:65], a[64:67], a[24:27], v[62:65]
    v_mfma_f32_16x16x32_bf16 v[82:85], a[64:67], a[104:107], v[82:85]
    buffer_load_dwordx4 a[88:91], v2, s[24:27], s76 offen sc1
    s_waitcnt lgkmcnt(4)
    v_cmp_gt_u32 vcc, 68, v12
    ds_read_b128 v[100:103], v3 offset:55296
    s_cbranch_vccnz L_cw_133
L_cn_134:
    s_waitcnt vmcnt(16) lgkmcnt(3)
    v_mfma_f32_16x16x32_bf16 v[46:49], a[68:71], a[28:31], v[46:49]
    v_mfma_f32_16x16x32_bf16 v[66:69], a[68:71], v[20:23], v[66:69]
    ds_read_b128 a[48:51], v3 offset:61440
    v_mfma_f32_16x16x32_bf16 v[50:53], a[72:75], a[28:31], v[50:53]
    v_mfma_f32_16x16x32_bf16 v[70:73], a[72:75], v[20:23], v[70:73]
    buffer_load_dwordx4 a[12:15], v3, s[24:27], s76 offen offset:2048 sc1
    ds_read_b128 a[52:55], v3 offset:62464
    s_waitcnt lgkmcnt(2)
    v_mfma_f32_16x16x32_bf16 v[54:57], a[76:79], a[28:31], v[54:57]
    v_mfma_f32_16x16x32_bf16 v[74:77], a[76:79], v[20:23], v[74:77]
    ds_read_b128 a[56:59], v3 offset:63488
    v_mfma_f32_16x16x32_bf16 v[58:61], v[96:99], a[28:31], v[58:61]
    v_mfma_f32_16x16x32_bf16 v[78:81], v[96:99], v[20:23], v[78:81]
    buffer_load_dwordx4 a[92:95], v2, s[24:27], s76 offen offset:2048 sc1
    ds_read_b128 a[60:63], v3 offset:64512
    v_mfma_f32_16x16x32_bf16 v[62:65], v[100:103], a[28:31], v[62:65]
    v_mfma_f32_16x16x32_bf16 v[82:85], v[100:103], v[20:23], v[82:85]
    ds_read_b128 a[64:67], v18
    v_mov_b32 v10, 91
    ds_write_b32 v26, v10 offset:96
    s_waitcnt vmcnt(16) lgkmcnt(4)
    v_mfma_f32_16x16x32_bf16 v[46:49], a[48:51], a[32:35], v[46:49]
    v_mfma_f32_16x16x32_bf16 v[66:69], a[48:51], v[28:31], v[66:69]
    ds_read_b32 v12, v27 offset:80
    ds_read_b128 a[68:71], v18 offset:6144
    v_mfma_f32_16x16x32_bf16 v[50:53], a[52:55], a[32:35], v[50:53]
    v_mfma_f32_16x16x32_bf16 v[70:73], a[52:55], v[28:31], v[70:73]
    ds_read_b128 a[72:75], v18 offset:7168
    s_waitcnt lgkmcnt(4)
    v_mfma_f32_16x16x32_bf16 v[54:57], a[56:59], a[32:35], v[54:57]
    v_mfma_f32_16x16x32_bf16 v[74:77], a[56:59], v[28:31], v[74:77]
    ds_read_b128 a[76:79], v18 offset:8192
    v_mfma_f32_16x16x32_bf16 v[58:61], a[60:63], a[32:35], v[58:61]
    v_mfma_f32_16x16x32_bf16 v[78:81], a[60:63], v[28:31], v[78:81]
    ds_read_b128 v[96:99], v18 offset:9216
    v_mfma_f32_16x16x32_bf16 v[62:65], a[64:67], a[32:35], v[62:65]
    v_mfma_f32_16x16x32_bf16 v[82:85], a[64:67], v[28:31], v[82:85]
    s_waitcnt lgkmcnt(4)
    v_cmp_gt_u32 vcc, 73, v12
    ds_read_b128 v[100:103], v18 offset:10240
    s_cbranch_vccnz L_cw_136
L_cn_137:
    s_waitcnt vmcnt(14) lgkmcnt(3)
    v_mfma_f32_16x16x32_bf16 v[46:49], a[68:71], a[36:39], v[46:49]
    v_mfma_f32_16x16x32_bf16 v[66:69], a[68:71], v[32:35], v[66:69]
    ds_read_b128 a[48:51], v18 offset:16384
    v_mfma_f32_16x16x32_bf16 v[50:53], a[72:75], a[36:39], v[50:53]
    v_mfma_f32_16x16x32_bf16 v[70:73], a[72:75], v[32:35], v[70:73]
    ds_read_b128 a[52:55], v18 offset:17408
    s_waitcnt lgkmcnt(2)
    v_mfma_f32_16x16x32_bf16 v[54:57], a[76:79], a[36:39], v[54:57]
    v_mfma_f32_16x16x32_bf16 v[74:77], a[76:79], v[32:35], v[74:77]
    ds_read_b128 a[56:59], v18 offset:18432
    v_mfma_f32_16x16x32_bf16 v[58:61], v[96:99], a[36:39], v[58:61]
    v_mfma_f32_16x16x32_bf16 v[78:81], v[96:99], v[32:35], v[78:81]
    ds_read_b128 a[60:63], v18 offset:19456
    v_mfma_f32_16x16x32_bf16 v[62:65], v[100:103], a[36:39], v[62:65]
    v_mfma_f32_16x16x32_bf16 v[82:85], v[100:103], v[32:35], v[82:85]
    ds_read_b128 a[64:67], v18 offset:20480
    v_mov_b32 v10, 96
    ds_write_b32 v26, v10 offset:96
    s_waitcnt vmcnt(12) lgkmcnt(4)
    v_mfma_f32_16x16x32_bf16 v[46:49], a[48:51], a[40:43], v[46:49]
    v_mfma_f32_16x16x32_bf16 v[66:69], a[48:51], v[38:41], v[66:69]
    ds_read_b32 v12, v27 offset:80
    ds_read_b128 a[68:71], v18 offset:26624
    v_mfma_f32_16x16x32_bf16 v[50:53], a[52:55], a[40:43], v[50:53]
    v_mfma_f32_16x16x32_bf16 v[70:73], a[52:55], v[38:41], v[70:73]
    ds_read_b128 a[72:75], v18 offset:27648
    s_waitcnt lgkmcnt(4)
    v_mfma_f32_16x16x32_bf16 v[54:57], a[56:59], a[40:43], v[54:57]
    v_mfma_f32_16x16x32_bf16 v[74:77], a[56:59], v[38:41], v[74:77]
    ds_read_b128 a[76:79], v18 offset:40960
    v_mfma_f32_16x16x32_bf16 v[58:61], a[60:63], a[40:43], v[58:61]
    v_mfma_f32_16x16x32_bf16 v[78:81], a[60:63], v[38:41], v[78:81]
    ds_read_b128 v[96:99], v18 offset:41984
    v_mfma_f32_16x16x32_bf16 v[62:65], a[64:67], a[40:43], v[62:65]
    v_mfma_f32_16x16x32_bf16 v[82:85], a[64:67], v[38:41], v[82:85]
    s_waitcnt lgkmcnt(4)
    v_cmp_gt_u32 vcc, 78, v12
    ds_read_b128 v[100:103], v18 offset:43008
    s_cbranch_vccnz L_cw_139
L_cn_140:
    s_waitcnt vmcnt(10) lgkmcnt(3)
    v_mfma_f32_16x16x32_bf16 v[46:49], a[68:71], a[44:47], v[46:49]
    v_mfma_f32_16x16x32_bf16 v[66:69], a[68:71], v[42:45], v[66:69]
    ds_read_b128 a[48:51], v3
    v_mfma_f32_16x16x32_bf16 v[50:53], a[72:75], a[44:47], v[50:53]
    v_mfma_f32_16x16x32_bf16 v[70:73], a[72:75], v[42:45], v[70:73]
    ds_read_b128 a[52:55], v3 offset:1024
    s_waitcnt lgkmcnt(2)
    v_mfma_f32_16x16x32_bf16 v[54:57], a[76:79], a[44:47], v[54:57]
    v_mfma_f32_16x16x32_bf16 v[74:77], a[76:79], v[42:45], v[74:77]
    ds_read_b128 a[56:59], v3 offset:2048
    v_mfma_f32_16x16x32_bf16 v[58:61], v[96:99], a[44:47], v[58:61]
    v_mfma_f32_16x16x32_bf16 v[78:81], v[96:99], v[42:45], v[78:81]
    ds_read_b128 a[60:63], v3 offset:3072
    v_mfma_f32_16x16x32_bf16 v[62:65], v[100:103], a[44:47], v[62:65]
    v_mfma_f32_16x16x32_bf16 v[82:85], v[100:103], v[42:45], v[82:85]
    ds_read_b128 a[64:67], v3 offset:4096
    v_mov_b32 v10, 101
    ds_write_b32 v26, v10 offset:96
    s_waitcnt vmcnt(7) lgkmcnt(4)
    v_mfma_f32_16x16x32_bf16 v[46:49], a[48:51], a[0:3], v[46:49]
    v_mfma_f32_16x16x32_bf16 v[66:69], a[48:51], a[80:83], v[66:69]
    ds_read_b32 v12, v27 offset:80
    ds_read_b128 a[68:71], v3 offset:10240
    v_mfma_f32_16x16x32_bf16 v[50:53], a[52:55], a[0:3], v[50:53]
    v_mfma_f32_16x16x32_bf16 v[70:73], a[52:55], a[80:83], v[70:73]
    ds_read_b128 a[72:75], v3 offset:11264
    s_waitcnt lgkmcnt(4)
    v_mfma_f32_16x16x32_bf16 v[54:57], a[56:59], a[0:3], v[54:57]
    v_mfma_f32_16x16x32_bf16 v[74:77], a[56:59], a[80:83], v[74:77]
    ds_read_b128 a[76:79], v3 offset:12288
    v_mfma_f32_16x16x32_bf16 v[58:61], a[60:63], a[0:3], v[58:61]
    v_mfma_f32_16x16x32_bf16 v[78:81], a[60:63], a[80:83], v[78:81]
    ds_read_b128 v[96:99], v3 offset:13312
    v_mfma_f32_16x16x32_bf16 v[62:65], a[64:67], a[0:3], v[62:65]
    v_mfma_f32_16x16x32_bf16 v[82:85], a[64:67], a[80:83], v[82:85]
    s_waitcnt lgkmcnt(4)
    v_cmp_gt_u32 vcc, 83, v12
    ds_read_b128 v[100:103], v3 offset:14336
    s_cbranch_vccnz L_cw_142
L_cn_143:
    s_waitcnt vmcnt(5) lgkmcnt(3)
    v_mfma_f32_16x16x32_bf16 v[46:49], a[68:71], a[4:7], v[46:49]
    v_mfma_f32_16x16x32_bf16 v[66:69], a[68:71], a[84:87], v[66:69]
    ds_read_b128 a[48:51], v3 offset:20480
    v_mfma_f32_16x16x32_bf16 v[50:53], a[72:75], a[4:7], v[50:53]
    v_mfma_f32_16x16x32_bf16 v[70:73], a[72:75], a[84:87], v[70:73]
    ds_read_b128 a[52:55], v3 offset:21504
    s_waitcnt lgkmcnt(2)
    v_mfma_f32_16x16x32_bf16 v[54:57], a[76:79], a[4:7], v[54:57]
    v_mfma_f32_16x16x32_bf16 v[74:77], a[76:79], a[84:87], v[74:77]
    ds_read_b128 a[56:59], v3 offset:22528
    v_mfma_f32_16x16x32_bf16 v[58:61], v[96:99], a[4:7], v[58:61]
    v_mfma_f32_16x16x32_bf16 v[78:81], v[96:99], a[84:87], v[78:81]
    ds_read_b128 a[60:63], v3 offset:23552
    v_mfma_f32_16x16x32_bf16 v[62:65], v[100:103], a[4:7], v[62:65]
    v_mfma_f32_16x16x32_bf16 v[82:85], v[100:103], a[84:87], v[82:85]
    ds_read_b128 a[64:67], v3 offset:24576
    v_mov_b32 v10, 106
    ds_write_b32 v26, v10 offset:96
    s_waitcnt vmcnt(2) lgkmcnt(4)
    s_mov_b64 exec, 0xffff
    s_mov_b32 s48, 200000
    s_mov_b32 s45, 196608
    s_branch L_pc_147
L_pt_145:
    buffer_load_dwordx2 v[14:15], v25, s[24:27], s45 offen offset:8 sc1
    s_waitcnt vmcnt(0)
L_pc_147:
    v_cmp_ne_u64_e64 vcc, s[32:33], v[14:15]
    s_cbranch_vccz L_pn_146
    s_mov_b64 exec, vcc
    s_sub_u32 s48, s48, 1
    s_cmp_lg_u32 s48, 0
    s_cbranch_scc1 L_pt_145
L_pn_146:
    s_mov_b64 exec, -1
    v_mfma_f32_16x16x32_bf16 v[46:49], a[48:51], a[8:11], v[46:49]
    s_add_u32 s76, s71, 32768
    buffer_load_dwordx4 a[16:19], v3, s[24:27], s76 offen sc1
    v_mfma_f32_16x16x32_bf16 v[66:69], a[48:51], a[88:91], v[66:69]
    ds_read_b32 v12, v27 offset:80
    ds_read_b128 a[68:71], v3 offset:30720
    v_mfma_f32_16x16x32_bf16 v[50:53], a[52:55], a[8:11], v[50:53]
    v_mfma_f32_16x16x32_bf16 v[70:73], a[52:55], a[88:91], v[70:73]
    ds_read_b128 a[72:75], v3 offset:31744
    s_waitcnt lgkmcnt(4)
    v_mfma_f32_16x16x32_bf16 v[54:57], a[56:59], a[8:11], v[54:57]
    v_mfma_f32_16x16x32_bf16 v[74:77], a[56:59], a[88:91], v[74:77]
    buffer_load_dwordx4 a[96:99], v2, s[24:27], s76 offen sc1
    ds_read_b128 a[76:79], v3 offset:32768
    v_mfma_f32_16x16x32_bf16 v[58:61], a[60:63], a[8:11], v[58:61]
    v_mfma_f32_16x16x32_bf16 v[78:81], a[60:63], a[88:91], v[78:81]
    ds_read_b128 v[96:99], v3 offset:33792
    v_mfma_f32_16x16x32_bf16 v[62:65], a[64:67], a[8:11], v[62:65]
    v_mfma_f32_16x16x32_bf16 v[82:85], a[64:67], a[88:91], v[82:85]
    s_waitcnt lgkmcnt(4)
    buffer_load_dwordx4 a[20:23], v3, s[24:27], s76 offen offset:2048 sc1
    v_cmp_gt_u32 vcc, 88, v12
    ds_read_b128 v[100:103], v3 offset:34816
    s_cbranch_vccnz L_cw_148
L_cn_149:
    s_waitcnt vmcnt(3) lgkmcnt(3)
    v_mfma_f32_16x16x32_bf16 v[46:49], a[68:71], a[12:15], v[46:49]
    v_mfma_f32_16x16x32_bf16 v[66:69], a[68:71], a[92:95], v[66:69]
    ds_read_b128 a[48:51], v18 offset:61440
    v_mfma_f32_16x16x32_bf16 v[50:53], a[72:75], a[12:15], v[50:53]
    v_mfma_f32_16x16x32_bf16 v[70:73], a[72:75], a[92:95], v[70:73]
    buffer_load_dwordx4 a[100:103], v2, s[24:27], s76 offen offset:2048 sc1
    ds_read_b128 a[52:55], v18 offset:62464
    s_waitcnt lgkmcnt(2)
    v_mfma_f32_16x16x32_bf16 v[54:57], a[76:79], a[12:15], v[54:57]
    v_mfma_f32_16x16x32_bf16 v[74:77], a[76:79], a[92:95], v[74:77]
    ds_read_b128 a[56:59], v18 offset:63488
    v_mfma_f32_16x16x32_bf16 v[58:61], v[96:99], a[12:15], v[58:61]
    v_mfma_f32_16x16x32_bf16 v[78:81], v[96:99], a[92:95], v[78:81]
    s_add_u32 s76, s71, 36864
    buffer_load_dwordx4 a[24:27], v3, s[24:27], s76 offen sc1
    ds_read_b128 a[60:63], v18 offset:64512
    v_mfma_f32_16x16x32_bf16 v[62:65], v[100:103], a[12:15], v[62:65]
    v_mfma_f32_16x16x32_bf16 v[82:85], v[100:103], a[92:95], v[82:85]
    ds_read_b128 a[64:67], v19
    v_mov_b32 v10, 109
    ds_write_b32 v26, v10 offset:96
    s_waitcnt vmcnt(3) lgkmcnt(4)
    v_mfma_f32_16x16x32_bf16 v[46:49], a[48:51], a[16:19], v[46:49]
    v_mfma_f32_16x16x32_bf16 v[66:69], a[48:51], a[96:99], v[66:69]
    buffer_load_dwordx4 a[104:107], v2, s[24:27], s76 offen sc1
    ds_read_b32 v12, v27 offset:80
    ds_read_b128 a[68:71], v19 offset:6144
    v_mfma_f32_16x16x32_bf16 v[50:53], a[52:55], a[16:19], v[50:53]
    v_mfma_f32_16x16x32_bf16 v[70:73], a[52:55], a[96:99], v[70:73]
    ds_read_b128 a[72:75], v19 offset:7168
    s_waitcnt lgkmcnt(4)
    v_mfma_f32_16x16x32_bf16 v[54:57], a[56:59], a[16:19], v[54:57]
    v_mfma_f32_16x16x32_bf16 v[74:77], a[56:59], a[96:99], v[74:77]
    buffer_load_dwordx4 a[28:31], v3, s[24:27], s76 offen offset:2048 sc1
    ds_read_b128 a[76:79], v19 offset:8192
    v_mfma_f32_16x16x32_bf16 v[58:61], a[60:63], a[16:19], v[58:61]
    v_mfma_f32_16x16x32_bf16 v[78:81], a[60:63], a[96:99], v[78:81]
    ds_read_b128 v[96:99], v19 offset:9216
    v_mfma_f32_16x16x32_bf16 v[62:65], a[64:67], a[16:19], v[62:65]
    v_mfma_f32_16x16x32_bf16 v[82:85], a[64:67], a[96:99], v[82:85]
    s_waitcnt lgkmcnt(4)
    buffer_load_dwordx4 v[20:23], v2, s[24:27], s76 offen offset:2048 sc1
    v_cmp_gt_u32 vcc, 93, v12
    ds_read_b128 v[100:103], v19 offset:10240
    s_cbranch_vccnz L_cw_151
L_cn_152:
    s_waitcnt vmcnt(4) lgkmcnt(3)
    v_mfma_f32_16x16x32_bf16 v[46:49], a[68:71], a[20:23], v[46:49]
    v_mfma_f32_16x16x32_bf16 v[66:69], a[68:71], a[100:103], v[66:69]
    ds_read_b128 a[48:51], v19 offset:16384
    v_mfma_f32_16x16x32_bf16 v[50:53], a[72:75], a[20:23], v[50:53]
    v_mfma_f32_16x16x32_bf16 v[70:73], a[72:75], a[100:103], v[70:73]
    s_add_u32 s76, s71, 40960
    buffer_load_dwordx4 a[32:35], v3, s[24:27], s76 offen sc1
    ds_read_b128 a[52:55], v19 offset:17408
    s_waitcnt lgkmcnt(2)
    v_mfma_f32_16x16x32_bf16 v[54:57], a[76:79], a[20:23], v[54:57]
    v_mfma_f32_16x16x32_bf16 v[74:77], a[76:79], a[100:103], v[74:77]
    ds_read_b128 a[56:59], v19 offset:18432
    v_mfma_f32_16x16x32_bf16 v[58:61], v[96:99], a[20:23], v[58:61]
    v_mfma_f32_16x16x32_bf16 v[78:81], v[96:99], a[100:103], v[78:81]
    buffer_load_dwordx4 v[28:31], v2, s[24:27], s76 offen sc1
    ds_read_b128 a[60:63], v19 offset:19456
    v_mfma_f32_16x16x32_bf16 v[62:65], v[100:103], a[20:23], v[62:65]
    v_mfma_f32_16x16x32_bf16 v[82:85], v[100:103], a[100:103], v[82:85]
    ds_read_b128 a[64:67], v3 offset:40960
    s_waitcnt vmcnt(4) lgkmcnt(3)
    v_mfma_f32_16x16x32_bf16 v[46:49], a[48:51], a[24:27], v[46:49]
    v_mfma_f32_16x16x32_bf16 v[66:69], a[48:51], a[104:107], v[66:69]
    ds_read_b32 v12, v27 offset:80
    buffer_load_dwordx4 a[36:39], v3, s[24:27], s76 offen offset:2048 sc1
    ds_read_b128 a[68:71], v3 offset:47104
    v_mfma_f32_16x16x32_bf16 v[50:53], a[52:55], a[24:27], v[50:53]
    v_mfma_f32_16x16x32_bf16 v[70:73], a[52:55], a[104:107], v[70:73]
    ds_read_b128 a[72:75], v3 offset:48128
    s_waitcnt lgkmcnt(3)
    v_mfma_f32_16x16x32_bf16 v[54:57], a[56:59], a[24:27], v[54:57]
    v_mfma_f32_16x16x32_bf16 v[74:77], a[56:59], a[104:107], v[74:77]
    ds_read_b128 a[76:79], v3 offset:49152
    buffer_load_dwordx4 v[32:35], v2, s[24:27], s76 offen offset:2048 sc1
    v_mfma_f32_16x16x32_bf16 v[58:61], a[60:63], a[24:27], v[58:61]
    v_mfma_f32_16x16x32_bf16 v[78:81], a[60:63], a[104:107], v[78:81]
    ds_read_b128 v[96:99], v3 offset:50176
    v_mfma_f32_16x16x32_bf16 v[62:65], a[64:67], a[24:27], v[62:65]
    v_mfma_f32_16x16x32_bf16 v[82:85], a[64:67], a[104:107], v[82:85]
    s_waitcnt lgkmcnt(4)
    v_cmp_gt_u32 vcc, 98, v12
    s_add_u32 s76, s71, 45056
    buffer_load_dwordx4 a[40:43], v3, s[24:27], s76 offen sc1
    ds_read_b128 v[100:103], v3 offset:51200
    s_cbranch_vccnz L_cw_154
L_cn_155:
    s_waitcnt vmcnt(5) lgkmcnt(3)
    v_mfma_f32_16x16x32_bf16 v[46:49], a[68:71], a[28:31], v[46:49]
    v_mfma_f32_16x16x32_bf16 v[66:69], a[68:71], v[20:23], v[66:69]
    ds_read_b128 a[48:51], v18 offset:32768
    v_mfma_f32_16x16x32_bf16 v[50:53], a[72:75], a[28:31], v[50:53]
    v_mfma_f32_16x16x32_bf16 v[70:73], a[72:75], v[20:23], v[70:73]
    buffer_load_dwordx4 v[38:41], v2, s[24:27], s76 offen sc1
    ds_read_b128 a[52:55], v18 offset:33792
    s_waitcnt lgkmcnt(2)
    v_mfma_f32_16x16x32_bf16 v[54:57], a[76:79], a[28:31], v[54:57]
    v_mfma_f32_16x16x32_bf16 v[74:77], a[76:79], v[20:23], v[74:77]
    ds_read_b128 a[56:59], v18 offset:34816
    v_mfma_f32_16x16x32_bf16 v[58:61], v[96:99], a[28:31], v[58:61]
    v_mfma_f32_16x16x32_bf16 v[78:81], v[96:99], v[20:23], v[78:81]
    buffer_load_dwordx4 a[44:47], v3, s[24:27], s76 offen offset:2048 sc1
    ds_read_b128 a[60:63], v18 offset:35840
    v_mfma_f32_16x16x32_bf16 v[62:65], v[100:103], a[28:31], v[62:65]
    v_mfma_f32_16x16x32_bf16 v[82:85], v[100:103], v[20:23], v[82:85]
    ds_read_b128 a[64:67], v18 offset:36864
    buffer_load_dwordx4 v[86:89], v3, s[24:27], s84 offen sc1
    s_add_u32 s38, s84, 8192
    buffer_load_dwordx4 v[90:93], v3, s[24:27], s38 offen sc1
    buffer_load_dwordx2 v[94:95], v5, s[24:27], s85 offen sc1
    s_waitcnt vmcnt(8) lgkmcnt(3)
    v_mfma_f32_16x16x32_bf16 v[46:49], a[48:51], a[32:35], v[46:49]
    v_mfma_f32_16x16x32_bf16 v[66:69], a[48:51], v[28:31], v[66:69]
    buffer_load_dwordx4 v[42:45], v2, s[24:27], s76 offen offset:2048 sc1
    ds_read_b32 v12, v27 offset:80
    ds_read_b128 a[68:71], v18 offset:47104
    v_mfma_f32_16x16x32_bf16 v[50:53], a[52:55], a[32:35], v[50:53]
    v_mfma_f32_16x16x32_bf16 v[70:73], a[52:55], v[28:31], v[70:73]
    ds_read_b128 a[72:75], v18 offset:48128
    s_waitcnt lgkmcnt(3)
    v_mfma_f32_16x16x32_bf16 v[54:57], a[56:59], a[32:35], v[54:57]
    v_mfma_f32_16x16x32_bf16 v[74:77], a[56:59], v[28:31], v[74:77]
    s_add_u32 s76, s71, 49152
    buffer_load_dwordx2 a[0:1], v5, s[24:27], s76 offen sc1
    ds_read_b128 a[76:79], v18 offset:49152
    v_mfma_f32_16x16x32_bf16 v[58:61], a[60:63], a[32:35], v[58:61]
    v_mfma_f32_16x16x32_bf16 v[78:81], a[60:63], v[28:31], v[78:81]
    ds_read_b128 v[96:99], v18 offset:50176
    buffer_load_dwordx2 a[2:3], v5, s[24:27], s76 offen offset:512 sc1
    v_mfma_f32_16x16x32_bf16 v[62:65], a[64:67], a[32:35], v[62:65]
    v_mfma_f32_16x16x32_bf16 v[82:85], a[64:67], v[28:31], v[82:85]
    s_waitcnt lgkmcnt(4)
    v_cmp_gt_u32 vcc, 103, v12
    buffer_load_dwordx2 a[80:81], v4, s[24:27], s76 offen sc1
    ds_read_b128 v[100:103], v18 offset:51200
    s_cbranch_vccnz L_cw_157
L_cn_158:
    s_waitcnt vmcnt(10) lgkmcnt(3)
    v_mfma_f32_16x16x32_bf16 v[46:49], a[68:71], a[36:39], v[46:49]
    v_mfma_f32_16x16x32_bf16 v[66:69], a[68:71], v[32:35], v[66:69]
    buffer_load_dwordx2 a[82:83], v4, s[24:27], s76 offen offset:512 sc1
    ds_read_b128 a[48:51], v19 offset:20480
    v_mfma_f32_16x16x32_bf16 v[50:53], a[72:75], a[36:39], v[50:53]
    v_mfma_f32_16x16x32_bf16 v[70:73], a[72:75], v[32:35], v[70:73]
    ds_read_b128 a[52:55], v19 offset:21504
    buffer_load_dwordx2 a[4:5], v5, s[24:27], s76 offen offset:2048 sc1
    s_waitcnt lgkmcnt(2)
    v_mfma_f32_16x16x32_bf16 v[54:57], a[76:79], a[36:39], v[54:57]
    v_mfma_f32_16x16x32_bf16 v[74:77], a[76:79], v[32:35], v[74:77]
    ds_read_b128 a[56:59], v19 offset:22528
    buffer_load_dwordx2 a[6:7], v5, s[24:27], s76 offen offset:2560 sc1
    v_mfma_f32_16x16x32_bf16 v[58:61], v[96:99], a[36:39], v[58:61]
    v_mfma_f32_16x16x32_bf16 v[78:81], v[96:99], v[32:35], v[78:81]
    ds_read_b128 a[60:63], v19 offset:23552
    v_mfma_f32_16x16x32_bf16 v[62:65], v[100:103], a[36:39], v[62:65]
    buffer_load_dwordx2 a[84:85], v4, s[24:27], s76 offen offset:2048 sc1
    v_mfma_f32_16x16x32_bf16 v[82:85], v[100:103], v[32:35], v[82:85]
    ds_read_b128 a[64:67], v19 offset:24576
    s_waitcnt vmcnt(12) lgkmcnt(3)
    v_mfma_f32_16x16x32_bf16 v[46:49], a[48:51], a[40:43], v[46:49]
    v_mfma_f32_16x16x32_bf16 v[66:69], a[48:51], v[38:41], v[66:69]
    buffer_load_dwordx2 a[86:87], v4, s[24:27], s76 offen offset:2560 sc1
    ds_read_b32 v12, v27 offset:80
    ds_read_b128 a[68:71], v3 offset:55296
    v_mfma_f32_16x16x32_bf16 v[50:53], a[52:55], a[40:43], v[50:53]
    v_mfma_f32_16x16x32_bf16 v[70:73], a[52:55], v[38:41], v[70:73]
    s_add_u32 s76, s71, 53248
    buffer_load_dwordx2 a[8:9], v5, s[24:27], s76 offen sc1
    ds_read_b128 a[72:75], v3 offset:56320
    s_waitcnt lgkmcnt(3)
    v_mfma_f32_16x16x32_bf16 v[54:57], a[56:59], a[40:43], v[54:57]
    v_mfma_f32_16x16x32_bf16 v[74:77], a[56:59], v[38:41], v[74:77]
    buffer_load_dwordx2 a[10:11], v5, s[24:27], s76 offen offset:512 sc1
    ds_read_b128 a[76:79], v3 offset:57344
    v_mfma_f32_16x16x32_bf16 v[58:61], a[60:63], a[40:43], v[58:61]
    v_mfma_f32_16x16x32_bf16 v[78:81], a[60:63], v[38:41], v[78:81]
    ds_read_b128 v[96:99], v3 offset:58368
    buffer_load_dwordx2 a[88:89], v4, s[24:27], s76 offen sc1
    v_mfma_f32_16x16x32_bf16 v[62:65], a[64:67], a[40:43], v[62:65]
    v_mfma_f32_16x16x32_bf16 v[82:85], a[64:67], v[38:41], v[82:85]
    s_waitcnt lgkmcnt(4)
    v_cmp_gt_u32 vcc, 108, v12
    buffer_load_dwordx2 a[90:91], v4, s[24:27], s76 offen offset:512 sc1
    ds_read_b128 v[100:103], v3 offset:59392
    s_cbranch_vccnz L_cw_160
L_cn_161:
    s_waitcnt vmcnt(12) lgkmcnt(3)
    v_mfma_f32_16x16x32_bf16 v[46:49], a[68:71], a[44:47], v[46:49]
    v_mfma_f32_16x16x32_bf16 v[66:69], a[68:71], v[42:45], v[66:69]
    ds_read_b128 a[48:51], v18
    v_mfma_f32_16x16x32_bf16 v[50:53], a[72:75], a[44:47], v[50:53]
    v_mfma_f32_16x16x32_bf16 v[70:73], a[72:75], v[42:45], v[70:73]
    ds_read_b128 a[52:55], v18 offset:1024
    s_waitcnt lgkmcnt(2)
    v_mfma_f32_16x16x32_bf16 v[54:57], a[76:79], a[44:47], v[54:57]
    v_mfma_f32_16x16x32_bf16 v[74:77], a[76:79], v[42:45], v[74:77]
    ds_read_b128 a[56:59], v18 offset:2048
    v_mfma_f32_16x16x32_bf16 v[58:61], v[96:99], a[44:47], v[58:61]
    v_mfma_f32_16x16x32_bf16 v[78:81], v[96:99], v[42:45], v[78:81]
    ds_read_b128 a[60:63], v18 offset:3072
    v_mfma_f32_16x16x32_bf16 v[62:65], v[100:103], a[44:47], v[62:65]
    v_mfma_f32_16x16x32_bf16 v[82:85], v[100:103], v[42:45], v[82:85]
    ds_read_b128 a[64:67], v18 offset:4096
    s_waitcnt vmcnt(8) lgkmcnt(3)
    v_mfma_f32_16x16x32_bf16 v[46:49], a[48:51], a[0:3], v[46:49]
    v_mfma_f32_16x16x32_bf16 v[66:69], a[48:51], a[80:83], v[66:69]
    ds_read_b32 v12, v27 offset:80
    ds_read_b128 a[68:71], v18 offset:10240
    v_mfma_f32_16x16x32_bf16 v[50:53], a[52:55], a[0:3], v[50:53]
    v_mfma_f32_16x16x32_bf16 v[70:73], a[52:55], a[80:83], v[70:73]
    ds_read_b128 a[72:75], v18 offset:11264
    s_waitcnt lgkmcnt(3)
    v_mfma_f32_16x16x32_bf16 v[54:57], a[56:59], a[0:3], v[54:57]
    v_mfma_f32_16x16x32_bf16 v[74:77], a[56:59], a[80:83], v[74:77]
    ds_read_b128 a[76:79], v18 offset:12288
    v_mfma_f32_16x16x32_bf16 v[58:61], a[60:63], a[0:3], v[58:61]
    v_mfma_f32_16x16x32_bf16 v[78:81], a[60:63], a[80:83], v[78:81]
    ds_read_b128 v[96:99], v18 offset:13312
    v_mfma_f32_16x16x32_bf16 v[62:65], a[64:67], a[0:3], v[62:65]
    v_mfma_f32_16x16x32_bf16 v[82:85], a[64:67], a[80:83], v[82:85]
    s_waitcnt lgkmcnt(4)
    v_cmp_gt_u32 vcc, 111, v12
    ds_read_b128 v[100:103], v18 offset:14336
    s_cbranch_vccnz L_cw_163
L_cn_164:
    s_waitcnt vmcnt(4) lgkmcnt(3)
    v_mfma_f32_16x16x32_bf16 v[46:49], a[68:71], a[4:7], v[46:49]
    v_mfma_f32_16x16x32_bf16 v[66:69], a[68:71], a[84:87], v[66:69]
    ds_read_b128 a[48:51], v18 offset:20480
    v_mfma_f32_16x16x32_bf16 v[50:53], a[72:75], a[4:7], v[50:53]
    v_mfma_f32_16x16x32_bf16 v[70:73], a[72:75], a[84:87], v[70:73]
    ds_read_b128 a[52:55], v18 offset:21504
    s_waitcnt lgkmcnt(2)
    v_mfma_f32_16x16x32_bf16 v[54:57], a[76:79], a[4:7], v[54:57]
    v_mfma_f32_16x16x32_bf16 v[74:77], a[76:79], a[84:87], v[74:77]
    ds_read_b128 a[56:59], v18 offset:22528
    v_mfma_f32_16x16x32_bf16 v[58:61], v[96:99], a[4:7], v[58:61]
    v_mfma_f32_16x16x32_bf16 v[78:81], v[96:99], a[84:87], v[78:81]
    ds_read_b128 a[60:63], v18 offset:23552
    v_mfma_f32_16x16x32_bf16 v[62:65], v[100:103], a[4:7], v[62:65]
    v_mfma_f32_16x16x32_bf16 v[82:85], v[100:103], a[84:87], v[82:85]
    ds_read_b128 a[64:67], v18 offset:24576
    s_waitcnt vmcnt(0) lgkmcnt(3)
    v_mfma_f32_16x16x32_bf16 v[46:49], a[48:51], a[8:11], v[46:49]
    v_mfma_f32_16x16x32_bf16 v[66:69], a[48:51], a[88:91], v[66:69]
    v_mfma_f32_16x16x32_bf16 v[50:53], a[52:55], a[8:11], v[50:53]
    v_mfma_f32_16x16x32_bf16 v[70:73], a[52:55], a[88:91], v[70:73]
    s_waitcnt lgkmcnt(0)
    v_mfma_f32_16x16x32_bf16 v[54:57], a[56:59], a[8:11], v[54:57]
    v_mfma_f32_16x16x32_bf16 v[74:77], a[56:59], a[88:91], v[74:77]
    v_mfma_f32_16x16x32_bf16 v[58:61], a[60:63], a[8:11], v[58:61]
    v_mfma_f32_16x16x32_bf16 v[78:81], a[60:63], a[88:91], v[78:81]
    v_mfma_f32_16x16x32_bf16 v[62:65], a[64:67], a[8:11], v[62:65]
    v_mfma_f32_16x16x32_bf16 v[82:85], a[64:67], a[88:91], v[82:85]
    ds_read_b32 v12, v27 offset:96
    s_waitcnt lgkmcnt(0)
    v_cmp_gt_u32 vcc, 109, v12
    s_cbranch_vccnz L_cw_166
L_cn_167:
    s_mov_b32 s39, 0
    s_mov_b32 s40, 4096
    s_mov_b32 s41, 8192
    s_mov_b32 s42, 12288
    s_cmp_ge_u32 s36, 2
    s_cselect_b32 s39, 16384, s39
    s_cselect_b32 s40, 20480, s40
    s_cselect_b32 s41, 24576, s41
    s_cselect_b32 s42, 28672, s42
    v_add_u32 v96, s39, v3
    v_add_u32 v97, s40, v3
    ds_write_b128 v96, v[66:69]
    ds_write_b128 v96, v[70:73] offset:1024
    ds_write_b128 v96, v[74:77] offset:2048
    ds_write_b128 v96, v[78:81] offset:3072
    ds_write_b128 v97, v[82:85]
    v_mov_b32 v10, 1
    ds_write_b32 v26, v10 offset:224
    v_add_u32 v96, s41, v3
    v_add_u32 v97, s42, v3
    v_xor_b32 v9, 4, v26
    s_mov_b32 s48, 200000
L_xw_169:
    ds_read_b32 v12, v9 offset:224
    s_waitcnt lgkmcnt(0)
    v_cmp_eq_u32 vcc, 0, v12
    s_cbranch_vccz L_xn_170
    s_sub_u32 s48, s48, 1
    s_cmp_lg_u32 s48, 0
    s_cbranch_scc1 L_xw_169
L_xn_170:
    ds_read_b128 v[66:69], v96
    ds_read_b128 v[70:73], v96 offset:1024
    ds_read_b128 v[74:77], v96 offset:2048
    ds_read_b128 v[78:81], v96 offset:3072
    ds_read_b128 v[82:85], v97
    s_waitcnt lgkmcnt(0)
    v_pk_add_f32 v[46:47], v[46:47], v[66:67]
    v_pk_add_f32 v[48:49], v[48:49], v[68:69]
    v_pk_add_f32 v[50:51], v[50:51], v[70:71]
    v_pk_add_f32 v[52:53], v[52:53], v[72:73]
    v_pk_add_f32 v[54:55], v[54:55], v[74:75]
    v_pk_add_f32 v[56:57], v[56:57], v[76:77]
    v_pk_add_f32 v[58:59], v[58:59], v[78:79]
    v_pk_add_f32 v[60:61], v[60:61], v[80:81]
    v_pk_add_f32 v[62:63], v[62:63], v[82:83]
    v_pk_add_f32 v[64:65], v[64:65], v[84:85]
    s_branch L_p4done
L_p4odd:
    ds_read_b32 v12, v27 offset:80
    s_waitcnt lgkmcnt(0)
    v_cmp_gt_u32 vcc, 49, v12
    s_cbranch_vccnz L_cw_171
L_cn_172:
    ds_read_b128 a[48:51], v18 offset:62464
    ds_read_b128 a[52:55], v18 offset:63488
    ds_read_b128 a[56:59], v18 offset:64512
    ds_read_b128 a[60:63], v19
    ds_read_b128 a[64:67], v19 offset:1024
    s_waitcnt vmcnt(14) lgkmcnt(3)
    s_add_u32 s76, s71, 12288
    buffer_load_dwordx4 a[24:27], v3, s[24:27], s76 offen offset:1024 sc1
    v_mfma_f32_16x16x32_bf16 v[46:49], a[48:51], a[0:3], 0
    buffer_load_dwordx4 a[104:107], v2, s[24:27], s76 offen offset:1024 sc1
    v_mfma_f32_16x16x32_bf16 v[66:69], a[48:51], a[80:83], 0
    ds_read_b32 v12, v27 offset:80
    ds_read_b128 a[68:71], v19 offset:7168
    v_mfma_f32_16x16x32_bf16 v[50:53], a[52:55], a[0:3], 0
    v_mfma_f32_16x16x32_bf16 v[70:73], a[52:55], a[80:83], 0
    ds_read_b128 a[72:75], v19 offset:8192
    s_waitcnt lgkmcnt(3)
    v_mfma_f32_16x16x32_bf16 v[54:57], a[56:59], a[0:3], 0
    v_mfma_f32_16x16x32_bf16 v[74:77], a[56:59], a[80:83], 0
    buffer_load_dwordx4 a[28:31], v3, s[24:27], s76 offen offset:3072 sc1
    ds_read_b128 a[76:79], v19 offset:9216
    v_mfma_f32_16x16x32_bf16 v[58:61], a[60:63], a[0:3], 0
    v_mfma_f32_16x16x32_bf16 v[78:81], a[60:63], a[80:83], 0
    ds_read_b128 v[96:99], v19 offset:10240
    v_mfma_f32_16x16x32_bf16 v[62:65], a[64:67], a[0:3], 0
    v_mfma_f32_16x16x32_bf16 v[82:85], a[64:67], a[80:83], 0
    s_waitcnt lgkmcnt(4)
    buffer_load_dwordx4 v[20:23], v2, s[24:27], s76 offen offset:3072 sc1
    v_cmp_gt_u32 vcc, 54, v12
    ds_read_b128 v[100:103], v19 offset:11264
    s_cbranch_vccnz L_cw_174
L_cn_175:
    s_waitcnt vmcnt(16) lgkmcnt(3)
    v_mfma_f32_16x16x32_bf16 v[46:49], a[68:71], a[4:7], v[46:49]
    v_mfma_f32_16x16x32_bf16 v[66:69], a[68:71], a[84:87], v[66:69]
    ds_read_b128 a[48:51], v19 offset:17408
    v_mfma_f32_16x16x32_bf16 v[50:53], a[72:75], a[4:7], v[50:53]
    v_mfma_f32_16x16x32_bf16 v[70:73], a[72:75], a[84:87], v[70:73]
    s_add_u32 s76, s71, 16384
    buffer_load_dwordx4 a[32:35], v3, s[24:27], s76 offen offset:1024 sc1
    ds_read_b128 a[52:55], v19 offset:18432
    s_waitcnt lgkmcnt(2)
    v_mfma_f32_16x16x32_bf16 v[54:57], a[76:79], a[4:7], v[54:57]
    v_mfma_f32_16x16x32_bf16 v[74:77], a[76:79], a[84:87], v[74:77]
    ds_read_b128 a[56:59], v19 offset:19456
    v_mfma_f32_16x16x32_bf16 v[58:61], v[96:99], a[4:7], v[58:61]
    v_mfma_f32_16x16x32_bf16 v[78:81], v[96:99], a[84:87], v[78:81]
    buffer_load_dwordx4 v[28:31], v2, s[24:27], s76 offen offset:1024 sc1
    ds_read_b128 a[60:63], v3 offset:40960
    v_mfma_f32_16x16x32_bf16 v[62:65], v[100:103], a[4:7], v[62:65]
    v_mfma_f32_16x16x32_bf16 v[82:85], v[100:103], a[84:87], v[82:85]
    ds_read_b128 a[64:67], v3 offset:41984
    v_mov_b32 v10, 77
    ds_write_b32 v26, v10 offset:96
    s_waitcnt vmcnt(16) lgkmcnt(4)
    v_mfma_f32_16x16x32_bf16 v[46:49], a[48:51], a[8:11], v[46:49]
    v_mfma_f32_16x16x32_bf16 v[66:69], a[48:51], a[88:91], v[66:69]
    buffer_load_dwordx4 a[36:39], v3, s[24:27], s76 offen offset:3072 sc1
    ds_read_b32 v12, v27 offset:80
    ds_read_b128 a[68:71], v3 offset:48128
    v_mfma_f32_16x16x32_bf16 v[50:53], a[52:55], a[8:11], v[50:53]
    v_mfma_f32_16x16x32_bf16 v[70:73], a[52:55], a[88:91], v[70:73]
    ds_read_b128 a[72:75], v3 offset:49152
    s_waitcnt lgkmcnt(4)
    v_mfma_f32_16x16x32_bf16 v[54:57], a[56:59], a[8:11], v[54:57]
    v_mfma_f32_16x16x32_bf16 v[74:77], a[56:59], a[88:91], v[74:77]
    buffer_load_dwordx4 v[32:35], v2, s[24:27], s76 offen offset:3072 sc1
    ds_read_b128 a[76:79], v3 offset:50176
    v_mfma_f32_16x16x32_bf16 v[58:61], a[60:63], a[8:11], v[58:61]
    v_mfma_f32_16x16x32_bf16 v[78:81], a[60:63], a[88:91], v[78:81]
    ds_read_b128 v[96:99], v3 offset:51200
    v_mfma_f32_16x16x32_bf16 v[62:65], a[64:67], a[8:11], v[62:65]
    v_mfma_f32_16x16x32_bf16 v[82:85], a[64:67], a[88:91], v[82:85]
    s_waitcnt lgkmcnt(4)
    s_add_u32 s76, s71, 20480
    buffer_load_dwordx4 a[40:43], v3, s[24:27], s76 offen offset:1024 sc1
    v_cmp_gt_u32 vcc, 59, v12
    ds_read_b128 v[100:103], v3 offset:52224
    s_cbranch_vccnz L_cw_177
L_cn_178:
    s_waitcnt vmcnt(17) lgkmcnt(3)
    v_mfma_f32_16x16x32_bf16 v[46:49], a[68:71], a[12:15], v[46:49]
    v_mfma_f32_16x16x32_bf16 v[66:69], a[68:71], a[92:95], v[66:69]
    ds_read_b128 a[48:51], v18 offset:33792
    v_mfma_f32_16x16x32_bf16 v[50:53], a[72:75], a[12:15], v[50:53]
    v_mfma_f32_16x16x32_bf16 v[70:73], a[72:75], a[92:95], v[70:73]
    buffer_load_dwordx4 v[38:41], v2, s[24:27], s76 offen offset:1024 sc1
    ds_read_b128 a[52:55], v18 offset:34816
    s_waitcnt lgkmcnt(2)
    v_mfma_f32_16x16x32_bf16 v[54:57], a[76:79], a[12:15], v[54:57]
    v_mfma_f32_16x16x32_bf16 v[74:77], a[76:79], a[92:95], v[74:77]
    ds_read_b128 a[56:59], v18 offset:35840
    v_mfma_f32_16x16x32_bf16 v[58:61], v[96:99], a[12:15], v[58:61]
    v_mfma_f32_16x16x32_bf16 v[78:81], v[96:99], a[92:95], v[78:81]
    buffer_load_dwordx4 a[44:47], v3, s[24:27], s76 offen offset:3072 sc1
    ds_read_b128 a[60:63], v18 offset:36864
    v_mfma_f32_16x16x32_bf16 v[62:65], v[100:103], a[12:15], v[62:65]
    v_mfma_f32_16x16x32_bf16 v[82:85], v[100:103], a[92:95], v[82:85]
    ds_read_b128 a[64:67], v18 offset:37888
    v_mov_b32 v10, 82
    ds_write_b32 v26, v10 offset:96
    s_waitcnt vmcnt(17) lgkmcnt(4)
    v_mfma_f32_16x16x32_bf16 v[46:49], a[48:51], a[16:19], v[46:49]
    v_mfma_f32_16x16x32_bf16 v[66:69], a[48:51], a[96:99], v[66:69]
    buffer_load_dwordx4 v[42:45], v2, s[24:27], s76 offen offset:3072 sc1
    ds_read_b32 v12, v27 offset:80
    ds_read_b128 a[68:71], v18 offset:48128
    v_mfma_f32_16x16x32_bf16 v[50:53], a[52:55], a[16:19], v[50:53]
    v_mfma_f32_16x16x32_bf16 v[70:73], a[52:55], a[96:99], v[70:73]
    ds_read_b128 a[72:75], v18 offset:49152
    s_waitcnt lgkmcnt(4)
    v_mfma_f32_16x16x32_bf16 v[54:57], a[56:59], a[16:19], v[54:57]
    v_mfma_f32_16x16x32_bf16 v[74:77], a[56:59], a[96:99], v[74:77]
    s_add_u32 s76, s71, 24576
    buffer_load_dwordx4 a[0:3], v3, s[24:27], s76 offen offset:1024 sc1
    ds_read_b128 a[76:79], v18 offset:50176
    v_mfma_f32_16x16x32_bf16 v[58:61], a[60:63], a[16:19], v[58:61]
    v_mfma_f32_16x16x32_bf16 v[78:81], a[60:63], a[96:99], v[78:81]
    ds_read_b128 v[96:99], v18 offset:51200
    v_mfma_f32_16x16x32_bf16 v[62:65], a[64:67], a[16:19], v[62:65]
    v_mfma_f32_16x16x32_bf16 v[82:85], a[64:67], a[96:99], v[82:85]
    ds_read_b128 v[100:103], v18 offset:52224
    buffer_load_dwordx4 a[80:83], v2, s[24:27], s76 offen offset:1024 sc1
    s_waitcnt vmcnt(14)
    s_cmp_eq_u32 s49, 0
    s_cbranch_scc1 L_sl_180
    s_lshl_b32 s45, s36, 5
    s_add_u32 s45, s45, s56
    s_add_u32 s45, s45, 131072
    s_mov_b64 exec, 1
    buffer_store_dwordx2 v[16:17], v11, s[24:27], s45 offen offset:8
    s_mov_b64 exec, -1
    s_branch L_dn_181
L_sl_180:
    s_lshl_b32 s45, s36, 5
    s_add_u32 s45, s45, s56
    s_add_u32 s45, s45, 131072
    s_mov_b64 exec, 1
    buffer_store_dwordx2 v[16:17], v11, s[24:27], s45 offen offset:8 sc1
    s_mov_b64 exec, -1
L_dn_181:
    ds_read_b32 v12, v27 offset:80
    s_waitcnt lgkmcnt(0)
    v_cmp_gt_u32 vcc, 64, v12
    s_cbranch_vccnz L_cw_182
L_cn_183:
    v_mfma_f32_16x16x32_bf16 v[46:49], a[68:71], a[20:23], v[46:49]
    buffer_load_dwordx4 a[4:7], v3, s[24:27], s76 offen offset:3072 sc1
    v_mfma_f32_16x16x32_bf16 v[66:69], a[68:71], a[100:103], v[66:69]
    ds_read_b128 a[48:51], v19 offset:21504
    v_mfma_f32_16x16x32_bf16 v[50:53], a[72:75], a[20:23], v[50:53]
    v_mfma_f32_16x16x32_bf16 v[70:73], a[72:75], a[100:103], v[70:73]
    ds_read_b128 a[52:55], v19 offset:22528
    v_mfma_f32_16x16x32_bf16 v[54:57], a[76:79], a[20:23], v[54:57]
    v_mfma_f32_16x16x32_bf16 v[74:77], a[76:79], a[100:103], v[74:77]
    buffer_load_dwordx4 a[84:87], v2, s[24:27], s76 offen offset:3072 sc1
    ds_read_b128 a[56:59], v19 offset:23552
    v_mfma_f32_16x16x32_bf16 v[58:61], v[96:99], a[20:23], v[58:61]
    v_mfma_f32_16x16x32_bf16 v[78:81], v[96:99], a[100:103], v[78:81]
    ds_read_b128 a[60:63], v19 offset:24576
    v_mfma_f32_16x16x32_bf16 v[62:65], v[100:103], a[20:23], v[62:65]
    v_mfma_f32_16x16x32_bf16 v[82:85], v[100:103], a[100:103], v[82:85]
    ds_read_b128 a[64:67], v19 offset:25600
    s_mov_b32 s45, 196608
    s_mov_b64 exec, 0xffff
    buffer_load_dwordx2 v[14:15], v25, s[24:27], s45 offen offset:8 sc1
    s_mov_b64 exec, -1
    v_mov_b32 v10, 87
    ds_write_b32 v26, v10 offset:96
    s_waitcnt vmcnt(16) lgkmcnt(4)
    v_mfma_f32_16x16x32_bf16 v[46:49], a[48:51], a[24:27], v[46:49]
    s_add_u32 s76, s71, 28672
    buffer_load_dwordx4 a[8:11], v3, s[24:27], s76 offen offset:1024 sc1
    v_mfma_f32_16x16x32_bf16 v[66:69], a[48:51], a[104:107], v[66:69]
    ds_read_b32 v12, v27 offset:80
    ds_read_b128 a[68:71], v3 offset:56320
    v_mfma_f32_16x16x32_bf16 v[50:53], a[52:55], a[24:27], v[50:53]
    v_mfma_f32_16x16x32_bf16 v[70:73], a[52:55], a[104:107], v[70:73]
    ds_read_b128 a[72:75], v3 offset:57344
    s_waitcnt lgkmcnt(4)
    v_mfma_f32_16x16x32_bf16 v[54:57], a[56:59], a[24:27], v[54:57]
    v_mfma_f32_16x16x32_bf16 v[74:77], a[56:59], a[104:107], v[74:77]
    buffer_load_dwordx4 a[88:91], v2, s[24:27], s76 offen offset:1024 sc1
    ds_read_b128 a[76:79], v3 offset:58368
    v_mfma_f32_16x16x32_bf16 v[58:61], a[60:63], a[24:27], v[58:61]
    v_mfma_f32_16x16x32_bf16 v[78:81], a[60:63], a[104:107], v[78:81]
    ds_read_b128 v[96:99], v3 offset:59392
    v_mfma_f32_16x16x32_bf16 v[62:65], a[64:67], a[24:27], v[62:65]
    v_mfma_f32_16x16x32_bf16 v[82:85], a[64:67], a[104:107], v[82:85]
    s_waitcnt lgkmcnt(4)
    buffer_load_dwordx4 a[12:15], v3, s[24:27], s76 offen offset:3072 sc1
    v_cmp_gt_u32 vcc, 69, v12
    ds_read_b128 v[100:103], v3 offset:60416
    s_cbranch_vccnz L_cw_185
L_cn_186:
    s_waitcnt vmcnt(17) lgkmcnt(3)
    v_mfma_f32_16x16x32_bf16 v[46:49], a[68:71], a[28:31], v[46:49]
    v_mfma_f32_16x16x32_bf16 v[66:69], a[68:71], v[20:23], v[66:69]
    ds_read_b128 a[48:51], v18 offset:1024
    v_mfma_f32_16x16x32_bf16 v[50:53], a[72:75], a[28:31], v[50:53]
    v_mfma_f32_16x16x32_bf16 v[70:73], a[72:75], v[20:23], v[70:73]
    buffer_load_dwordx4 a[92:95], v2, s[24:27], s76 offen offset:3072 sc1
    ds_read_b128 a[52:55], v18 offset:2048
    s_waitcnt lgkmcnt(2)
    v_mfma_f32_16x16x32_bf16 v[54:57], a[76:79], a[28:31], v[54:57]
    v_mfma_f32_16x16x32_bf16 v[74:77], a[76:79], v[20:23], v[74:77]
    ds_read_b128 a[56:59], v18 offset:3072
    v_mfma_f32_16x16x32_bf16 v[58:61], v[96:99], a[28:31], v[58:61]
    v_mfma_f32_16x16x32_bf16 v[78:81], v[96:99], v[20:23], v[78:81]
    ds_read_b128 a[60:63], v18 offset:4096
    v_mfma_f32_16x16x32_bf16 v[62:65], v[100:103], a[28:31], v[62:65]
    v_mfma_f32_16x16x32_bf16 v[82:85], v[100:103], v[20:23], v[82:85]
    ds_read_b128 a[64:67], v18 offset:5120
    v_mov_b32 v10, 92
    ds_write_b32 v26, v10 offset:96
    s_waitcnt vmcnt(16) lgkmcnt(4)
    v_mfma_f32_16x16x32_bf16 v[46:49], a[48:51], a[32:35], v[46:49]
    v_mfma_f32_16x16x32_bf16 v[66:69], a[48:51], v[28:31], v[66:69]
    ds_read_b32 v12, v27 offset:80
    ds_read_b128 a[68:71], v18 offset:11264
    v_mfma_f32_16x16x32_bf16 v[50:53], a[52:55], a[32:35], v[50:53]
    v_mfma_f32_16x16x32_bf16 v[70:73], a[52:55], v[28:31], v[70:73]
    ds_read_b128 a[72:75], v18 offset:12288
    s_waitcnt lgkmcnt(4)
    v_mfma_f32_16x16x32_bf16 v[54:57], a[56:59], a[32:35], v[54:57]
    v_mfma_f32_16x16x32_bf16 v[74:77], a[56:59], v[28:31], v[74:77]
    ds_read_b128 a[76:79], v18 offset:13312
    v_mfma_f32_16x16x32_bf16 v[58:61], a[60:63], a[32:35], v[58:61]
    v_mfma_f32_16x16x32_bf16 v[78:81], a[60:63], v[28:31], v[78:81]
    ds_read_b128 v[96:99], v18 offset:14336
    v_mfma_f32_16x16x32_bf16 v[62:65], a[64:67], a[32:35], v[62:65]
    v_mfma_f32_16x16x32_bf16 v[82:85], a[64:67], v[28:31], v[82:85]
    s_waitcnt lgkmcnt(4)
    v_cmp_gt_u32 vcc, 74, v12
    ds_read_b128 v[100:103], v18 offset:15360
    s_cbranch_vccnz L_cw_188
L_cn_189:
    s_waitcnt vmcnt(14) lgkmcnt(3)
    v_mfma_f32_16x16x32_bf16 v[46:49], a[68:71], a[36:39], v[46:49]
    v_mfma_f32_16x16x32_bf16 v[66:69], a[68:71], v[32:35], v[66:69]
    ds_read_b128 a[48:51], v18 offset:21504
    v_mfma_f32_16x16x32_bf16 v[50:53], a[72:75], a[36:39], v[50:53]
    v_mfma_f32_16x16x32_bf16 v[70:73], a[72:75], v[32:35], v[70:73]
    ds_read_b128 a[52:55], v18 offset:22528
    s_waitcnt lgkmcnt(2)
    v_mfma_f32_16x16x32_bf16 v[54:57], a[76:79], a[36:39], v[54:57]
    v_mfma_f32_16x16x32_bf16 v[74:77], a[76:79], v[32:35], v[74:77]
    ds_read_b128 a[56:59], v18 offset:23552
    v_mfma_f32_16x16x32_bf16 v[58:61], v[96:99], a[36:39], v[58:61]
    v_mfma_f32_16x16x32_bf16 v[78:81], v[96:99], v[32:35], v[78:81]
    ds_read_b128 a[60:63], v18 offset:24576
    v_mfma_f32_16x16x32_bf16 v[62:65], v[100:103], a[36:39], v[62:65]
    v_mfma_f32_16x16x32_bf16 v[82:85], v[100:103], v[32:35], v[82:85]
    ds_read_b128 a[64:67], v18 offset:25600
    v_mov_b32 v10, 97
    ds_write_b32 v26, v10 offset:96
    s_waitcnt vmcnt(12) lgkmcnt(4)
    v_mfma_f32_16x16x32_bf16 v[46:49], a[48:51], a[40:43], v[46:49]
    v_mfma_f32_16x16x32_bf16 v[66:69], a[48:51], v[38:41], v[66:69]
    ds_read_b32 v12, v27 offset:80
    ds_read_b128 a[68:71], v18 offset:44032
    v_mfma_f32_16x16x32_bf16 v[50:53], a[52:55], a[40:43], v[50:53]
    v_mfma_f32_16x16x32_bf16 v[70:73], a[52:55], v[38:41], v[70:73]
    ds_read_b128 a[72:75], v18 offset:57344
    s_waitcnt lgkmcnt(4)
    v_mfma_f32_16x16x32_bf16 v[54:57], a[56:59], a[40:43], v[54:57]
    v_mfma_f32_16x16x32_bf16 v[74:77], a[56:59], v[38:41], v[74:77]
    ds_read_b128 a[76:79], v18 offset:58368
    v_mfma_f32_16x16x32_bf16 v[58:61], a[60:63], a[40:43], v[58:61]
    v_mfma_f32_16x16x32_bf16 v[78:81], a[60:63], v[38:41], v[78:81]
    ds_read_b128 v[96:99], v18 offset:59392
    v_mfma_f32_16x16x32_bf16 v[62:65], a[64:67], a[40:43], v[62:65]
    v_mfma_f32_16x16x32_bf16 v[82:85], a[64:67], v[38:41], v[82:85]
    s_waitcnt lgkmcnt(4)
    v_cmp_gt_u32 vcc, 79, v12
    ds_read_b128 v[100:103], v18 offset:60416
    s_cbranch_vccnz L_cw_191
L_cn_192:
    s_waitcnt vmcnt(10) lgkmcnt(3)
    v_mfma_f32_16x16x32_bf16 v[46:49], a[68:71], a[44:47], v[46:49]
    v_mfma_f32_16x16x32_bf16 v[66:69], a[68:71], v[42:45], v[66:69]
    ds_read_b128 a[48:51], v3 offset:5120
    v_mfma_f32_16x16x32_bf16 v[50:53], a[72:75], a[44:47], v[50:53]
    v_mfma_f32_16x16x32_bf16 v[70:73], a[72:75], v[42:45], v[70:73]
    ds_read_b128 a[52:55], v3 offset:6144
    s_waitcnt lgkmcnt(2)
    v_mfma_f32_16x16x32_bf16 v[54:57], a[76:79], a[44:47], v[54:57]
    v_mfma_f32_16x16x32_bf16 v[74:77], a[76:79], v[42:45], v[74:77]
    ds_read_b128 a[56:59], v3 offset:7168
    v_mfma_f32_16x16x32_bf16 v[58:61], v[96:99], a[44:47], v[58:61]
    v_mfma_f32_16x16x32_bf16 v[78:81], v[96:99], v[42:45], v[78:81]
    ds_read_b128 a[60:63], v3 offset:8192
    v_mfma_f32_16x16x32_bf16 v[62:65], v[100:103], a[44:47], v[62:65]
    v_mfma_f32_16x16x32_bf16 v[82:85], v[100:103], v[42:45], v[82:85]
    ds_read_b128 a[64:67], v3 offset:9216
    v_mov_b32 v10, 102
    ds_write_b32 v26, v10 offset:96
    s_waitcnt vmcnt(8) lgkmcnt(4)
    v_mfma_f32_16x16x32_bf16 v[46:49], a[48:51], a[0:3], v[46:49]
    v_mfma_f32_16x16x32_bf16 v[66:69], a[48:51], a[80:83], v[66:69]
    ds_read_b32 v12, v27 offset:80
    ds_read_b128 a[68:71], v3 offset:15360
    v_mfma_f32_16x16x32_bf16 v[50:53], a[52:55], a[0:3], v[50:53]
    v_mfma_f32_16x16x32_bf16 v[70:73], a[52:55], a[80:83], v[70:73]
    ds_read_b128 a[72:75], v3 offset:16384
    s_waitcnt lgkmcnt(4)
    v_mfma_f32_16x16x32_bf16 v[54:57], a[56:59], a[0:3], v[54:57]
    v_mfma_f32_16x16x32_bf16 v[74:77], a[56:59], a[80:83], v[74:77]
    ds_read_b128 a[76:79], v3 offset:17408
    v_mfma_f32_16x16x32_bf16 v[58:61], a[60:63], a[0:3], v[58:61]
    v_mfma_f32_16x16x32_bf16 v[78:81], a[60:63], a[80:83], v[78:81]
    ds_read_b128 v[96:99], v3 offset:18432
    v_mfma_f32_16x16x32_bf16 v[62:65], a[64:67], a[0:3], v[62:65]
    v_mfma_f32_16x16x32_bf16 v[82:85], a[64:67], a[80:83], v[82:85]
    s_waitcnt lgkmcnt(4)
    v_cmp_gt_u32 vcc, 84, v12
    ds_read_b128 v[100:103], v3 offset:19456
    s_cbranch_vccnz L_cw_194
L_cn_195:
    s_waitcnt vmcnt(5) lgkmcnt(3)
    v_mfma_f32_16x16x32_bf16 v[46:49], a[68:71], a[4:7], v[46:49]
    v_mfma_f32_16x16x32_bf16 v[66:69], a[68:71], a[84:87], v[66:69]
    ds_read_b128 a[48:51], v3 offset:25600
    v_mfma_f32_16x16x32_bf16 v[50:53], a[72:75], a[4:7], v[50:53]
    v_mfma_f32_16x16x32_bf16 v[70:73], a[72:75], a[84:87], v[70:73]
    ds_read_b128 a[52:55], v3 offset:26624
    s_waitcnt lgkmcnt(2)
    v_mfma_f32_16x16x32_bf16 v[54:57], a[76:79], a[4:7], v[54:57]
    v_mfma_f32_16x16x32_bf16 v[74:77], a[76:79], a[84:87], v[74:77]
    ds_read_b128 a[56:59], v3 offset:27648
    v_mfma_f32_16x16x32_bf16 v[58:61], v[96:99], a[4:7], v[58:61]
    v_mfma_f32_16x16x32_bf16 v[78:81], v[96:99], a[84:87], v[78:81]
    ds_read_b128 a[60:63], v3 offset:28672
    v_mfma_f32_16x16x32_bf16 v[62:65], v[100:103], a[4:7], v[62:65]
    v_mfma_f32_16x16x32_bf16 v[82:85], v[100:103], a[84:87], v[82:85]
    ds_read_b128 a[64:67], v3 offset:29696
    v_mov_b32 v10, 107
    ds_write_b32 v26, v10 offset:96
    s_waitcnt vmcnt(2) lgkmcnt(4)
    s_mov_b64 exec, 0xffff
    s_mov_b32 s48, 200000
    s_mov_b32 s45, 196608
    s_branch L_pc_199
L_pt_197:
    buffer_load_dwordx2 v[14:15], v25, s[24:27], s45 offen offset:8 sc1
    s_waitcnt vmcnt(0)
L_pc_199:
    v_cmp_ne_u64_e64 vcc, s[32:33], v[14:15]
    s_cbranch_vccz L_pn_198
    s_mov_b64 exec, vcc
    s_sub_u32 s48, s48, 1
    s_cmp_lg_u32 s48, 0
    s_cbranch_scc1 L_pt_197
L_pn_198:
    s_mov_b64 exec, -1
    v_mfma_f32_16x16x32_bf16 v[46:49], a[48:51], a[8:11], v[46:49]
    s_add_u32 s76, s71, 32768
    buffer_load_dwordx4 a[16:19], v3, s[24:27], s76 offen offset:1024 sc1
    v_mfma_f32_16x16x32_bf16 v[66:69], a[48:51], a[88:91], v[66:69]
    ds_read_b32 v12, v27 offset:80
    ds_read_b128 a[68:71], v3 offset:35840
    v_mfma_f32_16x16x32_bf16 v[50:53], a[52:55], a[8:11], v[50:53]
    v_mfma_f32_16x16x32_bf16 v[70:73], a[52:55], a[88:91], v[70:73]
    ds_read_b128 a[72:75], v3 offset:36864
    s_waitcnt lgkmcnt(4)
    v_mfma_f32_16x16x32_bf16 v[54:57], a[56:59], a[8:11], v[54:57]
    v_mfma_f32_16x16x32_bf16 v[74:77], a[56:59], a[88:91], v[74:77]
    buffer_load_dwordx4 a[96:99], v2, s[24:27], s76 offen offset:1024 sc1
    ds_read_b128 a[76:79], v3 offset:37888
    v_mfma_f32_16x16x32_bf16 v[58:61], a[60:63], a[8:11], v[58:61]
    v_mfma_f32_16x16x32_bf16 v[78:81], a[60:63], a[88:91], v[78:81]
    ds_read_b128 v[96:99], v3 offset:38912
    v_mfma_f32_16x16x32_bf16 v[62:65], a[64:67], a[8:11], v[62:65]
    v_mfma_f32_16x16x32_bf16 v[82:85], a[64:67], a[88:91], v[82:85]
    s_waitcnt lgkmcnt(4)
    buffer_load_dwordx4 a[20:23], v3, s[24:27], s76 offen offset:3072 sc1
    v_cmp_gt_u32 vcc, 89, v12
    ds_read_b128 v[100:103], v3 offset:39936
    s_cbranch_vccnz L_cw_200
L_cn_201:
    s_waitcnt vmcnt(3) lgkmcnt(3)
    v_mfma_f32_16x16x32_bf16 v[46:49], a[68:71], a[12:15], v[46:49]
    v_mfma_f32_16x16x32_bf16 v[66:69], a[68:71], a[92:95], v[66:69]
    ds_read_b128 a[48:51], v19 offset:1024
    v_mfma_f32_16x16x32_bf16 v[50:53], a[72:75], a[12:15], v[50:53]
    v_mfma_f32_16x16x32_bf16 v[70:73], a[72:75], a[92:95], v[70:73]
    buffer_load_dwordx4 a[100:103], v2, s[24:27], s76 offen offset:3072 sc1
    ds_read_b128 a[52:55], v19 offset:2048
    s_waitcnt lgkmcnt(2)
    v_mfma_f32_16x16x32_bf16 v[54:57], a[76:79], a[12:15], v[54:57]
    v_mfma_f32_16x16x32_bf16 v[74:77], a[76:79], a[92:95], v[74:77]
    ds_read_b128 a[56:59], v19 offset:3072
    v_mfma_f32_16x16x32_bf16 v[58:61], v[96:99], a[12:15], v[58:61]
    v_mfma_f32_16x16x32_bf16 v[78:81], v[96:99], a[92:95], v[78:81]
    s_add_u32 s76, s71, 36864
    buffer_load_dwordx4 a[24:27], v3, s[24:27], s76 offen offset:1024 sc1
    ds_read_b128 a[60:63], v19 offset:4096
    v_mfma_f32_16x16x32_bf16 v[62:65], v[100:103], a[12:15], v[62:65]
    v_mfma_f32_16x16x32_bf16 v[82:85], v[100:103], a[92:95], v[82:85]
    ds_read_b128 a[64:67], v19 offset:5120
    v_mov_b32 v10, 109
    ds_write_b32 v26, v10 offset:96
    s_waitcnt vmcnt(3) lgkmcnt(4)
    v_mfma_f32_16x16x32_bf16 v[46:49], a[48:51], a[16:19], v[46:49]
    v_mfma_f32_16x16x32_bf16 v[66:69], a[48:51], a[96:99], v[66:69]
    buffer_load_dwordx4 a[104:107], v2, s[24:27], s76 offen offset:1024 sc1
    ds_read_b32 v12, v27 offset:80
    ds_read_b128 a[68:71], v19 offset:11264
    v_mfma_f32_16x16x32_bf16 v[50:53], a[52:55], a[16:19], v[50:53]
    v_mfma_f32_16x16x32_bf16 v[70:73], a[52:55], a[96:99], v[70:73]
    ds_read_b128 a[72:75], v19 offset:12288
    s_waitcnt lgkmcnt(4)
    v_mfma_f32_16x16x32_bf16 v[54:57], a[56:59], a[16:19], v[54:57]
    v_mfma_f32_16x16x32_bf16 v[74:77], a[56:59], a[96:99], v[74:77]
    buffer_load_dwordx4 a[28:31], v3, s[24:27], s76 offen offset:3072 sc1
    ds_read_b128 a[76:79], v19 offset:13312
    v_mfma_f32_16x16x32_bf16 v[58:61], a[60:63], a[16:19], v[58:61]
    v_mfma_f32_16x16x32_bf16 v[78:81], a[60:63], a[96:99], v[78:81]
    ds_read_b128 v[96:99], v19 offset:14336
    v_mfma_f32_16x16x32_bf16 v[62:65], a[64:67], a[16:19], v[62:65]
    v_mfma_f32_16x16x32_bf16 v[82:85], a[64:67], a[96:99], v[82:85]
    s_waitcnt lgkmcnt(4)
    buffer_load_dwordx4 v[20:23], v2, s[24:27], s76 offen offset:3072 sc1
    v_cmp_gt_u32 vcc, 94, v12
    ds_read_b128 v[100:103], v19 offset:15360
    s_cbranch_vccnz L_cw_203
L_cn_204:
    s_waitcnt vmcnt(4) lgkmcnt(3)
    v_mfma_f32_16x16x32_bf16 v[46:49], a[68:71], a[20:23], v[46:49]
    v_mfma_f32_16x16x32_bf16 v[66:69], a[68:71], a[100:103], v[66:69]
    ds_read_b128 a[48:51], v3 offset:41984
    v_mfma_f32_16x16x32_bf16 v[50:53], a[72:75], a[20:23], v[50:53]
    v_mfma_f32_16x16x32_bf16 v[70:73], a[72:75], a[100:103], v[70:73]
    s_add_u32 s76, s71, 40960
    buffer_load_dwordx4 a[32:35], v3, s[24:27], s76 offen offset:1024 sc1
    ds_read_b128 a[52:55], v3 offset:43008
    s_waitcnt lgkmcnt(2)
    v_mfma_f32_16x16x32_bf16 v[54:57], a[76:79], a[20:23], v[54:57]
    v_mfma_f32_16x16x32_bf16 v[74:77], a[76:79], a[100:103], v[74:77]
    ds_read_b128 a[56:59], v3 offset:44032
    v_mfma_f32_16x16x32_bf16 v[58:61], v[96:99], a[20:23], v[58:61]
    v_mfma_f32_16x16x32_bf16 v[78:81], v[96:99], a[100:103], v[78:81]
    buffer_load_dwordx4 v[28:31], v2, s[24:27], s76 offen offset:1024 sc1
    ds_read_b128 a[60:63], v3 offset:45056
    v_mfma_f32_16x16x32_bf16 v[62:65], v[100:103], a[20:23], v[62:65]
    v_mfma_f32_16x16x32_bf16 v[82:85], v[100:103], a[100:103], v[82:85]
    ds_read_b128 a[64:67], v3 offset:46080
    s_waitcnt vmcnt(4) lgkmcnt(3)
    v_mfma_f32_16x16x32_bf16 v[46:49], a[48:51], a[24:27], v[46:49]
    v_mfma_f32_16x16x32_bf16 v[66:69], a[48:51], a[104:107], v[66:69]
    ds_read_b32 v12, v27 offset:80
    buffer_load_dwordx4 a[36:39], v3, s[24:27], s76 offen offset:3072 sc1
    ds_read_b128 a[68:71], v3 offset:52224
    v_mfma_f32_16x16x32_bf16 v[50:53], a[52:55], a[24:27], v[50:53]
    v_mfma_f32_16x16x32_bf16 v[70:73], a[52:55], a[104:107], v[70:73]
    ds_read_b128 a[72:75], v18 offset:28672
    s_waitcnt lgkmcnt(3)
    v_mfma_f32_16x16x32_bf16 v[54:57], a[56:59], a[24:27], v[54:57]
    v_mfma_f32_16x16x32_bf16 v[74:77], a[56:59], a[104:107], v[74:77]
    ds_read_b128 a[76:79], v18 offset:29696
    buffer_load_dwordx4 v[32:35], v2, s[24:27], s76 offen offset:3072 sc1
    v_mfma_f32_16x16x32_bf16 v[58:61], a[60:63], a[24:27], v[58:61]
    v_mfma_f32_16x16x32_bf16 v[78:81], a[60:63], a[104:107], v[78:81]
    ds_read_b128 v[96:99], v18 offset:30720
    v_mfma_f32_16x16x32_bf16 v[62:65], a[64:67], a[24:27], v[62:65]
    v_mfma_f32_16x16x32_bf16 v[82:85], a[64:67], a[104:107], v[82:85]
    s_waitcnt lgkmcnt(4)
    v_cmp_gt_u32 vcc, 99, v12
    s_add_u32 s76, s71, 45056
    buffer_load_dwordx4 a[40:43], v3, s[24:27], s76 offen offset:1024 sc1
    ds_read_b128 v[100:103], v18 offset:31744
    s_cbranch_vccnz L_cw_206
L_cn_207:
    s_waitcnt vmcnt(5) lgkmcnt(3)
    v_mfma_f32_16x16x32_bf16 v[46:49], a[68:71], a[28:31], v[46:49]
    v_mfma_f32_16x16x32_bf16 v[66:69], a[68:71], v[20:23], v[66:69]
    ds_read_b128 a[48:51], v18 offset:37888
    v_mfma_f32_16x16x32_bf16 v[50:53], a[72:75], a[28:31], v[50:53]
    v_mfma_f32_16x16x32_bf16 v[70:73], a[72:75], v[20:23], v[70:73]
    buffer_load_dwordx4 v[38:41], v2, s[24:27], s76 offen offset:1024 sc1
    ds_read_b128 a[52:55], v18 offset:38912
    s_waitcnt lgkmcnt(2)
    v_mfma_f32_16x16x32_bf16 v[54:57], a[76:79], a[28:31], v[54:57]
    v_mfma_f32_16x16x32_bf16 v[74:77], a[76:79], v[20:23], v[74:77]
    ds_read_b128 a[56:59], v18 offset:39936
    v_mfma_f32_16x16x32_bf16 v[58:61], v[96:99], a[28:31], v[58:61]
    v_mfma_f32_16x16x32_bf16 v[78:81], v[96:99], v[20:23], v[78:81]
    buffer_load_dwordx4 a[44:47], v3, s[24:27], s76 offen offset:3072 sc1
    ds_read_b128 a[60:63], v18 offset:45056
    v_mfma_f32_16x16x32_bf16 v[62:65], v[100:103], a[28:31], v[62:65]
    v_mfma_f32_16x16x32_bf16 v[82:85], v[100:103], v[20:23], v[82:85]
    ds_read_b128 a[64:67], v18 offset:46080
    buffer_load_dwordx4 v[86:89], v3, s[24:27], s84 offen sc1
    s_add_u32 s38, s84, 8192
    buffer_load_dwordx4 v[90:93], v3, s[24:27], s38 offen sc1
    buffer_load_dwordx2 v[94:95], v5, s[24:27], s85 offen sc1
    s_waitcnt vmcnt(8) lgkmcnt(3)
    v_mfma_f32_16x16x32_bf16 v[46:49], a[48:51], a[32:35], v[46:49]
    v_mfma_f32_16x16x32_bf16 v[66:69], a[48:51], v[28:31], v[66:69]
    buffer_load_dwordx4 v[42:45], v2, s[24:27], s76 offen offset:3072 sc1
    ds_read_b32 v12, v27 offset:80
    ds_read_b128 a[68:71], v18 offset:52224
    v_mfma_f32_16x16x32_bf16 v[50:53], a[52:55], a[32:35], v[50:53]
    v_mfma_f32_16x16x32_bf16 v[70:73], a[52:55], v[28:31], v[70:73]
    ds_read_b128 a[72:75], v18 offset:53248
    s_waitcnt lgkmcnt(3)
    v_mfma_f32_16x16x32_bf16 v[54:57], a[56:59], a[32:35], v[54:57]
    v_mfma_f32_16x16x32_bf16 v[74:77], a[56:59], v[28:31], v[74:77]
    s_add_u32 s76, s71, 49152
    buffer_load_dwordx2 a[0:1], v5, s[24:27], s76 offen offset:1024 sc1
    ds_read_b128 a[76:79], v18 offset:54272
    v_mfma_f32_16x16x32_bf16 v[58:61], a[60:63], a[32:35], v[58:61]
    v_mfma_f32_16x16x32_bf16 v[78:81], a[60:63], v[28:31], v[78:81]
    ds_read_b128 v[96:99], v18 offset:55296
    buffer_load_dwordx2 a[2:3], v5, s[24:27], s76 offen offset:1536 sc1
    v_mfma_f32_16x16x32_bf16 v[62:65], a[64:67], a[32:35], v[62:65]
    v_mfma_f32_16x16x32_bf16 v[82:85], a[64:67], v[28:31], v[82:85]
    s_waitcnt lgkmcnt(4)
    v_cmp_gt_u32 vcc, 104, v12
    buffer_load_dwordx2 a[80:81], v4, s[24:27], s76 offen offset:1024 sc1
    ds_read_b128 v[100:103], v18 offset:56320
    s_cbranch_vccnz L_cw_209
L_cn_210:
    s_waitcnt vmcnt(10) lgkmcnt(3)
    v_mfma_f32_16x16x32_bf16 v[46:49], a[68:71], a[36:39], v[46:49]
    v_mfma_f32_16x16x32_bf16 v[66:69], a[68:71], v[32:35], v[66:69]
    buffer_load_dwordx2 a[82:83], v4, s[24:27], s76 offen offset:1536 sc1
    ds_read_b128 a[48:51], v19 offset:25600
    v_mfma_f32_16x16x32_bf16 v[50:53], a[72:75], a[36:39], v[50:53]
    v_mfma_f32_16x16x32_bf16 v[70:73], a[72:75], v[32:35], v[70:73]
    ds_read_b128 a[52:55], v19 offset:26624
    buffer_load_dwordx2 a[4:5], v5, s[24:27], s76 offen offset:3072 sc1
    s_waitcnt lgkmcnt(2)
    v_mfma_f32_16x16x32_bf16 v[54:57], a[76:79], a[36:39], v[54:57]
    v_mfma_f32_16x16x32_bf16 v[74:77], a[76:79], v[32:35], v[74:77]
    ds_read_b128 a[56:59], v19 offset:27648
    buffer_load_dwordx2 a[6:7], v5, s[24:27], s76 offen offset:3584 sc1
    v_mfma_f32_16x16x32_bf16 v[58:61], v[96:99], a[36:39], v[58:61]
    v_mfma_f32_16x16x32_bf16 v[78:81], v[96:99], v[32:35], v[78:81]
    ds_read_b128 a[60:63], v3 offset:53248
    v_mfma_f32_16x16x32_bf16 v[62:65], v[100:103], a[36:39], v[62:65]
    buffer_load_dwordx2 a[84:85], v4, s[24:27], s76 offen offset:3072 sc1
    v_mfma_f32_16x16x32_bf16 v[82:85], v[100:103], v[32:35], v[82:85]
    ds_read_b128 a[64:67], v3 offset:54272
    s_waitcnt vmcnt(12) lgkmcnt(3)
    v_mfma_f32_16x16x32_bf16 v[46:49], a[48:51], a[40:43], v[46:49]
    v_mfma_f32_16x16x32_bf16 v[66:69], a[48:51], v[38:41], v[66:69]
    buffer_load_dwordx2 a[86:87], v4, s[24:27], s76 offen offset:3584 sc1
    ds_read_b32 v12, v27 offset:80
    ds_read_b128 a[68:71], v3 offset:60416
    v_mfma_f32_16x16x32_bf16 v[50:53], a[52:55], a[40:43], v[50:53]
    v_mfma_f32_16x16x32_bf16 v[70:73], a[52:55], v[38:41], v[70:73]
    s_add_u32 s76, s71, 53248
    buffer_load_dwordx2 a[8:9], v5, s[24:27], s76 offen offset:1024 sc1
    ds_read_b128 a[72:75], v3 offset:61440
    s_waitcnt lgkmcnt(3)
    v_mfma_f32_16x16x32_bf16 v[54:57], a[56:59], a[40:43], v[54:57]
    v_mfma_f32_16x16x32_bf16 v[74:77], a[56:59], v[38:41], v[74:77]
    buffer_load_dwordx2 a[10:11], v5, s[24:27], s76 offen offset:1536 sc1
    ds_read_b128 a[76:79], v3 offset:62464
    v_mfma_f32_16x16x32_bf16 v[58:61], a[60:63], a[40:43], v[58:61]
    v_mfma_f32_16x16x32_bf16 v[78:81], a[60:63], v[38:41], v[78:81]
    ds_read_b128 v[96:99], v3 offset:63488
    buffer_load_dwordx2 a[88:89], v4, s[24:27], s76 offen offset:1024 sc1
    v_mfma_f32_16x16x32_bf16 v[62:65], a[64:67], a[40:43], v[62:65]
    v_mfma_f32_16x16x32_bf16 v[82:85], a[64:67], v[38:41], v[82:85]
    s_waitcnt lgkmcnt(4)
    v_cmp_gt_u32 vcc, 109, v12
    buffer_load_dwordx2 a[90:91], v4, s[24:27], s76 offen offset:1536 sc1
    ds_read_b128 v[100:103], v3 offset:64512
    s_cbranch_vccnz L_cw_212
L_cn_213:
    s_waitcnt vmcnt(12) lgkmcnt(3)
    v_mfma_f32_16x16x32_bf16 v[46:49], a[68:71], a[44:47], v[46:49]
    v_mfma_f32_16x16x32_bf16 v[66:69], a[68:71], v[42:45], v[66:69]
    ds_read_b128 a[48:51], v18 offset:5120
    v_mfma_f32_16x16x32_bf16 v[50:53], a[72:75], a[44:47], v[50:53]
    v_mfma_f32_16x16x32_bf16 v[70:73], a[72:75], v[42:45], v[70:73]
    ds_read_b128 a[52:55], v18 offset:6144
    s_waitcnt lgkmcnt(2)
    v_mfma_f32_16x16x32_bf16 v[54:57], a[76:79], a[44:47], v[54:57]
    v_mfma_f32_16x16x32_bf16 v[74:77], a[76:79], v[42:45], v[74:77]
    ds_read_b128 a[56:59], v18 offset:7168
    v_mfma_f32_16x16x32_bf16 v[58:61], v[96:99], a[44:47], v[58:61]
    v_mfma_f32_16x16x32_bf16 v[78:81], v[96:99], v[42:45], v[78:81]
    ds_read_b128 a[60:63], v18 offset:8192
    v_mfma_f32_16x16x32_bf16 v[62:65], v[100:103], a[44:47], v[62:65]
    v_mfma_f32_16x16x32_bf16 v[82:85], v[100:103], v[42:45], v[82:85]
    ds_read_b128 a[64:67], v18 offset:9216
    s_waitcnt vmcnt(8) lgkmcnt(3)
    v_mfma_f32_16x16x32_bf16 v[46:49], a[48:51], a[0:3], v[46:49]
    v_mfma_f32_16x16x32_bf16 v[66:69], a[48:51], a[80:83], v[66:69]
    ds_read_b32 v12, v27 offset:80
    ds_read_b128 a[68:71], v18 offset:15360
    v_mfma_f32_16x16x32_bf16 v[50:53], a[52:55], a[0:3], v[50:53]
    v_mfma_f32_16x16x32_bf16 v[70:73], a[52:55], a[80:83], v[70:73]
    ds_read_b128 a[72:75], v18 offset:16384
    s_waitcnt lgkmcnt(3)
    v_mfma_f32_16x16x32_bf16 v[54:57], a[56:59], a[0:3], v[54:57]
    v_mfma_f32_16x16x32_bf16 v[74:77], a[56:59], a[80:83], v[74:77]
    ds_read_b128 a[76:79], v18 offset:17408
    v_mfma_f32_16x16x32_bf16 v[58:61], a[60:63], a[0:3], v[58:61]
    v_mfma_f32_16x16x32_bf16 v[78:81], a[60:63], a[80:83], v[78:81]
    ds_read_b128 v[96:99], v18 offset:18432
    v_mfma_f32_16x16x32_bf16 v[62:65], a[64:67], a[0:3], v[62:65]
    v_mfma_f32_16x16x32_bf16 v[82:85], a[64:67], a[80:83], v[82:85]
    s_waitcnt lgkmcnt(4)
    v_cmp_gt_u32 vcc, 112, v12
    ds_read_b128 v[100:103], v18 offset:19456
    s_cbranch_vccnz L_cw_215
L_cn_216:
    s_waitcnt vmcnt(4) lgkmcnt(3)
    v_mfma_f32_16x16x32_bf16 v[46:49], a[68:71], a[4:7], v[46:49]
    v_mfma_f32_16x16x32_bf16 v[66:69], a[68:71], a[84:87], v[66:69]
    ds_read_b128 a[48:51], v18 offset:25600
    v_mfma_f32_16x16x32_bf16 v[50:53], a[72:75], a[4:7], v[50:53]
    v_mfma_f32_16x16x32_bf16 v[70:73], a[72:75], a[84:87], v[70:73]
    ds_read_b128 a[52:55], v18 offset:26624
    s_waitcnt lgkmcnt(2)
    v_mfma_f32_16x16x32_bf16 v[54:57], a[76:79], a[4:7], v[54:57]
    v_mfma_f32_16x16x32_bf16 v[74:77], a[76:79], a[84:87], v[74:77]
    ds_read_b128 a[56:59], v18 offset:27648
    v_mfma_f32_16x16x32_bf16 v[58:61], v[96:99], a[4:7], v[58:61]
    v_mfma_f32_16x16x32_bf16 v[78:81], v[96:99], a[84:87], v[78:81]
    ds_read_b128 a[60:63], v18 offset:40960
    v_mfma_f32_16x16x32_bf16 v[62:65], v[100:103], a[4:7], v[62:65]
    v_mfma_f32_16x16x32_bf16 v[82:85], v[100:103], a[84:87], v[82:85]
    ds_read_b128 a[64:67], v18 offset:41984
    s_waitcnt vmcnt(0) lgkmcnt(3)
    v_mfma_f32_16x16x32_bf16 v[46:49], a[48:51], a[8:11], v[46:49]
    v_mfma_f32_16x16x32_bf16 v[66:69], a[48:51], a[88:91], v[66:69]
    v_mfma_f32_16x16x32_bf16 v[50:53], a[52:55], a[8:11], v[50:53]
    v_mfma_f32_16x16x32_bf16 v[70:73], a[52:55], a[88:91], v[70:73]
    s_waitcnt lgkmcnt(0)
    v_mfma_f32_16x16x32_bf16 v[54:57], a[56:59], a[8:11], v[54:57]
    v_mfma_f32_16x16x32_bf16 v[74:77], a[56:59], a[88:91], v[74:77]
    v_mfma_f32_16x16x32_bf16 v[58:61], a[60:63], a[8:11], v[58:61]
    v_mfma_f32_16x16x32_bf16 v[78:81], a[60:63], a[88:91], v[78:81]
    v_mfma_f32_16x16x32_bf16 v[62:65], a[64:67], a[8:11], v[62:65]
    v_mfma_f32_16x16x32_bf16 v[82:85], a[64:67], a[88:91], v[82:85]
    ds_read_b32 v12, v27 offset:96
    s_waitcnt lgkmcnt(0)
    v_cmp_gt_u32 vcc, 109, v12
    s_cbranch_vccnz L_cw_218
L_cn_219:
    s_mov_b32 s39, 8192
    s_mov_b32 s40, 12288
    s_mov_b32 s41, 0
    s_mov_b32 s42, 4096
    s_cmp_ge_u32 s36, 2
    s_cselect_b32 s39, 24576, s39
    s_cselect_b32 s40, 28672, s40
    s_cselect_b32 s41, 16384, s41
    s_cselect_b32 s42, 20480, s42
    v_add_u32 v96, s39, v3
    v_add_u32 v97, s40, v3
    ds_write_b128 v96, v[46:49]
    ds_write_b128 v96, v[50:53] offset:1024
    ds_write_b128 v96, v[54:57] offset:2048
    ds_write_b128 v96, v[58:61] offset:3072
    ds_write_b128 v97, v[62:65]
    v_mov_b32 v10, 1
    ds_write_b32 v26, v10 offset:224
    v_add_u32 v96, s41, v3
    v_add_u32 v97, s42, v3
    v_xor_b32 v9, 4, v26
    s_mov_b32 s48, 200000
L_xw_221:
    ds_read_b32 v12, v9 offset:224
    s_waitcnt lgkmcnt(0)
    v_cmp_eq_u32 vcc, 0, v12
    s_cbranch_vccz L_xn_222
    s_sub_u32 s48, s48, 1
    s_cmp_lg_u32 s48, 0
    s_cbranch_scc1 L_xw_221
L_xn_222:
    ds_read_b128 v[46:49], v96
    ds_read_b128 v[50:53], v96 offset:1024
    ds_read_b128 v[54:57], v96 offset:2048
    ds_read_b128 v[58:61], v96 offset:3072
    ds_read_b128 v[62:65], v97
    s_waitcnt lgkmcnt(0)
    v_pk_add_f32 v[46:47], v[46:47], v[66:67]
    v_pk_add_f32 v[48:49], v[48:49], v[68:69]
    v_pk_add_f32 v[50:51], v[50:51], v[70:71]
    v_pk_add_f32 v[52:53], v[52:53], v[72:73]
    v_pk_add_f32 v[54:55], v[54:55], v[74:75]
    v_pk_add_f32 v[56:57], v[56:57], v[76:77]
    v_pk_add_f32 v[58:59], v[58:59], v[78:79]
    v_pk_add_f32 v[60:61], v[60:61], v[80:81]
    v_pk_add_f32 v[62:63], v[62:63], v[82:83]
    v_pk_add_f32 v[64:65], v[64:65], v[84:85]
L_p4done:
    v_mul_u32_u24 v106, 1280, v7
    v_lshl_add_u32 v106, v6, 3, v106
    v_lshlrev_b32 v8, 16, v86
    v_and_b32 v9, 0xffff0000, v86
    v_fma_f32 v8, v46, v36, v8
    v_fma_f32 v9, v47, v36, v9
    v_cvt_pk_bf16_f32 v96, v8, v9
    v_lshlrev_b32 v8, 16, v87
    v_and_b32 v9, 0xffff0000, v87
    v_fma_f32 v8, v48, v36, v8
    v_fma_f32 v9, v49, v36, v9
    v_cvt_pk_bf16_f32 v97, v8, v9
    buffer_store_dwordx2 v[96:97], v106, s[72:75], s70 offen
    v_lshlrev_b32 v8, 16, v88
    v_and_b32 v9, 0xffff0000, v88
    v_fma_f32 v8, v50, v36, v8
    v_fma_f32 v9, v51, v36, v9
    v_cvt_pk_bf16_f32 v98, v8, v9
    v_lshlrev_b32 v8, 16, v89
    v_and_b32 v9, 0xffff0000, v89
    v_fma_f32 v8, v52, v36, v8
    v_fma_f32 v9, v53, v36, v9
    v_cvt_pk_bf16_f32 v99, v8, v9
    buffer_store_dwordx2 v[98:99], v106, s[72:75], s70 offen offset:32
    v_lshlrev_b32 v8, 16, v90
    v_and_b32 v9, 0xffff0000, v90
    v_fma_f32 v8, v54, v36, v8
    v_fma_f32 v9, v55, v36, v9
    v_cvt_pk_bf16_f32 v100, v8, v9
    v_lshlrev_b32 v8, 16, v91
    v_and_b32 v9, 0xffff0000, v91
    v_fma_f32 v8, v56, v36, v8
    v_fma_f32 v9, v57, v36, v9
    v_cvt_pk_bf16_f32 v101, v8, v9
    buffer_store_dwordx2 v[100:101], v106, s[72:75], s70 offen offset:64
    v_lshlrev_b32 v8, 16, v92
    v_and_b32 v9, 0xffff0000, v92
    v_fma_f32 v8, v58, v36, v8
    v_fma_f32 v9, v59, v36, v9
    v_cvt_pk_bf16_f32 v102, v8, v9
    v_lshlrev_b32 v8, 16, v93
    v_and_b32 v9, 0xffff0000, v93
    v_fma_f32 v8, v60, v36, v8
    v_fma_f32 v9, v61, v36, v9
    v_cvt_pk_bf16_f32 v103, v8, v9
    buffer_store_dwordx2 v[102:103], v106, s[72:75], s70 offen offset:96
    v_lshlrev_b32 v8, 16, v94
    v_and_b32 v9, 0xffff0000, v94
    v_fma_f32 v8, v62, v36, v8
    v_fma_f32 v9, v63, v36, v9
    v_cvt_pk_bf16_f32 v104, v8, v9
    v_lshlrev_b32 v8, 16, v95
    v_and_b32 v9, 0xffff0000, v95
    v_fma_f32 v8, v64, v36, v8
    v_fma_f32 v9, v65, v36, v9
    v_cvt_pk_bf16_f32 v105, v8, v9
    buffer_store_dwordx2 v[104:105], v106, s[72:75], s70 offen offset:128
    s_or_b32 s38, s2, s36
    s_cmp_lg_u32 s38, 0
    s_cbranch_scc1 L_noep
    s_mov_b64 exec, 1
    buffer_store_dwordx2 v[16:17], v11, s[24:27], 0 offen sc1
    s_mov_b64 exec, -1
L_noep:
    s_endpgm
L_cw_3:
    s_mov_b32 s48, 200000
L_ct_5:
    ds_read_b32 v12, v27 offset:176
    s_waitcnt lgkmcnt(0)
    v_cmp_gt_u32 vcc, 1, v12
    s_cbranch_vccz L_cn_4
    s_sub_u32 s48, s48, 1
    s_cmp_lg_u32 s48, 0
    s_cbranch_scc1 L_ct_5
    s_branch L_cn_4
L_cw_6:
    s_mov_b32 s48, 200000
L_ct_8:
    ds_read_b32 v12, v27 offset:80
    s_waitcnt lgkmcnt(0)
    v_cmp_gt_u32 vcc, 2, v12
    s_cbranch_vccz L_cn_7
    s_sub_u32 s48, s48, 1
    s_cmp_lg_u32 s48, 0
    s_cbranch_scc1 L_ct_8
    s_branch L_cn_7
L_cw_9:
    s_mov_b32 s48, 200000
L_ct_11:
    ds_read_b32 v12, v27 offset:80
    s_waitcnt lgkmcnt(0)
    v_cmp_gt_u32 vcc, 3, v12
    s_cbranch_vccz L_cn_10
    s_sub_u32 s48, s48, 1
    s_cmp_lg_u32 s48, 0
    s_cbranch_scc1 L_ct_11
    s_branch L_cn_10
L_cw_12:
    s_mov_b32 s48, 200000
L_ct_14:
    ds_read_b32 v12, v27 offset:80
    s_waitcnt lgkmcnt(0)
    v_cmp_gt_u32 vcc, 5, v12
    s_cbranch_vccz L_cn_13
    s_sub_u32 s48, s48, 1
    s_cmp_lg_u32 s48, 0
    s_cbranch_scc1 L_ct_14
    s_branch L_cn_13
L_cw_15:
    s_mov_b32 s48, 200000
L_ct_17:
    ds_read_b32 v12, v27 offset:80
    s_waitcnt lgkmcnt(0)
    v_cmp_gt_u32 vcc, 6, v12
    s_cbranch_vccz L_cn_16
    s_sub_u32 s48, s48, 1
    s_cmp_lg_u32 s48, 0
    s_cbranch_scc1 L_ct_17
    s_branch L_cn_16
L_cw_19:
    s_mov_b32 s48, 200000
L_ct_21:
    ds_read_b32 v12, v27 offset:128
    s_waitcnt lgkmcnt(0)
    v_cmp_gt_u32 vcc, 1, v12
    s_cbranch_vccz L_cn_20
    s_sub_u32 s48, s48, 1
    s_cmp_lg_u32 s48, 0
    s_cbranch_scc1 L_ct_21
    s_branch L_cn_20
L_cw_22:
    s_mov_b32 s48, 200000
L_ct_24:
    ds_read_b32 v12, v27 offset:80
    s_waitcnt lgkmcnt(0)
    v_cmp_gt_u32 vcc, 8, v12
    s_cbranch_vccz L_cn_23
    s_sub_u32 s48, s48, 1
    s_cmp_lg_u32 s48, 0
    s_cbranch_scc1 L_ct_24
    s_branch L_cn_23
L_cw_25:
    s_mov_b32 s48, 200000
L_ct_27:
    ds_read_b32 v12, v27 offset:80
    s_waitcnt lgkmcnt(0)
    v_cmp_gt_u32 vcc, 9, v12
    s_cbranch_vccz L_cn_26
    s_sub_u32 s48, s48, 1
    s_cmp_lg_u32 s48, 0
    s_cbranch_scc1 L_ct_27
    s_branch L_cn_26
L_cw_28:
    s_mov_b32 s48, 200000
L_ct_30:
    ds_read_b32 v12, v27 offset:80
    s_waitcnt lgkmcnt(0)
    v_cmp_gt_u32 vcc, 11, v12
    s_cbranch_vccz L_cn_29
    s_sub_u32 s48, s48, 1
    s_cmp_lg_u32 s48, 0
    s_cbranch_scc1 L_ct_30
    s_branch L_cn_29
L_cw_32:
    s_mov_b32 s48, 200000
L_ct_34:
    ds_read_b32 v12, v27 offset:144
    s_waitcnt lgkmcnt(0)
    v_cmp_gt_u32 vcc, 1, v12
    s_cbranch_vccz L_cn_33
    s_sub_u32 s48, s48, 1
    s_cmp_lg_u32 s48, 0
    s_cbranch_scc1 L_ct_34
    s_branch L_cn_33
L_cw_35:
    s_mov_b32 s48, 200000
L_ct_37:
    ds_read_b32 v12, v27 offset:80
    s_waitcnt lgkmcnt(0)
    v_cmp_gt_u32 vcc, 12, v12
    s_cbranch_vccz L_cn_36
    s_sub_u32 s48, s48, 1
    s_cmp_lg_u32 s48, 0
    s_cbranch_scc1 L_ct_37
    s_branch L_cn_36
L_cw_38:
    s_mov_b32 s48, 200000
L_ct_40:
    ds_read_b32 v12, v27 offset:80
    s_waitcnt lgkmcnt(0)
    v_cmp_gt_u32 vcc, 14, v12
    s_cbranch_vccz L_cn_39
    s_sub_u32 s48, s48, 1
    s_cmp_lg_u32 s48, 0
    s_cbranch_scc1 L_ct_40
    s_branch L_cn_39
L_cw_44:
    s_mov_b32 s48, 200000
L_ct_46:
    ds_read_b32 v12, v27 offset:80
    s_waitcnt lgkmcnt(0)
    v_cmp_gt_u32 vcc, 15, v12
    s_cbranch_vccz L_cn_45
    s_sub_u32 s48, s48, 1
    s_cmp_lg_u32 s48, 0
    s_cbranch_scc1 L_ct_46
    s_branch L_cn_45
L_cw_47:
    s_mov_b32 s48, 200000
L_ct_49:
    ds_read_b32 v12, v27
    s_waitcnt lgkmcnt(0)
    v_cmp_gt_u32 vcc, 1, v12
    s_cbranch_vccz L_cn_48
    s_sub_u32 s48, s48, 1
    s_cmp_lg_u32 s48, 0
    s_cbranch_scc1 L_ct_49
    s_branch L_cn_48
L_cw_50:
    s_mov_b32 s48, 200000
L_ct_52:
    ds_read_b32 v12, v27 offset:96
    s_waitcnt lgkmcnt(0)
    v_cmp_gt_u32 vcc, 11, v12
    s_cbranch_vccz L_cn_51
    s_sub_u32 s48, s48, 1
    s_cmp_lg_u32 s48, 0
    s_cbranch_scc1 L_ct_52
    s_branch L_cn_51
L_cw_53:
    s_mov_b32 s48, 200000
L_ct_55:
    ds_read_b32 v12, v27 offset:16
    s_waitcnt lgkmcnt(0)
    v_cmp_gt_u32 vcc, 1, v12
    s_cbranch_vccz L_cn_54
    s_sub_u32 s48, s48, 1
    s_cmp_lg_u32 s48, 0
    s_cbranch_scc1 L_ct_55
    s_branch L_cn_54
L_cw_57:
    s_mov_b32 s48, 200000
L_ct_59:
    ds_read_b32 v12, v27 offset:976
    s_waitcnt lgkmcnt(0)
    v_cmp_gt_u32 vcc, 1, v12
    s_cbranch_vccz L_cn_58
    s_sub_u32 s48, s48, 1
    s_cmp_lg_u32 s48, 0
    s_cbranch_scc1 L_ct_59
    s_branch L_cn_58
L_cw_60:
    s_mov_b32 s48, 200000
L_ct_62:
    ds_read_b32 v12, v27 offset:1008
    s_waitcnt lgkmcnt(0)
    v_cmp_gt_u32 vcc, 1, v12
    s_cbranch_vccz L_cn_61
    s_sub_u32 s48, s48, 1
    s_cmp_lg_u32 s48, 0
    s_cbranch_scc1 L_ct_62
    s_branch L_cn_61
L_cw_63:
    s_mov_b32 s48, 200000
L_ct_65:
    ds_read_b32 v12, v27 offset:32
    s_waitcnt lgkmcnt(0)
    v_cmp_gt_u32 vcc, 1, v12
    s_cbranch_vccz L_cn_64
    s_sub_u32 s48, s48, 1
    s_cmp_lg_u32 s48, 0
    s_cbranch_scc1 L_ct_65
    s_branch L_cn_64
L_cw_66:
    s_mov_b32 s48, 200000
L_ct_68:
    s_sleep 1
    ds_read_b32 v12, v27 offset:48
    s_waitcnt lgkmcnt(0)
    v_cmp_gt_u32 vcc, 1, v12
    s_cbranch_vccz L_cn_67
    s_sub_u32 s48, s48, 1
    s_cmp_lg_u32 s48, 0
    s_cbranch_scc1 L_ct_68
    s_branch L_cn_67
L_cw_69:
    s_mov_b32 s48, 200000
L_ct_71:
    s_sleep 1
    ds_read_b32 v12, v27 offset:64
    s_waitcnt lgkmcnt(0)
    v_cmp_gt_u32 vcc, 1, v12
    s_cbranch_vccz L_cn_70
    s_sub_u32 s48, s48, 1
    s_cmp_lg_u32 s48, 0
    s_cbranch_scc1 L_ct_71
    s_branch L_cn_70
L_cw_75:
    s_mov_b32 s48, 200000
L_ct_77:
    ds_read_b32 v12, v27 offset:80
    s_waitcnt lgkmcnt(0)
    v_cmp_gt_u32 vcc, 21, v12
    s_cbranch_vccz L_cn_76
    s_sub_u32 s48, s48, 1
    s_cmp_lg_u32 s48, 0
    s_cbranch_scc1 L_ct_77
    s_branch L_cn_76
L_cw_90:
    s_mov_b32 s48, 200000
L_ct_92:
    ds_read_b32 v12, v27 offset:80
    s_waitcnt lgkmcnt(0)
    v_cmp_gt_u32 vcc, 25, v12
    s_cbranch_vccz L_cn_91
    s_sub_u32 s48, s48, 1
    s_cmp_lg_u32 s48, 0
    s_cbranch_scc1 L_ct_92
    s_branch L_cn_91
L_cw_96:
    s_mov_b32 s48, 200000
L_ct_98:
    ds_read_b32 v12, v27 offset:80
    s_waitcnt lgkmcnt(0)
    v_cmp_gt_u32 vcc, 29, v12
    s_cbranch_vccz L_cn_97
    s_sub_u32 s48, s48, 1
    s_cmp_lg_u32 s48, 0
    s_cbranch_scc1 L_ct_98
    s_branch L_cn_97
L_cw_99:
    s_mov_b32 s48, 200000
L_ct_101:
    ds_read_b32 v12, v27 offset:80
    s_waitcnt lgkmcnt(0)
    v_cmp_gt_u32 vcc, 32, v12
    s_cbranch_vccz L_cn_100
    s_sub_u32 s48, s48, 1
    s_cmp_lg_u32 s48, 0
    s_cbranch_scc1 L_ct_101
    s_branch L_cn_100
L_cw_102:
    s_mov_b32 s48, 200000
L_ct_104:
    ds_read_b32 v12, v27 offset:80
    s_waitcnt lgkmcnt(0)
    v_cmp_gt_u32 vcc, 35, v12
    s_cbranch_vccz L_cn_103
    s_sub_u32 s48, s48, 1
    s_cmp_lg_u32 s48, 0
    s_cbranch_scc1 L_ct_104
    s_branch L_cn_103
L_cw_107:
    s_mov_b32 s48, 200000
L_ct_109:
    ds_read_b32 v12, v27 offset:80
    s_waitcnt lgkmcnt(0)
    v_cmp_gt_u32 vcc, 38, v12
    s_cbranch_vccz L_cn_108
    s_sub_u32 s48, s48, 1
    s_cmp_lg_u32 s48, 0
    s_cbranch_scc1 L_ct_109
    s_branch L_cn_108
L_cw_110:
    s_mov_b32 s48, 200000
L_ct_112:
    ds_read_b32 v12, v27 offset:80
    s_waitcnt lgkmcnt(0)
    v_cmp_gt_u32 vcc, 41, v12
    s_cbranch_vccz L_cn_111
    s_sub_u32 s48, s48, 1
    s_cmp_lg_u32 s48, 0
    s_cbranch_scc1 L_ct_112
    s_branch L_cn_111
L_cw_113:
    s_mov_b32 s48, 200000
L_ct_115:
    ds_read_b32 v12, v27 offset:80
    s_waitcnt lgkmcnt(0)
    v_cmp_gt_u32 vcc, 44, v12
    s_cbranch_vccz L_cn_114
    s_sub_u32 s48, s48, 1
    s_cmp_lg_u32 s48, 0
    s_cbranch_scc1 L_ct_115
    s_branch L_cn_114
L_cw_119:
    s_mov_b32 s48, 200000
L_ct_121:
    ds_read_b32 v12, v27 offset:80
    s_waitcnt lgkmcnt(0)
    v_cmp_gt_u32 vcc, 48, v12
    s_cbranch_vccz L_cn_120
    s_sub_u32 s48, s48, 1
    s_cmp_lg_u32 s48, 0
    s_cbranch_scc1 L_ct_121
    s_branch L_cn_120
L_cw_122:
    s_mov_b32 s48, 200000
L_ct_124:
    ds_read_b32 v12, v27 offset:80
    s_waitcnt lgkmcnt(0)
    v_cmp_gt_u32 vcc, 53, v12
    s_cbranch_vccz L_cn_123
    s_sub_u32 s48, s48, 1
    s_cmp_lg_u32 s48, 0
    s_cbranch_scc1 L_ct_124
    s_branch L_cn_123
L_cw_125:
    s_mov_b32 s48, 200000
L_ct_127:
    ds_read_b32 v12, v27 offset:80
    s_waitcnt lgkmcnt(0)
    v_cmp_gt_u32 vcc, 58, v12
    s_cbranch_vccz L_cn_126
    s_sub_u32 s48, s48, 1
    s_cmp_lg_u32 s48, 0
    s_cbranch_scc1 L_ct_127
    s_branch L_cn_126
L_cw_130:
    s_mov_b32 s48, 200000
L_ct_132:
    ds_read_b32 v12, v27 offset:80
    s_waitcnt lgkmcnt(0)
    v_cmp_gt_u32 vcc, 63, v12
    s_cbranch_vccz L_cn_131
    s_sub_u32 s48, s48, 1
    s_cmp_lg_u32 s48, 0
    s_cbranch_scc1 L_ct_132
    s_branch L_cn_131
L_cw_133:
    s_mov_b32 s48, 200000
L_ct_135:
    ds_read_b32 v12, v27 offset:80
    s_waitcnt lgkmcnt(0)
    v_cmp_gt_u32 vcc, 68, v12
    s_cbranch_vccz L_cn_134
    s_sub_u32 s48, s48, 1
    s_cmp_lg_u32 s48, 0
    s_cbranch_scc1 L_ct_135
    s_branch L_cn_134
L_cw_136:
    s_mov_b32 s48, 200000
L_ct_138:
    ds_read_b32 v12, v27 offset:80
    s_waitcnt lgkmcnt(0)
    v_cmp_gt_u32 vcc, 73, v12
    s_cbranch_vccz L_cn_137
    s_sub_u32 s48, s48, 1
    s_cmp_lg_u32 s48, 0
    s_cbranch_scc1 L_ct_138
    s_branch L_cn_137
L_cw_139:
    s_mov_b32 s48, 200000
L_ct_141:
    ds_read_b32 v12, v27 offset:80
    s_waitcnt lgkmcnt(0)
    v_cmp_gt_u32 vcc, 78, v12
    s_cbranch_vccz L_cn_140
    s_sub_u32 s48, s48, 1
    s_cmp_lg_u32 s48, 0
    s_cbranch_scc1 L_ct_141
    s_branch L_cn_140
L_cw_142:
    s_mov_b32 s48, 200000
L_ct_144:
    ds_read_b32 v12, v27 offset:80
    s_waitcnt lgkmcnt(0)
    v_cmp_gt_u32 vcc, 83, v12
    s_cbranch_vccz L_cn_143
    s_sub_u32 s48, s48, 1
    s_cmp_lg_u32 s48, 0
    s_cbranch_scc1 L_ct_144
    s_branch L_cn_143
L_cw_148:
    s_mov_b32 s48, 200000
L_ct_150:
    ds_read_b32 v12, v27 offset:80
    s_waitcnt lgkmcnt(0)
    v_cmp_gt_u32 vcc, 88, v12
    s_cbranch_vccz L_cn_149
    s_sub_u32 s48, s48, 1
    s_cmp_lg_u32 s48, 0
    s_cbranch_scc1 L_ct_150
    s_branch L_cn_149
L_cw_151:
    s_mov_b32 s48, 200000
L_ct_153:
    ds_read_b32 v12, v27 offset:80
    s_waitcnt lgkmcnt(0)
    v_cmp_gt_u32 vcc, 93, v12
    s_cbranch_vccz L_cn_152
    s_sub_u32 s48, s48, 1
    s_cmp_lg_u32 s48, 0
    s_cbranch_scc1 L_ct_153
    s_branch L_cn_152
L_cw_154:
    s_mov_b32 s48, 200000
L_ct_156:
    ds_read_b32 v12, v27 offset:80
    s_waitcnt lgkmcnt(0)
    v_cmp_gt_u32 vcc, 98, v12
    s_cbranch_vccz L_cn_155
    s_sub_u32 s48, s48, 1
    s_cmp_lg_u32 s48, 0
    s_cbranch_scc1 L_ct_156
    s_branch L_cn_155
L_cw_157:
    s_mov_b32 s48, 200000
L_ct_159:
    ds_read_b32 v12, v27 offset:80
    s_waitcnt lgkmcnt(0)
    v_cmp_gt_u32 vcc, 103, v12
    s_cbranch_vccz L_cn_158
    s_sub_u32 s48, s48, 1
    s_cmp_lg_u32 s48, 0
    s_cbranch_scc1 L_ct_159
    s_branch L_cn_158
L_cw_160:
    s_mov_b32 s48, 200000
L_ct_162:
    ds_read_b32 v12, v27 offset:80
    s_waitcnt lgkmcnt(0)
    v_cmp_gt_u32 vcc, 108, v12
    s_cbranch_vccz L_cn_161
    s_sub_u32 s48, s48, 1
    s_cmp_lg_u32 s48, 0
    s_cbranch_scc1 L_ct_162
    s_branch L_cn_161
L_cw_163:
    s_mov_b32 s48, 200000
L_ct_165:
    ds_read_b32 v12, v27 offset:80
    s_waitcnt lgkmcnt(0)
    v_cmp_gt_u32 vcc, 111, v12
    s_cbranch_vccz L_cn_164
    s_sub_u32 s48, s48, 1
    s_cmp_lg_u32 s48, 0
    s_cbranch_scc1 L_ct_165
    s_branch L_cn_164
L_cw_166:
    s_mov_b32 s48, 200000
L_ct_168:
    ds_read_b32 v12, v27 offset:96
    s_waitcnt lgkmcnt(0)
    v_cmp_gt_u32 vcc, 109, v12
    s_cbranch_vccz L_cn_167
    s_sub_u32 s48, s48, 1
    s_cmp_lg_u32 s48, 0
    s_cbranch_scc1 L_ct_168
    s_branch L_cn_167
L_cw_171:
    s_mov_b32 s48, 200000
L_ct_173:
    ds_read_b32 v12, v27 offset:80
    s_waitcnt lgkmcnt(0)
    v_cmp_gt_u32 vcc, 49, v12
    s_cbranch_vccz L_cn_172
    s_sub_u32 s48, s48, 1
    s_cmp_lg_u32 s48, 0
    s_cbranch_scc1 L_ct_173
    s_branch L_cn_172
L_cw_174:
    s_mov_b32 s48, 200000
L_ct_176:
    ds_read_b32 v12, v27 offset:80
    s_waitcnt lgkmcnt(0)
    v_cmp_gt_u32 vcc, 54, v12
    s_cbranch_vccz L_cn_175
    s_sub_u32 s48, s48, 1
    s_cmp_lg_u32 s48, 0
    s_cbranch_scc1 L_ct_176
    s_branch L_cn_175
L_cw_177:
    s_mov_b32 s48, 200000
L_ct_179:
    ds_read_b32 v12, v27 offset:80
    s_waitcnt lgkmcnt(0)
    v_cmp_gt_u32 vcc, 59, v12
    s_cbranch_vccz L_cn_178
    s_sub_u32 s48, s48, 1
    s_cmp_lg_u32 s48, 0
    s_cbranch_scc1 L_ct_179
    s_branch L_cn_178
L_cw_182:
    s_mov_b32 s48, 200000
L_ct_184:
    ds_read_b32 v12, v27 offset:80
    s_waitcnt lgkmcnt(0)
    v_cmp_gt_u32 vcc, 64, v12
    s_cbranch_vccz L_cn_183
    s_sub_u32 s48, s48, 1
    s_cmp_lg_u32 s48, 0
    s_cbranch_scc1 L_ct_184
    s_branch L_cn_183
L_cw_185:
    s_mov_b32 s48, 200000
L_ct_187:
    ds_read_b32 v12, v27 offset:80
    s_waitcnt lgkmcnt(0)
    v_cmp_gt_u32 vcc, 69, v12
    s_cbranch_vccz L_cn_186
    s_sub_u32 s48, s48, 1
    s_cmp_lg_u32 s48, 0
    s_cbranch_scc1 L_ct_187
    s_branch L_cn_186
L_cw_188:
    s_mov_b32 s48, 200000
L_ct_190:
    ds_read_b32 v12, v27 offset:80
    s_waitcnt lgkmcnt(0)
    v_cmp_gt_u32 vcc, 74, v12
    s_cbranch_vccz L_cn_189
    s_sub_u32 s48, s48, 1
    s_cmp_lg_u32 s48, 0
    s_cbranch_scc1 L_ct_190
    s_branch L_cn_189
L_cw_191:
    s_mov_b32 s48, 200000
L_ct_193:
    ds_read_b32 v12, v27 offset:80
    s_waitcnt lgkmcnt(0)
    v_cmp_gt_u32 vcc, 79, v12
    s_cbranch_vccz L_cn_192
    s_sub_u32 s48, s48, 1
    s_cmp_lg_u32 s48, 0
    s_cbranch_scc1 L_ct_193
    s_branch L_cn_192
L_cw_194:
    s_mov_b32 s48, 200000
L_ct_196:
    ds_read_b32 v12, v27 offset:80
    s_waitcnt lgkmcnt(0)
    v_cmp_gt_u32 vcc, 84, v12
    s_cbranch_vccz L_cn_195
    s_sub_u32 s48, s48, 1
    s_cmp_lg_u32 s48, 0
    s_cbranch_scc1 L_ct_196
    s_branch L_cn_195
L_cw_200:
    s_mov_b32 s48, 200000
L_ct_202:
    ds_read_b32 v12, v27 offset:80
    s_waitcnt lgkmcnt(0)
    v_cmp_gt_u32 vcc, 89, v12
    s_cbranch_vccz L_cn_201
    s_sub_u32 s48, s48, 1
    s_cmp_lg_u32 s48, 0
    s_cbranch_scc1 L_ct_202
    s_branch L_cn_201
L_cw_203:
    s_mov_b32 s48, 200000
L_ct_205:
    ds_read_b32 v12, v27 offset:80
    s_waitcnt lgkmcnt(0)
    v_cmp_gt_u32 vcc, 94, v12
    s_cbranch_vccz L_cn_204
    s_sub_u32 s48, s48, 1
    s_cmp_lg_u32 s48, 0
    s_cbranch_scc1 L_ct_205
    s_branch L_cn_204
L_cw_206:
    s_mov_b32 s48, 200000
L_ct_208:
    ds_read_b32 v12, v27 offset:80
    s_waitcnt lgkmcnt(0)
    v_cmp_gt_u32 vcc, 99, v12
    s_cbranch_vccz L_cn_207
    s_sub_u32 s48, s48, 1
    s_cmp_lg_u32 s48, 0
    s_cbranch_scc1 L_ct_208
    s_branch L_cn_207
L_cw_209:
    s_mov_b32 s48, 200000
L_ct_211:
    ds_read_b32 v12, v27 offset:80
    s_waitcnt lgkmcnt(0)
    v_cmp_gt_u32 vcc, 104, v12
    s_cbranch_vccz L_cn_210
    s_sub_u32 s48, s48, 1
    s_cmp_lg_u32 s48, 0
    s_cbranch_scc1 L_ct_211
    s_branch L_cn_210
L_cw_212:
    s_mov_b32 s48, 200000
L_ct_214:
    ds_read_b32 v12, v27 offset:80
    s_waitcnt lgkmcnt(0)
    v_cmp_gt_u32 vcc, 109, v12
    s_cbranch_vccz L_cn_213
    s_sub_u32 s48, s48, 1
    s_cmp_lg_u32 s48, 0
    s_cbranch_scc1 L_ct_214
    s_branch L_cn_213
L_cw_215:
    s_mov_b32 s48, 200000
L_ct_217:
    ds_read_b32 v12, v27 offset:80
    s_waitcnt lgkmcnt(0)
    v_cmp_gt_u32 vcc, 112, v12
    s_cbranch_vccz L_cn_216
    s_sub_u32 s48, s48, 1
    s_cmp_lg_u32 s48, 0
    s_cbranch_scc1 L_ct_217
    s_branch L_cn_216
L_cw_218:
    s_mov_b32 s48, 200000
L_ct_220:
    ds_read_b32 v12, v27 offset:96
    s_waitcnt lgkmcnt(0)
    v_cmp_gt_u32 vcc, 109, v12
    s_cbranch_vccz L_cn_219
    s_sub_u32 s48, s48, 1
    s_cmp_lg_u32 s48, 0
    s_cbranch_scc1 L_ct_220
    s_branch L_cn_219
L_last:
    s_endpgm
.section .rodata,"a"
.p2align 6
.amdhsa_kernel sequential_preLN__linear_kernel_hedgehog__dense_activation_relu__prompt_kernel
  .amdhsa_next_free_vgpr 256
  .amdhsa_next_free_sgpr 102
  .amdhsa_accum_offset 148
  .amdhsa_group_segment_fixed_size 0
  .amdhsa_kernarg_size 80
  .amdhsa_user_sgpr_count 2
  .amdhsa_user_sgpr_kernarg_segment_ptr 1
  .amdhsa_system_sgpr_workgroup_id_x 1
.end_amdhsa_kernel
```
